```python
import torch

def _softmax(x, axis=-1):
    return torch.softmax(x, dim=axis)
def _gelu(x):
    return torch.nn.functional.gelu(x, approximate="tanh")
def _silu(x):
    return torch.nn.functional.silu(x)
def _sigmoid(x):
    return torch.sigmoid(x)
def _layernorm(x, axis=-1, eps=1e-5):
    m = x.mean(dim=axis, keepdim=True)
    v = x.var(dim=axis, keepdim=True, unbiased=False)
    return (x - m) / torch.sqrt(v + eps)
def _scatter_add(tgt, idx, src, axis=0):
    return tgt.clone().index_add_(axis, idx, src)
def _segment_sum(src, seg, n):
    out = torch.zeros((n,) + src.shape[1:], dtype=src.dtype)
    return out.index_add_(0, seg, src)
def _pad(x, pw):
    flat = tuple(v for pair in reversed(pw) for v in pair)
    return torch.nn.functional.pad(x, flat)

kernel_name = 'standalone__window_attn_swin__vision'

def setup_inputs():

    _w = (lambda a: (lambda t: t.to(torch.bfloat16) if t.is_floating_point() else t)(torch.as_tensor(a)))
    H = W = 224
    C = 192
    ws = 7
    nh = 4
    shift = ws // 2
    coords = torch.stack(torch.meshgrid(torch.arange(ws), torch.arange(ws), indexing='ij'), 0).reshape(2, -1)
    rel = coords[:, :, None] - coords[:, None, :]
    rel[0] += ws - 1
    rel[1] += ws - 1
    rel[0] *= 2 * ws - 1
    rp_idx = rel.sum(0).to(torch.int64)
    img_mask = torch.zeros((1, H, W, 1), dtype=float)
    cnt = 0
    for hs in (slice(0, H - ws), slice(H - ws, H - shift), slice(H - shift, H)):
        for vs in (slice(0, W - ws), slice(W - ws, W - shift), slice(W - shift, W)):
            img_mask[:, hs, vs, :] = cnt
            cnt += 1
    mw = img_mask.reshape(1, H // ws, ws, W // ws, ws, 1).permute(0, 1, 3, 2, 4, 5).reshape(-1, ws * ws)
    am = mw[:, :, None] - mw[:, None, :]
    attn_mask = torch.where(am != 0, -100.0, 0.0).to(float)
    return {
        "x": _w((lambda *s: torch.randn(*s, dtype=torch.bfloat16) * 1.6)(1, H, W, C)),
        "wqkv": _w((lambda *s: torch.randn(*s, dtype=torch.bfloat16) * 1.6)(C, 3 * C) * 0.02),
        "wo": _w((lambda *s: torch.randn(*s, dtype=torch.bfloat16) * 0.05)(C, C) * 0.02),
        "rpb": _w((lambda *s: torch.randn(*s, dtype=torch.bfloat16) * 0.2)((2 * ws - 1) * (2 * ws - 1), nh)),
        "rp_idx": _w(rp_idx),
        "attn_mask": _w(attn_mask),
    }

def reference(x, wqkv, wo, rpb, rp_idx, attn_mask):
    B, H, W, C = x.shape
    N = rp_idx.shape[0]
    ws = int(round(N ** 0.5))
    nh = rpb.shape[-1]
    hd = C // nh
    shift = ws // 2
    xs = torch.roll(x, (-shift, -shift), (1, 2))
    nWh = H // ws
    nWw = W // ws
    xw = (lambda x, *d: x.permute(*d))(xs.reshape(B, nWh, ws, nWw, ws, C), 0, 1, 3, 2, 4, 5).reshape(B * nWh * nWw, N, C)
    qkv = (lambda x, *d: x.permute(*d))(torch.einsum('wnc,cd->wnd', xw, wqkv).reshape(-1, N, 3, nh, hd), 2, 0, 3, 1, 4)
    q, k, v = qkv[0], qkv[1], qkv[2]
    attn = torch.einsum('whid,whjd->whij', q, k) * (hd ** -0.5)
    bias = (lambda x, *d: x.permute(*d))(rpb[rp_idx.reshape(-1)].reshape(N, N, nh), 2, 0, 1)
    attn = attn + bias[None, :, :, :]
    attn = (attn.reshape(B, nWh * nWw, nh, N, N) + attn_mask[None, :, None, :, :]).reshape(-1, nh, N, N)
    attn = _softmax(attn, axis=-1)
    out = (lambda x, *d: x.permute(*d))(torch.einsum('whij,whjd->whid', attn, v), 0, 2, 1, 3).reshape(-1, N, C)
    out = torch.einsum('wnc,cd->wnd', out, wo)
    out = (lambda x, *d: x.permute(*d))(out.reshape(B, nWh, nWw, ws, ws, C), 0, 1, 3, 2, 4, 5).reshape(B, H, W, C)
    return torch.roll(out, (shift, shift), (1, 2))
```

```asm
; @launch grid=(256,1,1) block=(256,1,1) lds=159744
.amdgcn_target "amdgcn-amd-amdhsa--gfx950"
.text
.globl standalone__window_attn_swin__vision_kernel
.p2align 8
.type standalone__window_attn_swin__vision_kernel,@function
standalone__window_attn_swin__vision_kernel:
    s_cmp_ge_u32 s2, 256
    s_cbranch_scc1 L_exit
L_work:
    s_load_dwordx8 s[8:15], s[0:1], 0
    s_load_dwordx2 s[16:17], s[0:1], 48
    v_lshrrev_b32 v136, 6, v0
    v_and_b32 v120, 63, v0
    v_readfirstlane_b32 s40, v136
    s_getpc_b64 s[70:71]
L_pc:
    s_lshr_b32 s3, s2, 3
    v_lshrrev_b32 v200, 5, v0
    v_lshlrev_b32 v200, 5, v200
    v_add_u32 v200, s3, v200
    v_lshlrev_b32 v200, 7, v200
    v_min_u32 v202, L_codeend-L_pc-4, v200
    s_mov_b32 exec_lo, 1
    s_mov_b32 exec_hi, 1
    global_load_dword v255, v202, s[70:71]
    s_mov_b64 exec, -1
    s_and_b32 s63, s40, 1
    s_lshr_b32 s64, s40, 1
    v_lshrrev_b32 v132, 3, v120
    s_lshl_b32 s69, s63, 3
    s_lshl_b32 s71, s64, 4
    v_add_u32 v41, s69, v132
    v_add_u32 v42, s71, v41
    v_mul_u32_u24 v43, 37, v42
    s_lshr_b32 s41, s2, 3
    v_lshrrev_b32 v43, 8, v43
    s_mul_i32 s60, s41, 7
    v_mul_u32_u24 v44, 7, v43
    s_add_u32 s60, s60, 3
    v_sub_u32 v134, v42, v44
    v_add_u32 v44, s60, v43
    s_and_b32 s42, s2, 7
    v_subrev_u32 v45, 224, v44
    s_mov_b32 s62, 86016
    s_mul_i32 s61, s42, 28
    v_min_u32 v44, v44, v45
    s_add_u32 s61, s61, 3
    v_mul_u32_u24 v8, s62, v44
    v_bfe_u32 v48, v41, 1, 3
    v_add_u32 v44, s61, v134
    v_and_b32 v133, 7, v120
    v_mul_u32_u24 v44, 384, v44
    v_xor_b32 v48, v48, v133
    v_add_u32 v8, v8, v44
    s_mov_b32 s34, 1352
    s_mov_b32 s35, 0x20000
    s_lshl_b32 s72, s63, 10
    s_mul_i32 s45, s64, 6144
    v_lshl_add_u32 v8, v48, 4, v8
    s_add_u32 s45, s45, s72
    s_mov_b32 s52, 0
    s_mov_b32 s22, 19267584
    s_mov_b32 s23, 0x20000
    s_lshl_b32 s70, s64, 3
    v_add_u32 v49, s70, v132
    v_add_u32 v50, 32, v49
    v_mul_u32_u24 v51, 37, v50
    v_lshrrev_b32 v51, 8, v51
    v_mul_u32_u24 v52, 7, v51
    v_lshlrev_b32 v41, 3, v0
    v_sub_u32 v135, v50, v52
    v_add_u32 v52, s60, v51
    v_subrev_u32 v53, 224, v52
    s_waitcnt lgkmcnt(0)
    s_mov_b32 s32, s14
    s_and_b32 s33, s15, 0xffff
    s_mov_b32 s20, s8
    s_and_b32 s21, s9, 0xffff
    v_min_u32 v52, v52, v53
    buffer_load_dwordx2 v[124:125], v41, s[32:35], 0 offen
    v_mul_u32_u24 v9, s62, v52
    s_add_u32 m0, s45, 0
    v_add_u32 v52, s61, v135
    buffer_load_dwordx4 v8, s[20:23], s52 offen nt lds
    v_bfe_u32 v40, v49, 1, 3
    v_mul_u32_u24 v52, 384, v52
    s_add_u32 m0, s45, 1920
    s_lshl_b32 s68, s63, 12
    s_lshl_b32 s73, s64, 10
    v_xor_b32 v40, v40, v133
    v_add_u32 v9, v9, v52
    s_add_u32 s46, s73, s68
    v_lshl_add_u32 v9, v40, 4, v9
    s_add_u32 s46, s46, 12288
    s_lshl_b32 s56, s63, 8
    buffer_load_dwordx4 v8, s[20:23], s52 offen offset:128 nt lds
    s_add_u32 m0, s45, 3840
    s_sub_u32 s51, 0, s63
    s_add_u32 s47, s73, 14208
    s_not_b32 s50, s51
    s_mul_i32 s76, s40, 7
    s_add_u32 s66, s60, 6
    s_mov_b32 s26, 221184
    s_mov_b32 s30, 73728
    s_mov_b32 s24, s10
    s_and_b32 s25, s11, 0xffff
    s_mov_b32 s28, s12
    s_and_b32 s29, s13, 0xffff
    s_add_u32 s76, s76, s61
    s_cmp_ge_u32 s66, 224
    s_cselect_b32 s67, 224, 0
    s_cmp_eq_u32 s40, 3
    s_cselect_b32 s12, s28, s24
    s_cselect_b32 s13, s29, s25
    s_cselect_b32 s14, s30, s26
    s_mov_b32 s15, 0x20000
    s_cselect_b32 s7, 0, s40
    s_mul_i32 s7, s7, 18
    buffer_load_dwordx4 v8, s[20:23], s52 offen offset:256 nt lds
    s_add_u32 m0, s46, 0
    s_add_u32 s76, s76, 6
    s_sub_u32 s66, s66, s67
    v_add_u32 v43, s7, v120
    s_cmp_ge_u32 s76, 224
    s_cselect_b32 s67, 224, 0
    s_mov_b32 s3, 0x2AAAAAAB
    v_lshlrev_b32 v42, 4, v120
    v_add_u32 v44, 0, v120
    v_lshlrev_b32 v43, 5, v43
    s_sub_u32 s76, s76, s67
    s_mul_i32 s66, s66, 86016
    buffer_load_dwordx4 v9, s[20:23], s56 offen nt lds
    s_add_u32 m0, s47, 0
    v_mul_hi_u32 v126, v44, s3
    v_add_u32 v43, s41, v43
    s_mul_i32 s76, s76, 384
    s_mul_i32 s67, s40, 384
    v_add_u32 v51, 64, v120
    v_lshlrev_b32 v44, 4, v44
    v_mul_u32_u24 v45, 96, v126
    v_bfe_u32 v49, v126, 2, 2
    v_and_b32 v48, 3, v126
    v_lshlrev_b32 v43, 7, v43
    s_add_u32 s76, s76, s66
    s_mul_i32 s65, s40, 96
    v_lshrrev_b32 v50, 4, v126
    v_mul_hi_u32 v127, v51, s3
    v_sub_u32 v129, v44, v45
    s_mov_b64 exec, s[50:51]
    buffer_load_dwordx4 v9, s[20:23], s52 offen offset:128 nt lds
    s_mov_b64 exec, -1
    s_add_u32 m0, s67, 36864
    v_lshl_add_u32 v49, v49, 3, v48
    s_movk_i32 s6, 0x480
    v_lshlrev_b32 v51, 4, v51
    v_mul_u32_u24 v52, 96, v127
    v_bfe_u32 v40, v127, 2, 2
    v_and_b32 v53, 3, v127
    v_add_u32 v129, s65, v129
    v_lshl_add_u32 v49, v50, 2, v49
    s_mul_i32 s48, s40, 3072
    v_lshrrev_b32 v41, 4, v127
    v_sub_u32 v130, v51, v52
    v_lshl_add_u32 v40, v40, 3, v53
    v_mad_u32_u24 v212, v49, s6, v129
    s_mov_b64 exec, 0xffffff
    buffer_load_dwordx4 v42, s[20:23], s76 offen nt lds
    s_mov_b64 exec, -1
    v_add_u32 v42, 0x80, v120
    v_mul_hi_u32 v128, v42, s3
    s_mov_b64 exec, 0x3ffff
    buffer_load_dword v254, v43, s[12:15], 0 offen
    s_mov_b64 exec, -1
    s_add_u32 s48, s48, 86016
    s_add_u32 m0, s48, 0
    v_add_u32 v130, s65, v130
    v_lshl_add_u32 v40, v41, 2, v40
    v_lshlrev_b32 v42, 4, v42
    v_bfe_u32 v45, v128, 2, 2
    v_and_b32 v44, 3, v128
    v_mul_u32_u24 v43, 96, v128
    s_mov_b32 s27, 0x20000
    s_mov_b32 s74, 384
    buffer_load_dwordx4 v212, s[24:27], s74 offen lds
    s_add_u32 m0, s48, 1024
    v_lshrrev_b32 v48, 4, v128
    v_mad_u32_u24 v213, v40, s6, v130
    v_lshl_add_u32 v45, v45, 3, v44
    v_sub_u32 v131, v42, v43
    v_lshl_add_u32 v45, v48, 2, v45
    v_add_u32 v131, s65, v131
    v_mad_u32_u24 v214, v45, s6, v131
    v_lshlrev_b32 v49, 4, v120
    v_mov_b32 v184, 0
    v_mov_b32 v185, 0
    buffer_load_dwordx4 v213, s[24:27], s74 offen lds
    s_add_u32 m0, s48, 2048
    v_mov_b32 v186, 0
    v_mov_b32 v187, 0
    v_add_u32 v49, 0x9600, v49
    s_mov_b32 exec_lo, 0xffffff
    s_mov_b32 exec_hi, 0x0
    ds_write_b128 v49, v[184:187]
    s_mov_b64 exec, -1
    s_mov_b32 s53, 2688
    s_add_u32 s57, s56, 2688
    buffer_load_dwordx4 v214, s[24:27], s74 offen lds
    s_mov_b32 s31, 0x20000
    v_lshlrev_b32 v28, 2, v120
    s_mov_b32 s54, 5376
    s_add_u32 s58, s56, 5376
    s_mov_b32 s38, 19267584
    s_mov_b32 s39, 0x20000
    s_mov_b32 s36, s16
    s_and_b32 s37, s17, 0xffff
    v_lshrrev_b32 v122, 4, v120
    v_bfe_u32 v50, v120, 2, 2
    v_lshl_add_u32 v50, v122, 2, v50
    v_mul_u32_u24 v50, 0x60, v50
    v_and_b32 v51, 3, v120
    v_add_u32 v50, s48, v50
    v_lshl_add_u32 v221, v51, 3, v50
    v_and_b32 v121, 15, v120
    s_lshl_b32 s3, s63, 5
    v_lshl_add_u32 v222, v51, 4, v50
    v_add_u32 v222, s3, v222
    s_lshl_b32 s3, s40, 8
    v_add_u32 v28, s3, v28
    v_add_u32 v28, 0x14000, v28
    v_bfe_u32 v52, v121, 1, 3
    v_xor_b32 v52, v52, v122
    v_lshlrev_b32 v52, 4, v52
    v_lshrrev_b32 v40, 2, v121
    v_and_b32 v41, 3, v121
    v_lshl_add_u32 v0, v121, 7, v52
    v_mul_u32_u24 v40, 0x180, v40
    v_cmp_eq_u32 vcc, 0, v41
    v_lshl_add_u32 v40, v122, 4, v40
    v_mov_b32 v41, 0x9600
    v_add_u32 v40, 0x9000, v40
    v_xor_b32 v1, 64, v0
    v_cndmask_b32 v223, v41, v40, vcc
    v_add_u32 v24, 0, v121
    s_mul_i32 s77, s40, 1024
    v_mul_u32_u24 v25, 37, v24
    s_add_u32 s77, s77, 81920
    v_lshrrev_b32 v25, 8, v25
    v_lshlrev_b32 v24, 2, v24
    s_add_u32 s78, s77, 336
    v_mad_u32_u24 v25, v25, 24, v24
    v_add_u32 v26, 16, v121
    v_add_u32 v104, s78, v25
    v_add_u32 v24, 32, v121
    v_mul_u32_u24 v27, 37, v26
    v_mul_u32_u24 v25, 37, v24
    v_lshrrev_b32 v27, 8, v27
    v_lshlrev_b32 v26, 2, v26
    v_lshrrev_b32 v25, 8, v25
    v_lshlrev_b32 v24, 2, v24
    v_lshlrev_b32 v107, 2, v122
    v_mad_u32_u24 v27, v27, 24, v26
    v_mad_u32_u24 v25, v25, 24, v24
    v_add_u32 v105, s78, v27
    v_add_u32 v26, 1, v107
    v_add_u32 v106, s78, v25
    v_add_u32 v24, 0, v107
    v_mul_u32_u24 v27, 37, v26
    v_mul_u32_u24 v25, 37, v24
    v_lshrrev_b32 v27, 8, v27
    v_lshlrev_b32 v26, 2, v26
    v_lshrrev_b32 v25, 8, v25
    v_lshlrev_b32 v24, 2, v24
    v_mad_u32_u24 v67, v27, 24, v26
    v_mad_u32_u24 v66, v25, 24, v24
    v_add_u32 v26, 3, v107
    v_add_u32 v24, 2, v107
    v_mul_u32_u24 v27, 37, v26
    v_mul_u32_u24 v25, 37, v24
    v_lshrrev_b32 v27, 8, v27
    s_waitcnt vmcnt(10)
    v_lshlrev_b32 v100, 16, v124
    v_and_b32 v101, 0xffff0000, v124
    v_lshlrev_b32 v102, 16, v125
    v_and_b32 v103, 0xffff0000, v125
    v_lshlrev_b32 v26, 2, v26
    v_lshrrev_b32 v25, 8, v25
    v_lshlrev_b32 v24, 2, v24
    v_mad_u32_u24 v69, v27, 24, v26
    v_mad_u32_u24 v68, v25, 24, v24
    v_add_u32 v26, 17, v107
    v_add_u32 v24, 16, v107
    v_mul_u32_u24 v27, 37, v26
    v_mul_u32_u24 v25, 37, v24
    v_lshrrev_b32 v27, 8, v27
    v_lshlrev_b32 v26, 2, v26
    v_lshrrev_b32 v25, 8, v25
    v_lshlrev_b32 v24, 2, v24
    v_mad_u32_u24 v73, v27, 24, v26
    v_mad_u32_u24 v72, v25, 24, v24
    v_add_u32 v26, 19, v107
    v_add_u32 v24, 18, v107
    v_mul_u32_u24 v27, 37, v26
    v_mul_u32_u24 v25, 37, v24
    v_lshrrev_b32 v27, 8, v27
    v_lshlrev_b32 v26, 2, v26
    v_lshrrev_b32 v25, 8, v25
    v_lshlrev_b32 v24, 2, v24
    v_mad_u32_u24 v75, v27, 24, v26
    v_mad_u32_u24 v74, v25, 24, v24
    s_mov_b32 s44, 0x3fb8aa3b
    v_mul_f32 v100, s44, v100
    v_mul_f32 v101, s44, v101
    v_mul_f32 v102, s44, v102
    v_mul_f32 v103, s44, v103
    ds_write_b32 v28, v100
    ds_write_b32 v28, v101 offset:1024
    ds_write_b32 v28, v102 offset:2048
    ds_write_b32 v28, v103 offset:3072
    v_add_u32 v26, 33, v107
    v_add_u32 v24, 32, v107
    v_mul_u32_u24 v27, 37, v26
    v_mul_u32_u24 v25, 37, v24
    v_lshrrev_b32 v37, 2, v121
    v_lshrrev_b32 v27, 8, v27
    v_lshlrev_b32 v26, 2, v26
    v_lshrrev_b32 v25, 8, v25
    v_lshlrev_b32 v24, 2, v24
    v_and_b32 v123, 3, v121
    v_lshlrev_b32 v37, 4, v37
    v_mad_u32_u24 v77, v27, 24, v26
    v_mad_u32_u24 v76, v25, 24, v24
    v_min_u32 v35, 48, v120
    v_add3_u32 v37, v37, v123, v107
    v_add_u32 v26, 35, v107
    v_add_u32 v24, 34, v107
    v_mul_u32_u24 v36, 37, v35
    v_mul_u32_u24 v123, 37, v37
    v_mul_u32_u24 v27, 37, v26
    v_mul_u32_u24 v25, 37, v24
    v_sub_u32 v225, v104, v67
    s_waitcnt lgkmcnt(0)
    s_barrier
    ds_read_b32 v81, v225
    v_sub_u32 v237, v105, v67
    ds_read_b32 v93, v237
    v_sub_u32 v249, v106, v67
    ds_read_b32 v185, v249
    v_sub_u32 v224, v104, v66
    ds_read_b32 v80, v224
    v_sub_u32 v236, v105, v66
    ds_read_b32 v92, v236
    v_sub_u32 v248, v106, v66
    ds_read_b32 v184, v248
    v_sub_u32 v227, v104, v69
    ds_read_b32 v83, v227
    v_sub_u32 v239, v105, v69
    ds_read_b32 v95, v239
    v_sub_u32 v251, v106, v69
    ds_read_b32 v187, v251
    v_sub_u32 v226, v104, v68
    ds_read_b32 v82, v226
    v_sub_u32 v238, v105, v68
    ds_read_b32 v94, v238
    v_sub_u32 v250, v106, v68
    ds_read_b32 v186, v250
    v_lshlrev_b32 v34, 2, v37
    v_lshrrev_b32 v36, 8, v36
    v_lshlrev_b32 v35, 2, v35
    v_lshrrev_b32 v123, 8, v123
    v_lshrrev_b32 v27, 8, v27
    v_lshlrev_b32 v26, 2, v26
    v_lshrrev_b32 v25, 8, v25
    v_lshlrev_b32 v24, 2, v24
    s_add_u32 s79, s77, 672
    v_sub_u32 v229, v104, v73
    ds_read_b32 v85, v229
    v_sub_u32 v241, v105, v73
    ds_read_b32 v97, v241
    v_sub_u32 v253, v106, v73
    ds_read_b32 v189, v253
    v_sub_u32 v228, v104, v72
    ds_read_b32 v84, v228
    v_sub_u32 v240, v105, v72
    ds_read_b32 v96, v240
    v_sub_u32 v252, v106, v72
    ds_read_b32 v188, v252
    v_sub_u32 v231, v104, v75
    ds_read_b32 v87, v231
    v_sub_u32 v243, v105, v75
    ds_read_b32 v99, v243
    v_sub_u32 v57, v106, v75
    ds_read_b32 v191, v57
    v_sub_u32 v230, v104, v74
    ds_read_b32 v86, v230
    v_sub_u32 v242, v105, v74
    ds_read_b32 v98, v242
    v_sub_u32 v56, v106, v74
    ds_read_b32 v190, v56
    v_mad_u32_u24 v36, v36, 24, v35
    v_mad_u32_u24 v123, v123, 24, v34
    v_mad_u32_u24 v199, v27, 24, v26
    v_mad_u32_u24 v198, v25, 24, v24
    v_sub_u32 v233, v104, v77
    ds_read_b32 v89, v233
    v_sub_u32 v245, v105, v77
    ds_read_b32 v101, v245
    v_sub_u32 v59, v106, v77
    ds_read_b32 v193, v59
    v_sub_u32 v232, v104, v76
    ds_read_b32 v88, v232
    v_sub_u32 v244, v105, v76
    ds_read_b32 v100, v244
    v_sub_u32 v58, v106, v76
    ds_read_b32 v192, v58
    v_add_u32 v64, s77, v36
    ds_read_b32 v196, v64
    v_sub_u32 v65, s79, v123
    ds_read_b32 v197, v65
    v_sub_u32 v235, v104, v199
    ds_read_b32 v91, v235
    v_sub_u32 v247, v105, v199
    ds_read_b32 v103, v247
    v_sub_u32 v61, v106, v199
    ds_read_b32 v195, v61
    v_sub_u32 v234, v104, v198
    ds_read_b32 v90, v234
    v_sub_u32 v246, v105, v198
    ds_read_b32 v102, v246
    v_sub_u32 v60, v106, v198
    ds_read_b32 v194, v60
    s_mul_i32 s49, s40, 9728
    v_lshlrev_b32 v43, 4, v120
    s_add_u32 s49, s49, 43008
    v_mul_u32_u24 v33, 80, v122
    v_add_u32 v5, s49, v43
    v_mul_u32_u24 v29, 80, v120
    v_lshl_add_u32 v33, v121, 2, v33
    v_mov_b32 v32, 0xf149f2ca
    v_add_u32 v34, s49, v34
    v_add_u32 v29, s49, v29
    v_add_u32 v33, s49, v33
    s_waitcnt lgkmcnt(15)
    ds_write_b128 v5, v[80:83]
    v_lshlrev_b32 v42, 4, v122
    v_add_u32 v42, s49, v42
    v_add_u32 v6, 0x2540, v42
    ds_write_b128 v5, v[92:95] offset:3072
    s_add_u32 m0, s48, 12288
    s_mov_b32 s75, 37248
    buffer_load_dwordx4 v212, s[24:27], s75 offen lds
    s_add_u32 m0, s48, 13312
    s_mov_b32 s74, 74112
    v_mul_u32_u24 v48, 0x180, v127
    ds_write_b128 v5, v[184:187] offset:6144
    buffer_load_dwordx4 v213, s[24:27], s75 offen lds
    s_add_u32 m0, s48, 14336
    v_mul_u32_u24 v44, 0x180, v126
    ds_write_b128 v5, v[84:87] offset:1024
    v_add_u32 v216, v48, v130
    v_add_u32 v215, v44, v129
    v_add_u32 v48, 0, v121
    v_lshrrev_b32 v45, 4, v126
    v_mul_u32_u24 v44, 37, v48
    v_mul_u32_u24 v45, 0x3000, v45
    ds_write_b128 v5, v[96:99] offset:4096
    buffer_load_dwordx4 v214, s[24:27], s75 offen lds
    s_add_u32 m0, s48, 24576
    s_mov_b32 s75, 110976
    v_lshrrev_b32 v44, 8, v44
    s_cmp_eq_u32 s42, 7
    s_cselect_b32 s68, 4, 64
    s_waitcnt lgkmcnt(15)
    ds_write_b128 v5, v[188:191] offset:7168
    v_add_u32 v218, v215, v45
    v_mul_u32_u24 v41, 7, v44
    v_cmp_le_u32 vcc, s68, v134
    buffer_load_dwordx4 v212, s[24:27], s74 offen lds
    s_waitcnt lgkmcnt(12)
    s_mov_b32 exec_lo, 0xfff0fff
    s_mov_b32 exec_hi, 0xfff0fff
    ds_write_b32 v34, v197 offset:9536
    s_mov_b64 exec, -1
    s_mov_b32 exec_lo, 0xf
    s_mov_b32 exec_hi, 0x0
    ds_write_b32 v29, v32 offset:9280
    s_mov_b64 exec, -1
    ds_write_b32 v33, v196 offset:9216
    s_waitcnt lgkmcnt(11)
    ds_write_b128 v5, v[88:91] offset:2048
    s_add_u32 m0, s48, 25600
    v_sub_u32 v45, v48, v41
    buffer_load_dwordx4 v213, s[24:27], s74 offen lds
    s_add_u32 m0, s48, 26624
    s_waitcnt lgkmcnt(11)
    ds_write_b128 v5, v[100:103] offset:5120
    v_add_u32 v41, s60, v44
    v_mov_b32 v52, 1
    buffer_load_dwordx4 v214, s[24:27], s74 offen lds
    s_waitcnt lgkmcnt(11)
    ds_write_b128 v5, v[192:195] offset:8192
    s_add_u32 m0, s48, 36864
    s_mov_b32 s74, 147840
    v_subrev_u32 v42, 224, v41
    v_cndmask_b32 v52, 0, v52, vcc
    v_min_u32 v41, v41, v42
    v_cmp_le_u32 vcc, s68, v135
    v_mul_u32_u24 v12, s62, v41
    v_add_u32 v41, s61, v45
    buffer_load_dwordx4 v212, s[24:27], s75 offen lds
    s_add_u32 m0, s48, 37888
    v_mov_b32 v53, 2
    v_mul_u32_u24 v41, 384, v41
    s_lshl_b32 s7, s63, 5
    v_cndmask_b32 v53, 0, v53, vcc
    v_add_u32 v12, v12, v41
    s_add_u32 s7, s7, s65
    v_cmp_le_u32 vcc, s68, v45
    v_lshl_add_u32 v41, v122, 4, v12
    v_mov_b32 v11, 0
    v_add_u32 v12, s7, v41
    v_or_b32 v11, v11, v52
    v_mov_b32 v41, 4
    v_or_b32 v11, v11, v53
    v_cndmask_b32 v41, 0, v41, vcc
    v_or_b32 v11, v11, v41
    buffer_load_dwordx4 v213, s[24:27], s75 offen lds
    s_add_u32 m0, s48, 38912
    s_waitcnt vmcnt(12)
    s_barrier
    ds_read_b128 v[200:203], v0
    ds_read_b128 v[204:207], v0 offset:6144
    ds_read_b128 v[108:111], v223
    ds_read_b128 v[112:115], v1
    buffer_load_dwordx4 v214, s[24:27], s75 offen lds
    s_add_u32 m0, s48, 49152
    s_mov_b32 s75, 184704
    ds_read_b128 v[116:119], v1 offset:6144
    s_waitcnt vmcnt(9)
    ds_read_b64_tr_b16 a[0:1], v221
    ds_read_b64_tr_b16 a[2:3], v221 offset:1536
    buffer_load_dwordx4 v212, s[24:27], s74 offen lds
    s_add_u32 m0, s48, 50176
    ds_read_b64_tr_b16 a[4:5], v221 offset:32
    ds_read_b64_tr_b16 a[6:7], v221 offset:1568
    ds_read_b64_tr_b16 a[8:9], v221 offset:64
    ds_read_b64_tr_b16 a[10:11], v221 offset:1600
    ds_read_b128 v[208:211], v0 offset:12288
    v_lshrrev_b32 v42, 2, v45
    v_lshrrev_b32 v41, 2, v44
    v_lshrrev_b32 v49, 4, v127
    v_lshl_add_u32 v43, v41, 1, v42
    v_mul_u32_u24 v49, 0x3000, v49
    v_cmp_eq_u32 vcc, v43, v122
    v_mul_u32_u24 v50, 0x180, v128
    s_waitcnt lgkmcnt(5)
    v_mfma_f32_16x16x32_bf16 v[136:139], a[0:3], v[200:203], 0
    v_add_u32 v219, v216, v49
    s_cmp_eq_u32 s41, 31
    s_cselect_b32 s72, 2, 0
    v_mfma_f32_16x16x32_bf16 v[148:151], a[0:3], v[204:207], 0
    buffer_load_dwordx4 v213, s[24:27], s74 offen lds
    s_add_u32 m0, s48, 51200
    s_waitcnt lgkmcnt(3)
    v_mfma_f32_16x16x32_bf16 v[140:143], a[4:7], v[200:203], 0
    v_mov_b32 v41, 0x3f803f80
    v_add_u32 v217, v50, v131
    v_mfma_f32_16x16x32_bf16 v[152:155], a[4:7], v[204:207], 0
    s_waitcnt lgkmcnt(1)
    v_xor_b32 v49, v43, v122
    v_cndmask_b32 v15, 0, v41, vcc
    v_mfma_f32_16x16x32_bf16 v[144:147], a[8:11], v[200:203], 0
    s_waitcnt lgkmcnt(0)
    ds_read_b128 v[200:203], v1 offset:12288
    v_and_b32 v50, s72, v49
    v_mfma_f32_16x16x32_bf16 v[156:159], a[8:11], v[204:207], 0
    buffer_load_dwordx4 v214, s[24:27], s74 offen lds
    s_add_u32 m0, s48, 61440
    v_mfma_f32_16x16x32_bf16 v[172:175], a[0:3], v[108:111], 0
    s_mov_b32 s74, 0
    ds_read_b128 v[204:207], v223 offset:64
    v_cmp_ne_u32 vcc, 0, v50
    v_mfma_f32_16x16x32_bf16 v[176:179], a[4:7], v[108:111], 0
    s_cmp_eq_u32 s42, 7
    s_cselect_b32 s73, 1, 0
    v_mov_b32 v41, 0xbe8ac310
    v_mfma_f32_16x16x32_bf16 v[180:183], a[8:11], v[108:111], 0
    ds_read_b128 v[108:111], v0 offset:8192
    s_or_b32 s73, s73, s72
    v_mfma_f32_16x16x32_bf16 v[160:163], a[0:3], v[208:211], 0
    v_cndmask_b32 v30, 0, v41, vcc
    v_and_b32 v50, s73, v49
    v_mfma_f32_16x16x32_bf16 v[164:167], a[4:7], v[208:211], 0
    buffer_load_dwordx4 v212, s[24:27], s75 offen lds
    s_add_u32 m0, s48, 62464
    v_mfma_f32_16x16x32_bf16 v[168:171], a[8:11], v[208:211], 0
    ds_read_b128 v[208:211], v0 offset:2048
    v_lshlrev_b32 v40, 4, v120
    v_cmp_ne_u32 vcc, 0, v50
    v_lshrrev_b32 v51, 4, v128
    v_add_u32 v42, 16, v121
    v_add_u32 v2, 0x15000, v40
    v_mov_b32 v41, 32
    v_mul_u32_u24 v51, 0x3000, v51
    v_mul_u32_u24 v40, 37, v42
    v_cndmask_b32 v41, 0, v41, vcc
    v_add_u32 v220, v217, v51
    buffer_load_dwordx4 v213, s[24:27], s75 offen lds
    s_add_u32 m0, s48, 63488
    v_lshrrev_b32 v40, 8, v40
    v_or_b32 v11, v11, v41
    v_mul_u32_u24 v51, 7, v40
    v_sub_u32 v41, v42, v51
    v_add_u32 v51, s60, v40
    v_subrev_u32 v52, 224, v51
    v_min_u32 v51, v51, v52
    v_mul_u32_u24 v13, s62, v51
    s_waitcnt vmcnt(11)
    ds_read_b64_tr_b16 a[12:13], v221 offset:12288
    ds_read_b64_tr_b16 a[14:15], v221 offset:13824
    buffer_load_dwordx4 v214, s[24:27], s75 offen lds
    s_add_u32 m0, s48, 0
    ds_read_b64_tr_b16 a[16:17], v221 offset:12320
    ds_read_b64_tr_b16 a[18:19], v221 offset:13856
    ds_read_b64_tr_b16 a[20:21], v221 offset:12352
    ds_read_b64_tr_b16 a[22:23], v221 offset:13888
    s_mov_b32 s75, 36864
    v_add_u32 v51, s61, v41
    v_mul_u32_u24 v51, 384, v51
    v_add_u32 v13, v13, v51
    v_cmp_le_u32 vcc, s68, v41
    v_lshl_add_u32 v51, v122, 4, v13
    v_add_u32 v13, s7, v51
    v_mov_b32 v51, 8
    v_cndmask_b32 v51, 0, v51, vcc
    s_waitcnt lgkmcnt(4)
    v_mfma_f32_16x16x32_bf16 v[136:139], a[12:15], v[112:115], v[136:139]
    v_or_b32 v11, v11, v51
    v_lshrrev_b32 v52, 2, v41
    v_mfma_f32_16x16x32_bf16 v[148:151], a[12:15], v[116:119], v[148:151]
    buffer_load_dwordx4 v212, s[24:27], s74 offen lds
    s_add_u32 m0, s48, 1024
    s_waitcnt lgkmcnt(2)
    v_mfma_f32_16x16x32_bf16 v[140:143], a[16:19], v[112:115], v[140:143]
    v_lshrrev_b32 v51, 2, v40
    v_lshl_add_u32 v53, v51, 1, v52
    v_mfma_f32_16x16x32_bf16 v[152:155], a[16:19], v[116:119], v[152:155]
    s_waitcnt lgkmcnt(0)
    v_cmp_eq_u32 vcc, v53, v122
    v_mov_b32 v51, 0x3f803f80
    v_mfma_f32_16x16x32_bf16 v[144:147], a[20:23], v[112:115], v[144:147]
    ds_read_b128 v[112:115], v0 offset:14336
    v_xor_b32 v43, v53, v122
    v_mfma_f32_16x16x32_bf16 v[156:159], a[20:23], v[116:119], v[156:159]
    buffer_load_dwordx4 v213, s[24:27], s74 offen lds
    s_add_u32 m0, s48, 2048
    v_mfma_f32_16x16x32_bf16 v[160:163], a[12:15], v[200:203], v[160:163]
    ds_read_b128 v[116:119], v223 offset:128
    v_cndmask_b32 v70, 0, v51, vcc
    v_mfma_f32_16x16x32_bf16 v[172:175], a[12:15], v[204:207], v[172:175]
    v_and_b32 v44, s72, v43
    v_cmp_ne_u32 vcc, 0, v44
    v_mfma_f32_16x16x32_bf16 v[164:167], a[16:19], v[200:203], v[164:167]
    v_mov_b32 v51, 0xbe8ac310
    v_and_b32 v44, s73, v43
    v_mfma_f32_16x16x32_bf16 v[176:179], a[16:19], v[204:207], v[176:179]
    v_cndmask_b32 v38, 0, v51, vcc
    v_cmp_ne_u32 vcc, 0, v44
    v_mfma_f32_16x16x32_bf16 v[168:171], a[20:23], v[200:203], v[168:171]
    buffer_load_dwordx4 v214, s[24:27], s74 offen lds
    s_add_u32 m0, s48, 12288
    v_mfma_f32_16x16x32_bf16 v[180:183], a[20:23], v[204:207], v[180:183]
    s_waitcnt vmcnt(12)
    ds_read_b64_tr_b16 a[24:25], v221 offset:24576
    ds_read_b64_tr_b16 a[26:27], v221 offset:26112
    buffer_load_dwordx4 v212, s[24:27], s75 offen lds
    s_add_u32 m0, s48, 13312
    ds_read_b64_tr_b16 a[28:29], v221 offset:24608
    ds_read_b64_tr_b16 a[30:31], v221 offset:26144
    ds_read_b64_tr_b16 a[32:33], v221 offset:24640
    ds_read_b64_tr_b16 a[34:35], v221 offset:26176
    s_mov_b32 s74, 73728
    ds_read_b128 v[200:203], v1 offset:2048
    s_waitcnt lgkmcnt(5)
    v_mfma_f32_16x16x32_bf16 v[148:151], a[24:27], v[108:111], v[148:151]
    ds_read_b128 v[204:207], v1 offset:8192
    v_add_u32 v52, 32, v121
    v_mfma_f32_16x16x32_bf16 v[160:163], a[24:27], v[112:115], v[160:163]
    v_mov_b32 v51, 64
    v_mul_u32_u24 v50, 37, v52
    v_mfma_f32_16x16x32_bf16 v[172:175], a[24:27], v[116:119], v[172:175]
    buffer_load_dwordx4 v213, s[24:27], s75 offen lds
    v_mfma_f32_16x16x32_bf16 v[136:139], a[24:27], v[208:211], v[136:139]
    s_waitcnt lgkmcnt(4)
    s_add_u32 m0, s48, 14336
    v_cndmask_b32 v51, 0, v51, vcc
    v_lshrrev_b32 v50, 8, v50
    v_mfma_f32_16x16x32_bf16 v[152:155], a[28:31], v[108:111], v[152:155]
    v_or_b32 v11, v11, v51
    v_mul_u32_u24 v45, 7, v50
    v_mfma_f32_16x16x32_bf16 v[164:167], a[28:31], v[112:115], v[164:167]
    s_waitcnt lgkmcnt(2)
    v_sub_u32 v51, v52, v45
    v_add_u32 v45, s60, v50
    v_mfma_f32_16x16x32_bf16 v[176:179], a[28:31], v[116:119], v[176:179]
    v_subrev_u32 v48, 224, v45
    v_min_u32 v45, v45, v48
    v_mfma_f32_16x16x32_bf16 v[156:159], a[32:35], v[108:111], v[156:159]
    buffer_load_dwordx4 v214, s[24:27], s75 offen lds
    s_add_u32 m0, s48, 24576
    v_mfma_f32_16x16x32_bf16 v[168:171], a[32:35], v[112:115], v[168:171]
    s_waitcnt vmcnt(12)
    ds_read_b64_tr_b16 a[36:37], v221 offset:36864
    ds_read_b64_tr_b16 a[38:39], v221 offset:38400
    v_mfma_f32_16x16x32_bf16 v[180:183], a[32:35], v[116:119], v[180:183]
    ds_read_b64_tr_b16 a[40:41], v221 offset:36896
    ds_read_b64_tr_b16 a[42:43], v221 offset:38432
    v_mfma_f32_16x16x32_bf16 v[140:143], a[28:31], v[208:211], v[140:143]
    ds_read_b64_tr_b16 a[44:45], v221 offset:36928
    ds_read_b64_tr_b16 a[46:47], v221 offset:38464
    v_mfma_f32_16x16x32_bf16 v[144:147], a[32:35], v[208:211], v[144:147]
    buffer_load_dwordx4 v212, s[24:27], s74 offen lds
    s_add_u32 m0, s48, 25600
    s_mov_b32 s75, 110592
    ds_read_b128 v[108:111], v223 offset:192
    ds_read_b128 v[112:115], v0 offset:4096
    ds_read_b128 v[116:119], v0 offset:10240
    v_mul_u32_u24 v14, s62, v45
    s_waitcnt lgkmcnt(7)
    v_mfma_f32_16x16x32_bf16 v[136:139], a[36:39], v[200:203], v[136:139]
    ds_read_b128 v[208:211], v1 offset:14336
    v_add_u32 v45, s61, v51
    v_mfma_f32_16x16x32_bf16 v[148:151], a[36:39], v[204:207], v[148:151]
    s_waitcnt lgkmcnt(5)
    v_mul_u32_u24 v45, 384, v45
    v_add_u32 v14, v14, v45
    v_mfma_f32_16x16x32_bf16 v[152:155], a[40:43], v[204:207], v[152:155]
    s_waitcnt lgkmcnt(4)
    v_cmp_le_u32 vcc, s68, v51
    v_lshl_add_u32 v45, v122, 4, v14
    v_mfma_f32_16x16x32_bf16 v[140:143], a[40:43], v[200:203], v[140:143]
    buffer_load_dwordx4 v213, s[24:27], s74 offen lds
    s_add_u32 m0, s48, 26624
    v_mfma_f32_16x16x32_bf16 v[156:159], a[44:47], v[204:207], v[156:159]
    s_waitcnt lgkmcnt(3)
    ds_read_b128 v[204:207], v223 offset:256
    v_add_u32 v14, s7, v45
    v_mfma_f32_16x16x32_bf16 v[144:147], a[44:47], v[200:203], v[144:147]
    ds_read_b128 v[200:203], v0 offset:16384
    v_mov_b32 v45, 16
    v_mfma_f32_16x16x32_bf16 v[172:175], a[36:39], v[108:111], v[172:175]
    v_cndmask_b32 v45, 0, v45, vcc
    v_or_b32 v11, v11, v45
    v_mfma_f32_16x16x32_bf16 v[176:179], a[40:43], v[108:111], v[176:179]
    s_waitcnt lgkmcnt(2)
    buffer_load_dwordx4 v214, s[24:27], s74 offen lds
    v_mfma_f32_16x16x32_bf16 v[180:183], a[44:47], v[108:111], v[180:183]
    s_add_u32 m0, s48, 36864
    s_waitcnt vmcnt(12)
    ds_read_b64_tr_b16 a[48:49], v221 offset:49152
    v_mfma_f32_16x16x32_bf16 v[160:163], a[36:39], v[208:211], v[160:163]
    ds_read_b64_tr_b16 a[50:51], v221 offset:50688
    ds_read_b64_tr_b16 a[52:53], v221 offset:49184
    v_mfma_f32_16x16x32_bf16 v[164:167], a[40:43], v[208:211], v[164:167]
    ds_read_b64_tr_b16 a[54:55], v221 offset:50720
    ds_read_b64_tr_b16 a[56:57], v221 offset:49216
    v_mfma_f32_16x16x32_bf16 v[168:171], a[44:47], v[208:211], v[168:171]
    buffer_load_dwordx4 v212, s[24:27], s75 offen lds
    s_add_u32 m0, s48, 37888
    ds_read_b64_tr_b16 a[58:59], v221 offset:50752
    s_mov_b32 s74, 147456
    ds_read_b128 v[108:111], v1 offset:10240
    ds_read_b128 v[208:211], v1 offset:4096
    v_lshrrev_b32 v48, 2, v51
    v_lshrrev_b32 v45, 2, v50
    s_waitcnt lgkmcnt(6)
    v_mfma_f32_16x16x32_bf16 v[136:139], a[48:51], v[112:115], v[136:139]
    v_lshl_add_u32 v49, v45, 1, v48
    v_cmp_eq_u32 vcc, v49, v122
    v_mfma_f32_16x16x32_bf16 v[148:151], a[48:51], v[116:119], v[148:151]
    s_waitcnt lgkmcnt(3)
    v_mov_b32 v45, 0x3f803f80
    v_xor_b32 v53, v49, v122
    v_mfma_f32_16x16x32_bf16 v[140:143], a[52:55], v[112:115], v[140:143]
    buffer_load_dwordx4 v213, s[24:27], s75 offen lds
    v_mfma_f32_16x16x32_bf16 v[152:155], a[52:55], v[116:119], v[152:155]
    s_waitcnt lgkmcnt(2)
    s_add_u32 m0, s48, 38912
    v_cndmask_b32 v16, 0, v45, vcc
    v_and_b32 v40, s72, v53
    v_mfma_f32_16x16x32_bf16 v[144:147], a[56:59], v[112:115], v[144:147]
    ds_read_b128 v[112:115], v1 offset:16384
    v_cmp_ne_u32 vcc, 0, v40
    v_mfma_f32_16x16x32_bf16 v[156:159], a[56:59], v[116:119], v[156:159]
    ds_read_b128 v[116:119], v223 offset:320
    v_mov_b32 v45, 0xbe8ac310
    v_mfma_f32_16x16x32_bf16 v[160:163], a[48:51], v[200:203], v[160:163]
    v_and_b32 v40, s73, v53
    v_cndmask_b32 v46, 0, v45, vcc
    v_mfma_f32_16x16x32_bf16 v[172:175], a[48:51], v[204:207], v[172:175]
    buffer_load_dwordx4 v214, s[24:27], s75 offen lds
    s_add_u32 m0, s48, 49152
    v_mfma_f32_16x16x32_bf16 v[164:167], a[52:55], v[200:203], v[164:167]
    s_waitcnt vmcnt(12)
    ds_read_b64_tr_b16 a[60:61], v221 offset:61440
    ds_read_b64_tr_b16 a[62:63], v221 offset:62976
    v_mfma_f32_16x16x32_bf16 v[176:179], a[52:55], v[204:207], v[176:179]
    ds_read_b64_tr_b16 a[64:65], v221 offset:61472
    ds_read_b64_tr_b16 a[66:67], v221 offset:63008
    v_mfma_f32_16x16x32_bf16 v[168:171], a[56:59], v[200:203], v[168:171]
    ds_read_b64_tr_b16 a[68:69], v221 offset:61504
    ds_read_b64_tr_b16 a[70:71], v221 offset:63040
    v_mfma_f32_16x16x32_bf16 v[180:183], a[56:59], v[204:207], v[180:183]
    buffer_load_dwordx4 v212, s[24:27], s74 offen lds
    s_add_u32 m0, s48, 50176
    s_mov_b32 s75, 184320
    ds_read_b128 v[200:203], v0
    ds_read_b128 v[204:207], v0 offset:6144
    v_cmp_ne_u32 vcc, 0, v40
    v_mov_b32 v45, 0x80
    s_waitcnt lgkmcnt(6)
    v_mfma_f32_16x16x32_bf16 v[148:151], a[60:63], v[108:111], v[148:151]
    v_mov_b32 v49, 3
    v_cndmask_b32 v45, 0, v45, vcc
    v_mfma_f32_16x16x32_bf16 v[160:163], a[60:63], v[112:115], v[160:163]
    s_waitcnt lgkmcnt(3)
    v_cmp_eq_u32 vcc, v49, v122
    v_or_b32 v11, v11, v45
    v_mfma_f32_16x16x32_bf16 v[172:175], a[60:63], v[116:119], v[172:175]
    s_waitcnt lgkmcnt(2)
    v_cvt_pk_bf16_f32 v32, v148, v149
    v_cvt_pk_bf16_f32 v33, v150, v151
    v_mfma_f32_16x16x32_bf16 v[152:155], a[64:67], v[108:111], v[152:155]
    buffer_load_dwordx4 v213, s[24:27], s74 offen lds
    s_add_u32 m0, s48, 51200
    v_mfma_f32_16x16x32_bf16 v[164:167], a[64:67], v[112:115], v[164:167]
    v_xor_b32 v53, v49, v122
    v_mov_b32 v45, 0x3f803f80
    v_mfma_f32_16x16x32_bf16 v[176:179], a[64:67], v[116:119], v[176:179]
    v_and_b32 v40, s72, v53
    v_cndmask_b32 v78, 0, v45, vcc
    v_mfma_f32_16x16x32_bf16 v[156:159], a[68:71], v[108:111], v[156:159]
    ds_read_b128 v[108:111], v223
    v_cvt_pk_bf16_f32 v34, v152, v153
    v_mfma_f32_16x16x32_bf16 v[168:171], a[68:71], v[112:115], v[168:171]
    buffer_load_dwordx4 v214, s[24:27], s74 offen lds
    v_mfma_f32_16x16x32_bf16 v[180:183], a[68:71], v[116:119], v[180:183]
    s_add_u32 m0, s48, 61440
    s_waitcnt vmcnt(12)
    ds_read_b64_tr_b16 a[144:145], v221
    v_mfma_f32_16x16x32_bf16 v[136:139], a[60:63], v[208:211], v[136:139]
    ds_read_b64_tr_b16 a[146:147], v221 offset:1536
    ds_read_b64_tr_b16 a[148:149], v221 offset:32
    v_mfma_f32_16x16x32_bf16 v[140:143], a[64:67], v[208:211], v[140:143]
    ds_read_b64_tr_b16 a[150:151], v221 offset:1568
    ds_read_b64_tr_b16 a[152:153], v221 offset:64
    v_mfma_f32_16x16x32_bf16 v[144:147], a[68:71], v[208:211], v[144:147]
    buffer_load_dwordx4 v212, s[24:27], s75 offen lds
    s_add_u32 m0, s48, 62464
    ds_read_b64_tr_b16 a[154:155], v221 offset:1600
    s_mov_b32 s74, 768
    ds_read_b128 v[112:115], v1
    ds_read_b128 v[116:119], v1 offset:6144
    ds_read_b128 v[208:211], v0 offset:12288
    v_cvt_pk_bf16_f32 v35, v154, v155
    s_waitcnt lgkmcnt(7)
    v_mfma_f32_16x16x32_bf16 v[148:151], a[144:147], v[204:207], 0
    v_cvt_pk_bf16_f32 v36, v156, v157
    v_cvt_pk_bf16_f32 v37, v158, v159
    s_waitcnt lgkmcnt(5)
    v_mfma_f32_16x16x32_bf16 v[152:155], a[148:151], v[204:207], 0
    buffer_load_dwordx4 v213, s[24:27], s75 offen lds
    s_add_u32 m0, s48, 63488
    s_waitcnt lgkmcnt(3)
    v_mfma_f32_16x16x32_bf16 v[156:159], a[152:155], v[204:207], 0
    v_cvt_pk_bf16_f32 v24, v136, v137
    v_cvt_pk_bf16_f32 v25, v138, v139
    v_mfma_f32_16x16x32_bf16 v[136:139], a[144:147], v[200:203], 0
    v_cvt_pk_bf16_f32 v26, v140, v141
    v_cvt_pk_bf16_f32 v27, v142, v143
    v_mfma_f32_16x16x32_bf16 v[140:143], a[148:151], v[200:203], 0
    v_cvt_pk_bf16_f32 v28, v144, v145
    v_cvt_pk_bf16_f32 v29, v146, v147
    v_mfma_f32_16x16x32_bf16 v[144:147], a[152:155], v[200:203], 0
    s_waitcnt vmcnt(11)
    ds_read_b64_tr_b16 a[156:157], v221 offset:12288
    buffer_load_dwordx4 v214, s[24:27], s75 offen lds
    s_add_u32 m0, s48, 0
    ds_read_b64_tr_b16 a[158:159], v221 offset:13824
    buffer_load_dwordx4 v212, s[24:27], s74 offen lds
    s_add_u32 m0, s48, 1024
    s_waitcnt lgkmcnt(0)
    v_mfma_f32_16x16x32_bf16 v[136:139], a[156:159], v[112:115], v[136:139]
    ds_read_b64_tr_b16 a[160:161], v221 offset:12320
    ds_read_b64_tr_b16 a[162:163], v221 offset:13856
    v_mfma_f32_16x16x32_bf16 v[148:151], a[156:159], v[116:119], v[148:151]
    buffer_load_dwordx4 v213, s[24:27], s74 offen lds
    s_add_u32 m0, s48, 2048
    ds_read_b64_tr_b16 a[164:165], v221 offset:12352
    ds_read_b64_tr_b16 a[166:167], v221 offset:13888
    s_mov_b32 s75, 37632
    v_cmp_ne_u32 vcc, 0, v40
    v_and_b32 v40, s73, v53
    s_waitcnt lgkmcnt(2)
    v_mfma_f32_16x16x32_bf16 v[140:143], a[160:163], v[112:115], v[140:143]
    v_cvt_pk_bf16_f32 v48, v172, v173
    v_cvt_pk_bf16_f32 v49, v174, v175
    v_mfma_f32_16x16x32_bf16 v[152:155], a[160:163], v[116:119], v[152:155]
    v_cvt_pk_bf16_f32 v50, v176, v177
    v_cvt_pk_bf16_f32 v51, v178, v179
    v_mfma_f32_16x16x32_bf16 v[172:175], a[144:147], v[108:111], 0
    s_waitcnt vmcnt(11)
    ds_read_b64_tr_b16 a[168:169], v221 offset:24576
    v_mfma_f32_16x16x32_bf16 v[176:179], a[148:151], v[108:111], 0
    buffer_load_dwordx4 v214, s[24:27], s74 offen lds
    s_add_u32 m0, s48, 12288
    s_waitcnt lgkmcnt(1)
    v_mfma_f32_16x16x32_bf16 v[144:147], a[164:167], v[112:115], v[144:147]
    ds_read_b64_tr_b16 a[170:171], v221 offset:26112
    ds_read_b64_tr_b16 a[172:173], v221 offset:24608
    v_mfma_f32_16x16x32_bf16 v[156:159], a[164:167], v[116:119], v[156:159]
    ds_read_b64_tr_b16 a[174:175], v221 offset:26144
    ds_read_b64_tr_b16 a[176:177], v221 offset:24640
    ds_read_b64_tr_b16 a[178:179], v221 offset:26176
    s_mov_b32 s74, 74496
    v_mov_b32 v45, 0xbe8ac310
    buffer_load_dwordx4 v212, s[24:27], s75 offen lds
    s_add_u32 m0, s48, 13312
    v_cvt_pk_bf16_f32 v52, v180, v181
    v_cvt_pk_bf16_f32 v53, v182, v183
    v_mfma_f32_16x16x32_bf16 v[180:183], a[152:155], v[108:111], 0
    ds_read_b128 v[204:207], v223 offset:64
    buffer_load_dwordx4 v213, s[24:27], s75 offen lds
    s_add_u32 m0, s48, 14336
    ds_read_b128 v[200:203], v1 offset:12288
    v_cndmask_b32 v54, 0, v45, vcc
    v_cmp_ne_u32 vcc, 0, v40
    v_mov_b32 v45, 0x100
    s_mul_i32 s6, s63, 96
    v_cndmask_b32 v45, 0, v45, vcc
    s_waitcnt lgkmcnt(1)
    v_mfma_f32_16x16x32_bf16 v[172:175], a[156:159], v[204:207], v[172:175]
    ds_read_b128 v[112:115], v0 offset:14336
    ds_read_b128 v[116:119], v223 offset:128
    v_mfma_f32_16x16x32_bf16 v[176:179], a[160:163], v[204:207], v[176:179]
    ds_read_b128 v[108:111], v0 offset:8192
    v_or_b32 v11, v11, v45
    v_mfma_f32_16x16x32_bf16 v[180:183], a[164:167], v[204:207], v[180:183]
    buffer_load_dwordx4 v214, s[24:27], s75 offen lds
    s_waitcnt vmcnt(12)
    ds_read_b64_tr_b16 a[180:181], v221 offset:36864
    ds_read_b64_tr_b16 a[182:183], v221 offset:38400
    ds_read_b64_tr_b16 a[184:185], v221 offset:36896
    ds_read_b64_tr_b16 a[186:187], v221 offset:38432
    ds_read_b64_tr_b16 a[188:189], v221 offset:36928
    ds_read_b64_tr_b16 a[190:191], v221 offset:38464
    s_add_u32 m0, s45, 18432
    s_mov_b32 s75, 111360
    s_sub_u32 s6, 64, s6
    v_lshlrev_b32 v45, 3, v122
    v_sub_u32 v10, s6, v45
    v_cvt_pk_bf16_f32 v41, v162, v163
    v_cvt_pk_bf16_f32 v42, v164, v165
    v_cvt_pk_bf16_f32 v43, v166, v167
    v_mfma_f32_16x16x32_bf16 v[164:167], a[148:151], v[208:211], 0
    s_waitcnt lgkmcnt(7)
    buffer_load_dwordx4 v8, s[20:23], s53 offen nt lds
    s_add_u32 m0, s48, 24576
    v_mfma_f32_16x16x32_bf16 v[164:167], a[160:163], v[200:203], v[164:167]
    s_waitcnt lgkmcnt(5)
    v_cvt_pk_bf16_f32 v44, v168, v169
    v_cvt_pk_bf16_f32 v40, v160, v161
    v_mfma_f32_16x16x32_bf16 v[160:163], a[144:147], v[208:211], 0
    v_cvt_pk_bf16_f32 v45, v170, v171
    v_lshrrev_b32 v19, 4, v2
    v_mfma_f32_16x16x32_bf16 v[168:171], a[152:155], v[208:211], 0
    ds_read_b128 v[208:211], v0 offset:2048
    ds_read_b128 v[204:207], v1 offset:8192
    v_mfma_f32_16x16x32_bf16 v[160:163], a[156:159], v[200:203], v[160:163]
    v_subrev_u32 v19, 0x1500, v19
    v_lshrrev_b32 v7, 4, v19
    v_mfma_f32_16x16x32_bf16 v[168:171], a[164:167], v[200:203], v[168:171]
    buffer_load_dwordx4 v212, s[24:27], s74 offen lds
    s_add_u32 m0, s48, 25600
    v_mfma_f32_16x16x32_bf16 v[172:175], a[168:171], v[116:119], v[172:175]
    ds_read_b128 v[200:203], v1 offset:2048
    v_cmp_eq_u32 vcc, 0, v7
    v_mfma_f32_16x16x32_bf16 v[176:179], a[172:175], v[116:119], v[176:179]
    v_and_b32 v19, 15, v19
    v_mov_b32 v7, 16
    v_mfma_f32_16x16x32_bf16 v[148:151], a[168:171], v[108:111], v[148:151]
    v_cndmask_b32 v19, v7, v19, vcc
    v_lshlrev_b32 v19, 2, v19
    v_mfma_f32_16x16x32_bf16 v[152:155], a[172:175], v[108:111], v[152:155]
    s_waitcnt lgkmcnt(2)
    v_add_u32 v7, s49, v19
    s_mov_b32 s43, 0x3e553b95
    v_mfma_f32_16x16x32_bf16 v[156:159], a[176:179], v[108:111], v[156:159]
    s_waitcnt lgkmcnt(1)
    buffer_load_dwordx4 v213, s[24:27], s74 offen lds
    s_add_u32 m0, s48, 26624
    v_mfma_f32_16x16x32_bf16 v[180:183], a[176:179], v[116:119], v[180:183]
    s_waitcnt vmcnt(12)
    ds_read_b64_tr_b16 a[192:193], v221 offset:49152
    ds_read_b64_tr_b16 a[194:195], v221 offset:50688
    v_mfma_f32_16x16x32_bf16 v[164:167], a[172:175], v[112:115], v[164:167]
    ds_read_b64_tr_b16 a[196:197], v221 offset:49184
    ds_read_b64_tr_b16 a[198:199], v221 offset:50720
    v_mfma_f32_16x16x32_bf16 v[160:163], a[168:171], v[112:115], v[160:163]
    ds_read_b64_tr_b16 a[200:201], v221 offset:49216
    ds_read_b64_tr_b16 a[202:203], v221 offset:50752
    v_mfma_f32_16x16x32_bf16 v[168:171], a[176:179], v[112:115], v[168:171]
    ds_read_b128 v[108:111], v223 offset:192
    ds_read_b128 v[116:119], v0 offset:10240
    v_mfma_f32_16x16x32_bf16 v[136:139], a[168:171], v[208:211], v[136:139]
    s_waitcnt lgkmcnt(8)
    buffer_load_dwordx4 v214, s[24:27], s74 offen lds
    s_add_u32 m0, s45, 20352
    v_mfma_f32_16x16x32_bf16 v[140:143], a[172:175], v[208:211], v[140:143]
    s_mov_b32 s74, 148224
    ds_read_b128 v[112:115], v0 offset:4096
    ds_read_b128 v[104:107], v5
    v_mfma_f32_16x16x32_bf16 v[144:147], a[176:179], v[208:211], v[144:147]
    ds_read_b128 v[208:211], v1 offset:14336
    v_mov_b32 v31, 0
    v_mfma_f32_16x16x32_bf16 v[148:151], a[180:183], v[204:207], v[148:151]
    ds_read_b128 v[184:187], v223
    v_mov_b32 v39, 0
    v_mfma_f32_16x16x32_bf16 v[152:155], a[184:187], v[204:207], v[152:155]
    buffer_load_dwordx4 v8, s[20:23], s53 offen offset:128 nt lds
    v_mfma_f32_16x16x32_bf16 v[156:159], a[188:191], v[204:207], v[156:159]
    s_waitcnt lgkmcnt(5)
    s_add_u32 m0, s48, 36864
    ds_read_b128 v[204:207], v223 offset:256
    v_mov_b32 v47, 0
    v_mfma_f32_16x16x32_bf16 v[136:139], a[180:183], v[200:203], v[136:139]
    s_waitcnt lgkmcnt(5)
    v_mov_b32 v55, 0
    v_mov_b32 v63, 0
    v_mfma_f32_16x16x32_bf16 v[140:143], a[184:187], v[200:203], v[140:143]
    s_waitcnt lgkmcnt(4)
    v_mov_b32 v62, v15
    s_lshl_b32 s3, s63, 6
    v_mfma_f32_16x16x32_bf16 v[144:147], a[188:191], v[200:203], v[144:147]
    ds_read_b128 v[200:203], v0 offset:16384
    ds_read_b128 v[188:191], v1
    v_mfma_f32_16x16x32_bf16 v[172:175], a[180:183], v[108:111], v[172:175]
    s_waitcnt lgkmcnt(4)
    buffer_load_dwordx4 v212, s[24:27], s75 offen lds
    v_mfma_f32_16x16x32_bf16 v[176:179], a[184:187], v[108:111], v[176:179]
    s_add_u32 m0, s48, 37888
    s_waitcnt vmcnt(12)
    ds_read_b64_tr_b16 a[204:205], v221 offset:61440
    v_mfma_f32_16x16x32_bf16 v[180:183], a[188:191], v[108:111], v[180:183]
    s_waitcnt lgkmcnt(3)
    ds_read_b64_tr_b16 a[206:207], v221 offset:62976
    ds_read_b64_tr_b16 a[208:209], v221 offset:61472
    v_mfma_f32_16x16x32_bf16 v[148:151], a[192:195], v[116:119], v[148:151]
    ds_read_b64_tr_b16 a[210:211], v221 offset:63008
    ds_read_b64_tr_b16 a[212:213], v221 offset:61504
    v_mfma_f32_16x16x32_bf16 v[152:155], a[196:199], v[116:119], v[152:155]
    ds_read_b64_tr_b16 a[214:215], v221 offset:63040
    ds_read_b128 v[108:111], v1 offset:10240
    v_mfma_f32_16x16x32_bf16 v[156:159], a[200:203], v[116:119], v[156:159]
    buffer_load_dwordx4 v213, s[24:27], s75 offen lds
    s_add_u32 m0, s48, 38912
    v_mfma_f32_16x16x32_bf16 v[136:139], a[192:195], v[112:115], v[136:139]
    ds_read_b128 v[116:119], v223 offset:320
    ds_read_b128 v[192:195], v1 offset:6144
    v_mfma_f32_16x16x32_bf16 v[140:143], a[196:199], v[112:115], v[140:143]
    s_sub_u32 s3, 64, s3
    ds_read_b128 v[120:123], v5 offset:3072
    v_mov_b32 v20, 0x3f803f80
    v_mfma_f32_16x16x32_bf16 v[144:147], a[200:203], v[112:115], v[144:147]
    ds_read_b128 v[112:115], v1 offset:16384
    v_mov_b32 v21, 0x3f803f80
    v_mfma_f32_16x16x32_bf16 v[160:163], a[180:183], v[208:211], v[160:163]
    s_waitcnt lgkmcnt(5)
    ds_read_b128 v[124:127], v5 offset:4096
    v_mov_b32 v22, 0x3f803f80
    v_mfma_f32_16x16x32_bf16 v[164:167], a[184:187], v[208:211], v[164:167]
    s_waitcnt lgkmcnt(5)
    buffer_load_dwordx4 v214, s[24:27], s75 offen lds
    s_add_u32 m0, s45, 22272
    v_mfma_f32_16x16x32_bf16 v[168:171], a[188:191], v[208:211], v[168:171]
    s_mov_b32 s75, 185088
    ds_read_b128 v[208:211], v1 offset:4096
    ds_read_b128 v[128:131], v5 offset:5120
    v_mfma_f32_16x16x32_bf16 v[172:175], a[192:195], v[204:207], v[172:175]
    s_waitcnt lgkmcnt(6)
    ds_read_b32 v132, v7 offset:9296
    ds_read_b128 v[224:227], v5 offset:6144
    v_mfma_f32_16x16x32_bf16 v[176:179], a[196:199], v[204:207], v[176:179]
    v_mov_b32 v23, 0x3f803f80
    v_mov_b32 v71, 0
    v_mfma_f32_16x16x32_bf16 v[180:183], a[200:203], v[204:207], v[180:183]
    s_waitcnt vmcnt(11)
    ds_read_b64_tr_b16 a[72:73], v221
    v_mfma_f32_16x16x32_bf16 v[160:163], a[192:195], v[200:203], v[160:163]
    s_waitcnt lgkmcnt(6)
    ds_read_b64_tr_b16 a[74:75], v221 offset:1536
    ds_read_b64_tr_b16 a[76:77], v221 offset:32
    v_mfma_f32_16x16x32_bf16 v[164:167], a[196:199], v[200:203], v[164:167]
    ds_read_b64_tr_b16 a[78:79], v221 offset:1568
    ds_read_b64_tr_b16 a[80:81], v221 offset:64
    v_mfma_f32_16x16x32_bf16 v[168:171], a[200:203], v[200:203], v[168:171]
    s_waitcnt lgkmcnt(8)
    ds_read_b64_tr_b16 a[82:83], v221 offset:1600
    buffer_load_dwordx4 v8, s[20:23], s53 offen offset:256 nt lds
    v_mfma_f32_16x16x32_bf16 v[148:151], a[204:207], v[108:111], v[148:151]
    s_add_u32 m0, s48, 49152
    ds_read_b128 v[200:203], v0
    ds_read_b128 v[204:207], v0 offset:6144
    v_mfma_f32_16x16x32_bf16 v[152:155], a[208:211], v[108:111], v[152:155]
    ds_read_b128 v[228:231], v5 offset:7168
    s_lshl_b32 s69, s40, 10
    v_mfma_f32_16x16x32_bf16 v[156:159], a[212:215], v[108:111], v[156:159]
    ds_read_b128 v[108:111], v5 offset:1024
    v_mul_f32 v148, s43, v148
    v_mfma_f32_16x16x32_bf16 v[172:175], a[204:207], v[116:119], v[172:175]
    buffer_load_dwordx4 v212, s[24:27], s74 offen lds
    s_add_u32 m0, s48, 50176
    v_mfma_f32_16x16x32_bf16 v[176:179], a[208:211], v[116:119], v[176:179]
    v_mul_f32 v149, s43, v149
    v_mul_f32 v150, s43, v150
    v_mfma_f32_16x16x32_bf16 v[180:183], a[212:215], v[116:119], v[180:183]
    ds_read_b32 v116, v7 offset:9216
    v_mul_f32 v151, s43, v151
    v_mfma_f32_16x16x32_bf16 v[160:163], a[204:207], v[112:115], v[160:163]
    v_mul_f32 v152, s43, v152
    v_mul_f32 v153, s43, v153
    v_mfma_f32_16x16x32_bf16 v[164:167], a[208:211], v[112:115], v[164:167]
    v_mul_f32 v154, s43, v154
    v_mul_f32 v155, s43, v155
    v_mfma_f32_16x16x32_bf16 v[168:171], a[212:215], v[112:115], v[168:171]
    buffer_load_dwordx4 v213, s[24:27], s74 offen lds
    s_add_u32 m0, s48, 51200
    v_mfma_f32_16x16x32_bf16 v[136:139], a[204:207], v[208:211], v[136:139]
    ds_read_b128 v[112:115], v5 offset:2048
    v_mul_f32 v156, s43, v156
    v_mfma_f32_16x16x32_bf16 v[140:143], a[208:211], v[208:211], v[140:143]
    v_mul_f32 v157, s43, v157
    v_mul_f32 v158, s43, v158
    v_mfma_f32_16x16x32_bf16 v[144:147], a[212:215], v[208:211], v[144:147]
    s_waitcnt vmcnt(11)
    ds_read_b64_tr_b16 a[84:85], v221 offset:12288
    ds_read_b64_tr_b16 a[86:87], v221 offset:13824
    ds_read_b64_tr_b16 a[88:89], v221 offset:12320
    buffer_load_dwordx4 v214, s[24:27], s74 offen lds
    ds_read_b64_tr_b16 a[90:91], v221 offset:13856
    ds_read_b64_tr_b16 a[92:93], v221 offset:12352
    ds_read_b64_tr_b16 a[94:95], v221 offset:13888
    s_add_u32 m0, s46, 18432
    s_mov_b32 s74, 0
    ds_read_b128 v[208:211], v0 offset:12288
    v_mul_f32 v136, s43, v136
    v_mul_f32 v137, s43, v137
    v_mul_f32 v138, s43, v138
    v_mul_f32 v139, s43, v139
    v_mul_f32 v140, s43, v140
    v_mul_f32 v141, s43, v141
    v_mul_f32 v142, s43, v142
    v_mul_f32 v143, s43, v143
    v_cvt_pk_bf16_f32 v56, v136, v137
    v_cvt_pk_bf16_f32 v57, v138, v139
    s_waitcnt lgkmcnt(12)
    v_mfma_f32_16x16x32_bf16 v[136:139], v[200:203], a[72:75], 0
    s_waitcnt lgkmcnt(3)
    buffer_load_dwordx4 v9, s[20:23], s57 offen nt lds
    s_add_u32 m0, s48, 61440
    v_mfma_f32_16x16x32_bf16 v[136:139], v[188:191], a[84:87], v[136:139]
    v_cvt_pk_bf16_f32 v58, v140, v141
    v_cvt_pk_bf16_f32 v59, v142, v143
    v_mfma_f32_16x16x32_bf16 v[140:143], v[200:203], a[76:79], 0
    v_mul_f32 v144, s43, v144
    v_mul_f32 v145, s43, v145
    v_mfma_f32_16x16x32_bf16 v[104:107], v[24:27], v[56:59], v[104:107]
    v_mul_f32 v146, s43, v146
    v_mul_f32 v147, s43, v147
    v_mfma_f32_16x16x32_bf16 v[108:111], v[32:35], v[56:59], v[108:111]
    v_cvt_pk_bf16_f32 v60, v144, v145
    v_cvt_pk_bf16_f32 v61, v146, v147
    v_mfma_f32_16x16x32_bf16 v[112:115], v[40:43], v[56:59], v[112:115]
    v_mul_f32 v159, s43, v159
    v_cvt_pk_bf16_f32 v64, v148, v149
    v_mfma_f32_16x16x32_bf16 v[116:119], v[48:51], v[56:59], v[116:119]
    v_cvt_pk_bf16_f32 v65, v150, v151
    v_cvt_pk_bf16_f32 v66, v152, v153
    v_mfma_f32_16x16x32_bf16 v[104:107], v[28:31], v[60:63], v[104:107]
    v_cvt_pk_bf16_f32 v67, v154, v155
    v_cvt_pk_bf16_f32 v68, v156, v157
    v_mfma_f32_16x16x32_bf16 v[108:111], v[36:39], v[60:63], v[108:111]
    v_cvt_pk_bf16_f32 v69, v158, v159
    v_mul_f32 v160, s43, v160
    v_mfma_f32_16x16x32_bf16 v[112:115], v[44:47], v[60:63], v[112:115]
    v_mul_f32 v161, s43, v161
    v_mul_f32 v162, s43, v162
    v_mfma_f32_16x16x32_bf16 v[116:119], v[52:55], v[60:63], v[116:119]
    buffer_load_dwordx4 v212, s[24:27], s75 offen lds
    s_add_u32 m0, s48, 62464
    v_mfma_f32_16x16x32_bf16 v[144:147], v[200:203], a[80:83], 0
    s_waitcnt lgkmcnt(0)
    ds_read_b128 v[200:203], v1 offset:12288
    v_mul_f32 v163, s43, v163
    v_mfma_f32_16x16x32_bf16 v[148:151], v[204:207], a[72:75], 0
    v_mul_f32 v164, s43, v164
    v_mul_f32 v165, s43, v165
    v_mfma_f32_16x16x32_bf16 v[152:155], v[204:207], a[76:79], 0
    v_mul_f32 v166, s43, v166
    v_mul_f32 v167, s43, v167
    v_mfma_f32_16x16x32_bf16 v[156:159], v[204:207], a[80:83], 0
    buffer_load_dwordx4 v213, s[24:27], s75 offen lds
    v_mfma_f32_16x16x32_bf16 v[140:143], v[188:191], a[88:91], v[140:143]
    s_add_u32 m0, s48, 63488
    v_mul_f32 v168, s43, v168
    v_mul_f32 v169, s43, v169
    v_mfma_f32_16x16x32_bf16 v[144:147], v[188:191], a[92:95], v[144:147]
    v_mul_f32 v170, s43, v170
    v_mul_f32 v171, s43, v171
    v_mfma_f32_16x16x32_bf16 v[148:151], v[192:195], a[84:87], v[148:151]
    v_cvt_pk_bf16_f32 v56, v160, v161
    v_cvt_pk_bf16_f32 v57, v162, v163
    v_mfma_f32_16x16x32_bf16 v[160:163], v[208:211], a[72:75], 0
    s_waitcnt lgkmcnt(0)
    v_cvt_pk_bf16_f32 v58, v164, v165
    v_cvt_pk_bf16_f32 v59, v166, v167
    v_mfma_f32_16x16x32_bf16 v[164:167], v[208:211], a[76:79], 0
    buffer_load_dwordx4 v214, s[24:27], s75 offen lds
    s_add_u32 m0, s47, 18432
    v_mfma_f32_16x16x32_bf16 v[160:163], v[200:203], a[84:87], v[160:163]
    s_mov_b32 s75, 18432
    v_cvt_pk_bf16_f32 v60, v168, v169
    v_cvt_pk_bf16_f32 v61, v170, v171
    v_mfma_f32_16x16x32_bf16 v[168:171], v[208:211], a[80:83], 0
    ds_read_b128 v[204:207], v223 offset:64
    ds_read_b128 v[208:211], v0 offset:2048
    v_mfma_f32_16x16x32_bf16 v[164:167], v[200:203], a[88:91], v[164:167]
    v_mul_f32 v172, s43, v172
    v_mul_f32 v173, s43, v173
    v_mfma_f32_16x16x32_bf16 v[168:171], v[200:203], a[92:95], v[168:171]
    v_mul_f32 v174, s43, v174
    v_mul_f32 v175, s43, v175
    v_mfma_f32_16x16x32_bf16 v[152:155], v[192:195], a[88:91], v[152:155]
    s_waitcnt vmcnt(12)
    ds_read_b64_tr_b16 a[96:97], v221 offset:24576
    ds_read_b64_tr_b16 a[98:99], v221 offset:26112
    v_mfma_f32_16x16x32_bf16 v[156:159], v[192:195], a[92:95], v[156:159]
    ds_read_b64_tr_b16 a[100:101], v221 offset:24608
    ds_read_b64_tr_b16 a[102:103], v221 offset:26144
    v_mfma_f32_16x16x32_bf16 v[120:123], v[24:27], v[64:67], v[120:123]
    ds_read_b64_tr_b16 a[104:105], v221 offset:24640
    ds_read_b64_tr_b16 a[106:107], v221 offset:26176
    v_mfma_f32_16x16x32_bf16 v[124:127], v[32:35], v[64:67], v[124:127]
    s_mov_b64 exec, s[50:51]
    buffer_load_dwordx4 v9, s[20:23], s53 offen offset:128 nt lds
    s_mov_b64 exec, -1
    v_mfma_f32_16x16x32_bf16 v[128:131], v[40:43], v[64:67], v[128:131]
    s_add_u32 m0, s48, 24576
    v_mul_f32 v176, s43, v176
    v_mul_f32 v177, s43, v177
    v_mfma_f32_16x16x32_bf16 v[120:123], v[28:31], v[68:71], v[120:123]
    s_waitcnt lgkmcnt(4)
    v_mul_f32 v178, s43, v178
    v_mul_f32 v179, s43, v179
    v_mfma_f32_16x16x32_bf16 v[136:139], v[208:211], a[96:99], v[136:139]
    v_mul_f32 v180, s43, v180
    v_mul_f32 v181, s43, v181
    s_waitcnt lgkmcnt(2)
    v_mfma_f32_16x16x32_bf16 v[140:143], v[208:211], a[100:103], v[140:143]
    s_waitcnt lgkmcnt(0)
    buffer_load_dwordx4 v215, s[28:31], s74 offen lds
    v_mfma_f32_16x16x32_bf16 v[144:147], v[208:211], a[104:107], v[144:147]
    s_add_u32 m0, s48, 25600
    v_mul_f32 v182, s43, v182
    v_mul_f32 v183, s43, v183
    v_mfma_f32_16x16x32_bf16 v[132:135], v[48:51], v[64:67], v[132:135]
    v_cvt_pk_bf16_f32 v72, v172, v173
    v_cvt_pk_bf16_f32 v73, v174, v175
    v_mfma_f32_16x16x32_bf16 v[172:175], v[184:187], a[72:75], 0
    v_cvt_pk_bf16_f32 v74, v176, v177
    v_cvt_pk_bf16_f32 v75, v178, v179
    v_mfma_f32_16x16x32_bf16 v[176:179], v[184:187], a[76:79], 0
    buffer_load_dwordx4 v216, s[28:31], s74 offen lds
    s_add_u32 m0, s48, 26624
    v_mfma_f32_16x16x32_bf16 v[172:175], v[204:207], a[84:87], v[172:175]
    v_cvt_pk_bf16_f32 v76, v180, v181
    v_cvt_pk_bf16_f32 v77, v182, v183
    v_mfma_f32_16x16x32_bf16 v[180:183], v[184:187], a[80:83], 0
    ds_read_b128 v[184:187], v0 offset:8192
    ds_read_b128 v[200:203], v1 offset:2048
    v_mfma_f32_16x16x32_bf16 v[176:179], v[204:207], a[88:91], v[176:179]
    ds_read_b128 v[188:191], v0 offset:14336
    v_add_u32 v212, s3, v221
    v_mfma_f32_16x16x32_bf16 v[180:183], v[204:207], a[92:95], v[180:183]
    ds_read_b128 v[204:207], v1 offset:8192
    v_mov_b32 v18, 1.0
    v_mfma_f32_16x16x32_bf16 v[124:127], v[36:39], v[68:71], v[124:127]
    buffer_load_dwordx4 v217, s[28:31], s74 offen lds
    s_add_u32 m0, s48, 36864
    v_mfma_f32_16x16x32_bf16 v[128:131], v[44:47], v[68:71], v[128:131]
    ds_read_b128 v[208:211], v1 offset:14336
    ds_read_b128 v[192:195], v223 offset:128
    v_mfma_f32_16x16x32_bf16 v[132:135], v[52:55], v[68:71], v[132:135]
    s_mov_b32 s74, 36864
    ds_read_b128 v[232:235], v5 offset:8192
    v_add_u32 v3, s69, v2
    s_waitcnt lgkmcnt(6)
    v_mfma_f32_16x16x32_bf16 v[148:151], v[184:187], a[96:99], v[148:151]
    s_waitcnt vmcnt(12)
    ds_read_b64_tr_b16 a[108:109], v221 offset:36864
    ds_read_b64_tr_b16 a[110:111], v221 offset:38400
    v_mfma_f32_16x16x32_bf16 v[152:155], v[184:187], a[100:103], v[152:155]
    ds_read_b64_tr_b16 a[112:113], v221 offset:36896
    ds_read_b64_tr_b16 a[114:115], v221 offset:38432
    v_mfma_f32_16x16x32_bf16 v[156:159], v[184:187], a[104:107], v[156:159]
    s_waitcnt lgkmcnt(8)
    ds_read_b64_tr_b16 a[116:117], v221 offset:36928
    ds_read_b64_tr_b16 a[118:119], v221 offset:38464
    v_mfma_f32_16x16x32_bf16 v[160:163], v[188:191], a[96:99], v[160:163]
    ds_read_b128 v[184:187], v223 offset:192
    s_lshl_b32 s70, s63, 3
    v_mfma_f32_16x16x32_bf16 v[164:167], v[188:191], a[100:103], v[164:167]
    v_exp_f32 v104, v104
    v_mfma_f32_16x16x32_bf16 v[168:171], v[188:191], a[104:107], v[168:171]
    s_waitcnt lgkmcnt(8)
    ds_read_b128 v[188:191], v0 offset:4096
    ds_read_b32 v236, v7 offset:9376
    v_mfma_f32_16x16x32_bf16 v[172:175], v[192:195], a[96:99], v[172:175]
    s_waitcnt lgkmcnt(8)
    v_exp_f32 v105, v105
    v_mfma_f32_16x16x32_bf16 v[176:179], v[192:195], a[100:103], v[176:179]
    s_waitcnt lgkmcnt(6)
    v_exp_f32 v106, v106
    v_mfma_f32_16x16x32_bf16 v[136:139], v[200:203], a[108:111], v[136:139]
    s_waitcnt lgkmcnt(5)
    v_exp_f32 v107, v107
    v_mfma_f32_16x16x32_bf16 v[140:143], v[200:203], a[112:115], v[140:143]
    s_waitcnt lgkmcnt(3)
    buffer_load_dwordx4 v215, s[28:31], s75 offen lds
    s_add_u32 m0, s48, 37888
    v_mfma_f32_16x16x32_bf16 v[144:147], v[200:203], a[116:119], v[144:147]
    s_waitcnt lgkmcnt(2)
    ds_read_b128 v[200:203], v0 offset:16384
    v_cvt_pk_bf16_f32 v104, v104, v105
    v_mfma_f32_16x16x32_bf16 v[148:151], v[204:207], a[108:111], v[148:151]
    v_exp_f32 v108, v108
    v_mfma_f32_16x16x32_bf16 v[152:155], v[204:207], a[112:115], v[152:155]
    s_waitcnt lgkmcnt(1)
    v_exp_f32 v109, v109
    v_mfma_f32_16x16x32_bf16 v[156:159], v[204:207], a[116:119], v[156:159]
    buffer_load_dwordx4 v216, s[28:31], s75 offen lds
    s_add_u32 m0, s48, 38912
    v_mfma_f32_16x16x32_bf16 v[160:163], v[208:211], a[108:111], v[160:163]
    ds_read_b128 v[204:207], v223 offset:256
    v_cvt_pk_bf16_f32 v105, v106, v107
    v_mfma_f32_16x16x32_bf16 v[164:167], v[208:211], a[112:115], v[164:167]
    v_exp_f32 v110, v110
    v_mfma_f32_16x16x32_bf16 v[168:171], v[208:211], a[116:119], v[168:171]
    ds_read_b128 v[208:211], v1 offset:4096
    v_cvt_pk_bf16_f32 v106, v108, v109
    v_mfma_f32_16x16x32_bf16 v[180:183], v[192:195], a[104:107], v[180:183]
    ds_read_b128 v[192:195], v0 offset:10240
    s_lshl_b32 s69, s64, 10
    v_mfma_f32_16x16x32_bf16 v[172:175], v[184:187], a[108:111], v[172:175]
    buffer_load_dwordx4 v217, s[28:31], s75 offen lds
    s_add_u32 m0, s48, 49152
    v_mfma_f32_16x16x32_bf16 v[176:179], v[184:187], a[112:115], v[176:179]
    s_mov_b32 s75, 55296
    v_exp_f32 v111, v111
    v_mfma_f32_16x16x32_bf16 v[180:183], v[184:187], a[116:119], v[180:183]
    ds_read_b128 v[184:187], v1 offset:10240
    v_cvt_pk_bf16_f32 v107, v110, v111
    v_mfma_f32_16x16x32_bf16 v[224:227], v[24:27], v[56:59], v[224:227]
    s_waitcnt vmcnt(11)
    ds_read_b64_tr_b16 a[120:121], v221 offset:49152
    v_mfma_f32_16x16x32_bf16 v[228:231], v[32:35], v[56:59], v[228:231]
    ds_read_b64_tr_b16 a[122:123], v221 offset:50688
    ds_read_b64_tr_b16 a[124:125], v221 offset:49184
    v_mfma_f32_16x16x32_bf16 v[232:235], v[40:43], v[56:59], v[232:235]
    ds_read_b64_tr_b16 a[126:127], v221 offset:50720
    ds_read_b64_tr_b16 a[128:129], v221 offset:49216
    v_mfma_f32_16x16x32_bf16 v[196:199], v[20:23], v[104:107], 0
    ds_read_b64_tr_b16 a[130:131], v221 offset:50752
    ds_read_b128 v[108:111], v6 offset:64
    v_mfma_f32_16x16x32_bf16 v[236:239], v[48:51], v[56:59], v[236:239]
    v_exp_f32 v112, v112
    v_exp_f32 v113, v113
    v_exp_f32 v114, v114
    v_cvt_pk_bf16_f32 v112, v112, v113
    s_waitcnt lgkmcnt(5)
    v_mfma_f32_16x16x32_bf16 v[160:163], v[200:203], a[120:123], v[160:163]
    v_exp_f32 v115, v115
    v_mfma_f32_16x16x32_bf16 v[136:139], v[188:191], a[120:123], v[136:139]
    s_waitcnt lgkmcnt(2)
    v_exp_f32 v116, v116
    v_mfma_f32_16x16x32_bf16 v[164:167], v[200:203], a[124:127], v[164:167]
    s_waitcnt lgkmcnt(1)
    buffer_load_dwordx4 v215, s[28:31], s74 offen lds
    s_add_u32 m0, s48, 50176
    v_mfma_f32_16x16x32_bf16 v[168:171], v[200:203], a[128:131], v[168:171]
    s_waitcnt lgkmcnt(0)
    v_cvt_pk_bf16_f32 v113, v114, v115
    v_cvt_pk_bf16_f32 v114, v116, 0
    v_mfma_f32_16x16x32_bf16 v[172:175], v[204:207], a[120:123], v[172:175]
    v_mov_b32 v115, 0
    s_add_u32 s69, s69, s70
    v_mfma_f32_16x16x32_bf16 v[140:143], v[188:191], a[124:127], v[140:143]
    v_exp_f32 v120, v120
    v_mfma_f32_16x16x32_bf16 v[176:179], v[204:207], a[124:127], v[176:179]
    buffer_load_dwordx4 v216, s[28:31], s74 offen lds
    s_add_u32 m0, s48, 51200
    v_mfma_f32_16x16x32_bf16 v[144:147], v[188:191], a[128:131], v[144:147]
    ds_read_b128 v[188:191], v1 offset:16384
    s_add_u32 s69, s69, 4096
    v_mfma_f32_16x16x32_bf16 v[180:183], v[204:207], a[128:131], v[180:183]
    v_exp_f32 v121, v121
    v_mfma_f32_16x16x32_bf16 v[148:151], v[192:195], a[120:123], v[148:151]
    v_exp_f32 v122, v122
    v_mfma_f32_16x16x32_bf16 v[152:155], v[192:195], a[124:127], v[152:155]
    v_exp_f32 v123, v123
    v_mfma_f32_16x16x32_bf16 v[156:159], v[192:195], a[128:131], v[156:159]
    buffer_load_dwordx4 v217, s[28:31], s74 offen lds
    s_add_u32 m0, s48, 61440
    v_mfma_f32_16x16x32_bf16 v[196:199], v[20:23], v[112:115], v[196:199]
    s_waitcnt vmcnt(10)
    ds_read_b64_tr_b16 a[132:133], v221 offset:61440
    ds_read_b64_tr_b16 a[134:135], v221 offset:62976
    v_mfma_f32_16x16x32_bf16 v[108:111], v[32:35], v[72:75], v[108:111]
    ds_read_b64_tr_b16 a[136:137], v221 offset:61472
    ds_read_b64_tr_b16 a[138:139], v221 offset:63008
    ds_read_b64_tr_b16 a[140:141], v221 offset:61504
    ds_read_b64_tr_b16 a[142:143], v221 offset:63040
    s_mov_b32 s74, 12288
    ds_read_b128 v[192:195], v223 offset:320
    v_rcp_f32 v197, v196
    v_exp_f32 v124, v124
    v_exp_f32 v125, v125
    v_exp_f32 v126, v126
    v_exp_f32 v127, v127
    v_cvt_pk_bf16_f32 v120, v120, v121
    v_cvt_pk_bf16_f32 v121, v122, v123
    s_waitcnt lgkmcnt(5)
    v_mfma_f32_16x16x32_bf16 v[136:139], v[208:211], a[132:135], v[136:139]
    v_exp_f32 v128, v128
    s_waitcnt lgkmcnt(3)
    v_mfma_f32_16x16x32_bf16 v[140:143], v[208:211], a[136:139], v[140:143]
    s_waitcnt lgkmcnt(1)
    buffer_load_dwordx4 v215, s[28:31], s75 offen lds
    v_mfma_f32_16x16x32_bf16 v[144:147], v[208:211], a[140:143], v[144:147]
    s_add_u32 m0, s48, 62464
    v_exp_f32 v129, v129
    v_mfma_f32_16x16x32_bf16 v[148:151], v[184:187], a[132:135], v[148:151]
    s_waitcnt lgkmcnt(0)
    v_cvt_pk_bf16_f32 v80, v136, v137
    v_cvt_pk_bf16_f32 v81, v138, v139
    v_mfma_f32_16x16x32_bf16 v[152:155], v[184:187], a[136:139], v[152:155]
    v_cvt_pk_bf16_f32 v88, v140, v141
    v_cvt_pk_bf16_f32 v89, v142, v143
    v_mfma_f32_16x16x32_bf16 v[156:159], v[184:187], a[140:143], v[156:159]
    buffer_load_dwordx4 v216, s[28:31], s75 offen lds
    s_add_u32 m0, s48, 63488
    v_mfma_f32_16x16x32_bf16 v[160:163], v[188:191], a[132:135], v[160:163]
    s_waitcnt vmcnt(11)
    s_barrier
    v_mfma_f32_16x16x32_bf16 v[164:167], v[188:191], a[136:139], v[164:167]
    ds_read_b128 v[200:203], v0 offset:18432
    ds_read_b128 v[204:207], v1 offset:18432
    v_mfma_f32_16x16x32_bf16 v[168:171], v[188:191], a[140:143], v[168:171]
    ds_read_b128 v[208:211], v0 offset:20480
    v_cvt_pk_bf16_f32 v96, v144, v145
    v_mfma_f32_16x16x32_bf16 v[172:175], v[192:195], a[132:135], v[172:175]
    buffer_load_dwordx4 v217, s[28:31], s75 offen lds
    s_add_u32 m0, s48, 24576
    v_mfma_f32_16x16x32_bf16 v[176:179], v[192:195], a[136:139], v[176:179]
    v_cvt_pk_bf16_f32 v97, v146, v147
    v_cvt_pk_bf16_f32 v82, v148, v149
    v_mfma_f32_16x16x32_bf16 v[180:183], v[192:195], a[140:143], v[180:183]
    v_cvt_pk_bf16_f32 v83, v150, v151
    v_cvt_pk_bf16_f32 v90, v152, v153
    v_cvt_pk_bf16_f32 v91, v154, v155
    v_mfma_f32_16x16x32_bf16 v[184:187], v[80:83], v[104:107], 0
    s_waitcnt lgkmcnt(2)
    v_cvt_pk_bf16_f32 v98, v156, v157
    v_cvt_pk_bf16_f32 v99, v158, v159
    v_mfma_f32_16x16x32_bf16 v[136:139], a[0:3], v[200:203], 0
    s_waitcnt lgkmcnt(1)
    s_mov_b32 s75, 49152
    s_barrier
    v_mfma_f32_16x16x32_bf16 v[140:143], a[4:7], v[200:203], 0
    v_cvt_pk_bf16_f32 v84, v160, v161
    v_cvt_pk_bf16_f32 v85, v162, v163
    v_mfma_f32_16x16x32_bf16 v[144:147], a[8:11], v[200:203], 0
    v_cvt_pk_bf16_f32 v92, v164, v165
    v_cvt_pk_bf16_f32 v93, v166, v167
    v_mfma_f32_16x16x32_bf16 v[148:151], v[200:203], a[72:75], 0
    v_cvt_pk_bf16_f32 v100, v168, v169
    v_cvt_pk_bf16_f32 v101, v170, v171
    v_mfma_f32_16x16x32_bf16 v[152:155], v[200:203], a[76:79], 0
    v_cvt_pk_bf16_f32 v86, v172, v173
    v_cvt_pk_bf16_f32 v87, v174, v175
    v_mfma_f32_16x16x32_bf16 v[156:159], v[200:203], a[80:83], 0
    s_waitcnt vmcnt(9)
    ds_read_b64_tr_b16 a[216:217], v222 offset:24576
    ds_read_b64_tr_b16 a[218:219], v222 offset:26112
    v_mfma_f32_16x16x32_bf16 v[136:139], a[12:15], v[204:207], v[136:139]
    s_waitcnt lgkmcnt(2)
    ds_read_b64_tr_b16 a[220:221], v222 offset:24584
    ds_read_b64_tr_b16 a[222:223], v222 offset:26120
    v_mfma_f32_16x16x32_bf16 v[140:143], a[16:19], v[204:207], v[140:143]
    ds_read_b64_tr_b16 a[224:225], v212 offset:24576
    ds_read_b64_tr_b16 a[226:227], v212 offset:26112
    v_mfma_f32_16x16x32_bf16 v[144:147], a[20:23], v[204:207], v[144:147]
    ds_read_b128 v[200:203], v1 offset:20480
    v_cvt_pk_bf16_f32 v94, v176, v177
    v_mfma_f32_16x16x32_bf16 v[148:151], v[204:207], a[84:87], v[148:151]
    v_cvt_pk_bf16_f32 v95, v178, v179
    v_cvt_pk_bf16_f32 v102, v180, v181
    v_mfma_f32_16x16x32_bf16 v[152:155], v[204:207], a[88:91], v[152:155]
    v_cvt_pk_bf16_f32 v103, v182, v183
    v_cvt_pk_bf16_f32 v122, v124, v125
    v_mfma_f32_16x16x32_bf16 v[156:159], v[204:207], a[92:95], v[156:159]
    ds_read_b128 v[204:207], v0 offset:22528
    v_cvt_pk_bf16_f32 v123, v126, v127
    v_mfma_f32_16x16x32_bf16 v[136:139], a[24:27], v[208:211], v[136:139]
    v_exp_f32 v130, v130
    v_mfma_f32_16x16x32_bf16 v[140:143], a[28:31], v[208:211], v[140:143]
    s_waitcnt lgkmcnt(2)
    buffer_load_dwordx4 v218, s[28:31], s74 offen lds
    s_add_u32 m0, s48, 25600
    v_mfma_f32_16x16x32_bf16 v[144:147], a[32:35], v[208:211], v[144:147]
    s_waitcnt lgkmcnt(1)
    v_exp_f32 v131, v131
    v_mfma_f32_16x16x32_bf16 v[148:151], v[208:211], a[96:99], v[148:151]
    v_exp_f32 v132, v132
    v_mfma_f32_16x16x32_bf16 v[152:155], v[208:211], a[100:103], v[152:155]
    v_max3_f32 v18, v18, v196, v197
    v_cvt_pk_bf16_f32 v128, v128, v129
    v_mfma_f32_16x16x32_bf16 v[156:159], v[208:211], a[104:107], v[156:159]
    buffer_load_dwordx4 v219, s[28:31], s74 offen lds
    s_add_u32 m0, s48, 26624
    v_mfma_f32_16x16x32_bf16 v[188:191], v[88:91], v[104:107], 0
    ds_read_b128 v[208:211], v1 offset:22528
    v_cvt_pk_bf16_f32 v129, v130, v131
    v_mfma_f32_16x16x32_bf16 v[192:195], v[96:99], v[104:107], 0
    s_waitcnt vmcnt(8)
    ds_read_b64_tr_b16 a[228:229], v222 offset:36864
    v_mfma_f32_16x16x32_bf16 v[184:187], v[84:87], v[112:115], v[184:187]
    ds_read_b64_tr_b16 a[230:231], v222 offset:38400
    ds_read_b64_tr_b16 a[232:233], v222 offset:36872
    v_mfma_f32_16x16x32_bf16 v[188:191], v[92:95], v[112:115], v[188:191]
    ds_read_b64_tr_b16 a[234:235], v222 offset:38408
    ds_read_b64_tr_b16 a[236:237], v212 offset:36864
    v_mfma_f32_16x16x32_bf16 v[192:195], v[100:103], v[112:115], v[192:195]
    buffer_load_dwordx4 v220, s[28:31], s74 offen lds
    s_add_u32 m0, s48, 36864
    v_mfma_f32_16x16x32_bf16 v[136:139], a[36:39], v[200:203], v[136:139]
    s_waitcnt lgkmcnt(6)
    ds_read_b64_tr_b16 a[238:239], v212 offset:38400
    ds_read_b128 v[104:107], v6
    v_mfma_f32_16x16x32_bf16 v[140:143], a[40:43], v[200:203], v[140:143]
    v_mul_f32 v184, v184, v197
    v_mul_f32 v185, v185, v197
    v_mfma_f32_16x16x32_bf16 v[144:147], a[44:47], v[200:203], v[144:147]
    v_mul_f32 v186, v186, v197
    v_mul_f32 v187, v187, v197
    v_mfma_f32_16x16x32_bf16 v[148:151], v[200:203], a[108:111], v[148:151]
    v_cvt_pk_bf16_f32 v184, v184, v185
    v_mul_f32 v188, v188, v197
    v_mfma_f32_16x16x32_bf16 v[152:155], v[200:203], a[112:115], v[152:155]
    v_mul_f32 v189, v189, v197
    v_mul_f32 v190, v190, v197
    v_mfma_f32_16x16x32_bf16 v[156:159], v[200:203], a[116:119], v[156:159]
    s_waitcnt lgkmcnt(1)
    buffer_load_dwordx4 v218, s[28:31], s75 offen lds
    s_add_u32 m0, s48, 37888
    v_mfma_f32_16x16x32_bf16 v[136:139], a[48:51], v[204:207], v[136:139]
    s_waitcnt lgkmcnt(0)
    ds_read_b128 v[200:203], v0 offset:24576
    v_mul_f32 v191, v191, v197
    v_mfma_f32_16x16x32_bf16 v[140:143], a[52:55], v[204:207], v[140:143]
    v_cvt_pk_bf16_f32 v185, v186, v187
    v_mul_f32 v192, v192, v197
    v_mfma_f32_16x16x32_bf16 v[144:147], a[56:59], v[204:207], v[144:147]
    v_mul_f32 v193, v193, v197
    v_mul_f32 v194, v194, v197
    v_mfma_f32_16x16x32_bf16 v[148:151], v[204:207], a[120:123], v[148:151]
    buffer_load_dwordx4 v219, s[28:31], s75 offen lds
    s_add_u32 m0, s48, 38912
    v_mfma_f32_16x16x32_bf16 v[152:155], v[204:207], a[124:127], v[152:155]
    v_mul_f32 v195, v195, v197
    v_cvt_pk_bf16_f32 v186, v188, v189
    v_mfma_f32_16x16x32_bf16 v[156:159], v[204:207], a[128:131], v[156:159]
    s_waitcnt vmcnt(8)
    ds_read_b64_tr_b16 a[240:241], v222 offset:49152
    ds_read_b64_tr_b16 a[242:243], v222 offset:50688
    v_mfma_f32_16x16x32_bf16 v[104:107], v[24:27], v[72:75], v[104:107]
    s_waitcnt lgkmcnt(2)
    ds_read_b64_tr_b16 a[244:245], v222 offset:49160
    ds_read_b64_tr_b16 a[246:247], v222 offset:50696
    v_mfma_f32_16x16x32_bf16 v[136:139], a[60:63], v[208:211], v[136:139]
    ds_read_b64_tr_b16 a[248:249], v212 offset:49152
    ds_read_b64_tr_b16 a[250:251], v212 offset:50688
    v_mfma_f32_16x16x32_bf16 v[140:143], a[64:67], v[208:211], v[140:143]
    buffer_load_dwordx4 v220, s[28:31], s75 offen lds
    s_add_u32 m0, s45, 0
    v_mfma_f32_16x16x32_bf16 v[144:147], a[68:71], v[208:211], v[144:147]
    ds_read_b128 v[204:207], v1 offset:24576
    v_cvt_pk_bf16_f32 v187, v190, v191
    v_mfma_f32_16x16x32_bf16 v[148:151], v[208:211], a[132:135], v[148:151]
    v_cvt_pk_bf16_f32 v192, v192, v193
    v_mov_b32 v62, v16
    v_mfma_f32_16x16x32_bf16 v[152:155], v[208:211], a[136:139], v[152:155]
    v_add_u32 v4, s69, v2
    v_cvt_pk_bf16_f32 v130, v132, 0
    v_mfma_f32_16x16x32_bf16 v[224:227], v[28:31], v[60:63], v[224:227]
    buffer_load_dwordx4 v8, s[20:23], s54 offen nt lds
    v_mfma_f32_16x16x32_bf16 v[228:231], v[36:39], v[60:63], v[228:231]
    s_add_u32 m0, s45, 1920
    v_mov_b32 v131, 0
    v_cvt_pk_bf16_f32 v193, v194, v195
    v_mfma_f32_16x16x32_bf16 v[232:235], v[44:47], v[60:63], v[232:235]
    v_mov_b32 v79, 0
    v_cvt_pk_bf16_f32 v24, v136, v137
    v_mfma_f32_16x16x32_bf16 v[236:239], v[52:55], v[60:63], v[236:239]
    v_exp_f32 v224, v224
    v_mfma_f32_16x16x32_bf16 v[156:159], v[208:211], a[140:143], v[156:159]
    ds_read_b128 v[208:211], v0 offset:26624
    v_cvt_pk_bf16_f32 v25, v138, v139
    v_mfma_f32_16x16x32_bf16 v[196:199], v[20:23], v[120:123], 0
    buffer_load_dwordx4 v8, s[20:23], s54 offen offset:128 nt lds
    s_add_u32 m0, s45, 3840
    v_mfma_f32_16x16x32_bf16 v[104:107], v[28:31], v[76:79], v[104:107]
    v_exp_f32 v225, v225
    v_mfma_f32_16x16x32_bf16 v[196:199], v[20:23], v[128:131], v[196:199]
    s_waitcnt vmcnt(8)
    ds_read_b64_tr_b16 a[252:253], v222 offset:61440
    ds_read_b64_tr_b16 a[254:255], v222 offset:62976
    v_mfma_f32_16x16x32_bf16 v[188:191], v[88:91], v[120:123], 0
    v_exp_f32 v226, v226
    v_mfma_f32_16x16x32_bf16 v[108:111], v[36:39], v[76:79], v[108:111]
    v_exp_f32 v227, v227
    v_mfma_f32_16x16x32_bf16 v[188:191], v[92:95], v[128:131], v[188:191]
    buffer_load_dwordx4 v8, s[20:23], s54 offen offset:256 nt lds
    s_add_u32 m0, s46, 0
    v_mfma_f32_16x16x32_bf16 v[160:163], a[0:3], v[200:203], 0
    s_waitcnt lgkmcnt(2)
    v_rcp_f32 v197, v196
    v_mfma_f32_16x16x32_bf16 v[164:167], a[4:7], v[200:203], 0
    v_exp_f32 v228, v228
    v_mfma_f32_16x16x32_bf16 v[168:171], a[8:11], v[200:203], 0
    v_exp_f32 v229, v229
    v_mfma_f32_16x16x32_bf16 v[172:175], v[200:203], a[72:75], 0
    v_exp_f32 v230, v230
    v_mfma_f32_16x16x32_bf16 v[176:179], v[200:203], a[76:79], 0
    buffer_load_dwordx4 v9, s[20:23], s58 offen nt lds
    s_add_u32 m0, s47, 0
    v_mfma_f32_16x16x32_bf16 v[180:183], v[200:203], a[80:83], 0
    ds_read_b128 v[200:203], v1 offset:26624
    v_cvt_pk_bf16_f32 v224, v224, v225
    v_mfma_f32_16x16x32_bf16 v[160:163], a[12:15], v[204:207], v[160:163]
    v_exp_f32 v231, v231
    v_mfma_f32_16x16x32_bf16 v[164:167], a[16:19], v[204:207], v[164:167]
    v_exp_f32 v232, v232
    v_mfma_f32_16x16x32_bf16 v[168:171], a[20:23], v[204:207], v[168:171]
    v_exp_f32 v233, v233
    v_mfma_f32_16x16x32_bf16 v[172:175], v[204:207], a[84:87], v[172:175]
    s_mov_b64 exec, s[50:51]
    buffer_load_dwordx4 v9, s[20:23], s54 offen offset:128 nt lds
    s_mov_b64 exec, -1
    v_mfma_f32_16x16x32_bf16 v[176:179], v[204:207], a[88:91], v[176:179]
    v_cvt_pk_bf16_f32 v225, v226, v227
    v_mul_f32 v188, v188, v197
    v_mfma_f32_16x16x32_bf16 v[180:183], v[204:207], a[92:95], v[180:183]
    ds_read_b128 v[204:207], v0 offset:28672
    v_mul_f32 v189, v189, v197
    v_mfma_f32_16x16x32_bf16 v[160:163], a[24:27], v[208:211], v[160:163]
    s_waitcnt lgkmcnt(1)
    v_exp_f32 v234, v234
    v_mfma_f32_16x16x32_bf16 v[164:167], a[28:31], v[208:211], v[164:167]
    v_exp_f32 v235, v235
    v_mfma_f32_16x16x32_bf16 v[168:171], a[32:35], v[208:211], v[168:171]
    s_waitcnt vmcnt(8)
    ds_read_b64_tr_b16 v[240:241], v212 offset:24576
    v_mfma_f32_16x16x32_bf16 v[172:175], v[208:211], a[96:99], v[172:175]
    ds_read_b64_tr_b16 v[242:243], v212 offset:26112
    ds_read_b64_tr_b16 v[238:239], v222 offset:26120
    v_mfma_f32_16x16x32_bf16 v[176:179], v[208:211], a[100:103], v[176:179]
    v_mul_f32 v190, v190, v197
    v_mul_f32 v191, v191, v197
    v_mfma_f32_16x16x32_bf16 v[180:183], v[208:211], a[104:107], v[180:183]
    ds_read_b128 v[208:211], v1 offset:28672
    v_cvt_pk_bf16_f32 v226, v228, v229
    v_mfma_f32_16x16x32_bf16 v[160:163], a[36:39], v[200:203], v[160:163]
    s_waitcnt lgkmcnt(4)
    ds_read_b64_tr_b16 v[228:229], v212 offset:61440
    v_cvt_pk_bf16_f32 v227, v230, v231
    v_mfma_f32_16x16x32_bf16 v[164:167], a[40:43], v[200:203], v[164:167]
    ds_read_b64_tr_b16 v[230:231], v212 offset:62976
    v_max3_f32 v18, v18, v196, v197
    v_mfma_f32_16x16x32_bf16 v[168:171], a[44:47], v[200:203], v[168:171]
    v_exp_f32 v236, v236
    v_mfma_f32_16x16x32_bf16 v[172:175], v[200:203], a[108:111], v[172:175]
    v_cvt_pk_bf16_f32 v232, v232, v233
    v_cvt_pk_bf16_f32 v233, v234, v235
    v_mfma_f32_16x16x32_bf16 v[176:179], v[200:203], a[112:115], v[176:179]
    v_cvt_pk_bf16_f32 v234, v236, 0
    v_mov_b32 v235, 0
    v_mfma_f32_16x16x32_bf16 v[180:183], v[200:203], a[116:119], v[180:183]
    ds_read_b64_tr_b16 v[236:237], v222 offset:24584
    ds_read_b128 v[200:203], v0 offset:30720
    v_mfma_f32_16x16x32_bf16 v[160:163], a[48:51], v[204:207], v[160:163]
    s_waitcnt lgkmcnt(2)
    v_exp_f32 v104, v104
    v_mfma_f32_16x16x32_bf16 v[164:167], a[52:55], v[204:207], v[164:167]
    v_exp_f32 v105, v105
    v_mfma_f32_16x16x32_bf16 v[168:171], a[56:59], v[204:207], v[168:171]
    v_exp_f32 v106, v106
    v_mfma_f32_16x16x32_bf16 v[172:175], v[204:207], a[120:123], v[172:175]
    v_exp_f32 v107, v107
    v_mfma_f32_16x16x32_bf16 v[176:179], v[204:207], a[124:127], v[176:179]
    v_exp_f32 v108, v108
    v_mfma_f32_16x16x32_bf16 v[180:183], v[204:207], a[128:131], v[180:183]
    s_waitcnt lgkmcnt(0)
    ds_read_b128 v[204:207], v1 offset:30720
    v_cvt_pk_bf16_f32 v104, v104, v105
    v_mfma_f32_16x16x32_bf16 v[160:163], a[60:63], v[208:211], v[160:163]
    s_waitcnt vmcnt(5)
    ds_read_b64_tr_b16 v[244:245], v222 offset:36864
    ds_read_b64_tr_b16 v[246:247], v222 offset:38400
    v_mfma_f32_16x16x32_bf16 v[164:167], a[64:67], v[208:211], v[164:167]
    ds_read_b64_tr_b16 v[248:249], v222 offset:36872
    ds_read_b64_tr_b16 v[250:251], v222 offset:38408
    v_mfma_f32_16x16x32_bf16 v[168:171], a[68:71], v[208:211], v[168:171]
    ds_read_b64_tr_b16 v[252:253], v212 offset:36864
    ds_read_b64_tr_b16 v[254:255], v212 offset:38400
    v_mfma_f32_16x16x32_bf16 v[172:175], v[208:211], a[132:135], v[172:175]
    v_exp_f32 v109, v109
    v_mfma_f32_16x16x32_bf16 v[176:179], v[208:211], a[136:139], v[176:179]
    v_exp_f32 v110, v110
    v_mfma_f32_16x16x32_bf16 v[180:183], v[208:211], a[140:143], v[180:183]
    ds_read_b128 v[208:211], v0 offset:32768
    v_cvt_pk_bf16_f32 v105, v106, v107
    v_mfma_f32_16x16x32_bf16 v[136:139], a[0:3], v[200:203], 0
    s_waitcnt lgkmcnt(4)
    v_exp_f32 v111, v111
    v_mfma_f32_16x16x32_bf16 v[136:139], a[12:15], v[204:207], v[136:139]
    ds_write_b128 v3, v[184:187] offset:6144
    v_mfma_f32_16x16x32_bf16 v[184:187], v[80:83], v[120:123], 0
    v_cvt_pk_bf16_f32 v106, v108, v109
    v_cvt_pk_bf16_f32 v107, v110, v111
    v_mfma_f32_16x16x32_bf16 v[184:187], v[84:87], v[128:131], v[184:187]
    v_cvt_pk_bf16_f32 v26, v140, v141
    v_cvt_pk_bf16_f32 v27, v142, v143
    v_mfma_f32_16x16x32_bf16 v[140:143], a[4:7], v[200:203], 0
    s_waitcnt lgkmcnt(1)
    v_cvt_pk_bf16_f32 v28, v144, v145
    v_cvt_pk_bf16_f32 v29, v146, v147
    v_mfma_f32_16x16x32_bf16 v[144:147], a[8:11], v[200:203], 0
    v_cvt_pk_bf16_f32 v32, v160, v161
    v_mul_f32 v184, v184, v197
    v_mfma_f32_16x16x32_bf16 v[140:143], a[16:19], v[204:207], v[140:143]
    v_mul_f32 v185, v185, v197
    v_mul_f32 v186, v186, v197
    v_mfma_f32_16x16x32_bf16 v[144:147], a[20:23], v[204:207], v[144:147]
    v_mul_f32 v187, v187, v197
    v_cvt_pk_bf16_f32 v184, v184, v185
    v_mfma_f32_16x16x32_bf16 v[136:139], a[24:27], v[208:211], v[136:139]
    v_cvt_pk_bf16_f32 v185, v186, v187
    v_cvt_pk_bf16_f32 v186, v188, v189
    v_mfma_f32_16x16x32_bf16 v[140:143], a[28:31], v[208:211], v[140:143]
    v_cvt_pk_bf16_f32 v187, v190, v191
    v_cvt_pk_bf16_f32 v33, v162, v163
    v_mfma_f32_16x16x32_bf16 v[188:191], v[88:91], v[224:227], 0
    v_cvt_pk_bf16_f32 v34, v164, v165
    v_cvt_pk_bf16_f32 v35, v166, v167
    v_mfma_f32_16x16x32_bf16 v[188:191], v[92:95], v[232:235], v[188:191]
    v_cvt_pk_bf16_f32 v36, v168, v169
    v_cvt_pk_bf16_f32 v37, v170, v171
    v_mfma_f32_16x16x32_bf16 v[144:147], a[32:35], v[208:211], v[144:147]
    ds_write_b64 v4, v[192:193] offset:6144
    v_mfma_f32_16x16x32_bf16 v[192:195], v[96:99], v[120:123], 0
    ds_read_b128 v[112:115], v6 offset:128
    ds_read_b32 v116, v7 offset:9456
    v_mfma_f32_16x16x32_bf16 v[192:195], v[100:103], v[128:131], v[192:195]
    ds_write_b128 v3, v[184:187] offset:12288
    v_mfma_f32_16x16x32_bf16 v[184:187], v[80:83], v[224:227], 0
    v_lshrrev_b32 v19, 4, v2
    v_subrev_u32 v19, 0x1500, v19
    v_mfma_f32_16x16x32_bf16 v[184:187], v[84:87], v[232:235], v[184:187]
    v_lshrrev_b32 v7, 4, v19
    v_cmp_eq_u32 vcc, 1, v7
    v_and_b32 v19, 15, v19
    v_mul_f32 v192, v192, v197
    v_mul_f32 v193, v193, v197
    v_mul_f32 v194, v194, v197
    v_mul_f32 v195, v195, v197
    v_mfma_f32_16x16x32_bf16 v[196:199], v[20:23], v[224:227], 0
    s_waitcnt lgkmcnt(2)
    v_cvt_pk_bf16_f32 v192, v192, v193
    v_cvt_pk_bf16_f32 v193, v194, v195
    v_mfma_f32_16x16x32_bf16 v[196:199], v[20:23], v[232:235], v[196:199]
    s_waitcnt lgkmcnt(1)
    v_mov_b32 v7, 16
    v_cndmask_b32 v19, v7, v19, vcc
    v_mfma_f32_16x16x32_bf16 v[112:115], v[40:43], v[72:75], v[112:115]
    ds_read_b128 v[120:123], v5
    v_lshlrev_b32 v19, 2, v19
    v_mfma_f32_16x16x32_bf16 v[116:119], v[48:51], v[72:75], v[116:119]
    ds_read_b128 v[124:127], v5 offset:1024
    v_add_u32 v7, s49, v19
    v_mfma_f32_16x16x32_bf16 v[112:115], v[44:47], v[76:79], v[112:115]
    v_rcp_f32 v197, v196
    v_mfma_f32_16x16x32_bf16 v[116:119], v[52:55], v[76:79], v[116:119]
    ds_write_b64 v4, v[192:193] offset:12288
    v_mfma_f32_16x16x32_bf16 v[192:195], v[96:99], v[224:227], 0
    ds_read_b64_tr_b16 v[224:225], v222 offset:61448
    ds_read_b64_tr_b16 v[226:227], v222 offset:62984
    v_mfma_f32_16x16x32_bf16 v[192:195], v[100:103], v[232:235], v[192:195]
    ds_read_b64_tr_b16 v[232:233], v222 offset:24576
    ds_read_b64_tr_b16 v[234:235], v222 offset:26112
    v_mul_f32 v184, v184, v197
    v_mul_f32 v185, v185, v197
    v_mul_f32 v186, v186, v197
    v_mul_f32 v187, v187, v197
    v_cvt_pk_bf16_f32 v184, v184, v185
    v_mul_f32 v188, v188, v197
    v_mul_f32 v189, v189, v197
    v_mul_f32 v190, v190, v197
    v_mul_f32 v191, v191, v197
    v_mul_f32 v192, v192, v197
    v_mul_f32 v193, v193, v197
    v_cvt_pk_bf16_f32 v185, v186, v187
    v_mul_f32 v194, v194, v197
    v_mul_f32 v195, v195, v197
    v_cvt_pk_bf16_f32 v192, v192, v193
    v_cvt_pk_bf16_f32 v186, v188, v189
    v_cvt_pk_bf16_f32 v187, v190, v191
    v_mfma_f32_16x16x32_bf16 v[188:191], v[88:91], v[104:107], 0
    v_cvt_pk_bf16_f32 v193, v194, v195
    ds_write_b128 v3, v[184:187] offset:18432
    v_mfma_f32_16x16x32_bf16 v[184:187], v[80:83], v[104:107], 0
    v_cvt_pk_bf16_f32 v88, v152, v153
    ds_write_b64 v4, v[192:193] offset:18432
    v_mfma_f32_16x16x32_bf16 v[192:195], v[96:99], v[104:107], 0
    v_cvt_pk_bf16_f32 v89, v154, v155
    v_cvt_pk_bf16_f32 v80, v148, v149
    v_mfma_f32_16x16x32_bf16 v[152:155], v[200:203], a[76:79], 0
    v_cvt_pk_bf16_f32 v81, v150, v151
    v_cvt_pk_bf16_f32 v96, v156, v157
    v_mfma_f32_16x16x32_bf16 v[148:151], v[200:203], a[72:75], 0
    v_cvt_pk_bf16_f32 v97, v158, v159
    v_cvt_pk_bf16_f32 v90, v176, v177
    v_mfma_f32_16x16x32_bf16 v[156:159], v[200:203], a[80:83], 0
    ds_read_b128 v[200:203], v1 offset:32768
    v_cvt_pk_bf16_f32 v91, v178, v179
    v_mfma_f32_16x16x32_bf16 v[152:155], v[204:207], a[88:91], v[152:155]
    v_cvt_pk_bf16_f32 v82, v172, v173
    v_cvt_pk_bf16_f32 v83, v174, v175
    v_mfma_f32_16x16x32_bf16 v[148:151], v[204:207], a[84:87], v[148:151]
    v_cvt_pk_bf16_f32 v98, v180, v181
    v_cvt_pk_bf16_f32 v99, v182, v183
    v_mfma_f32_16x16x32_bf16 v[156:159], v[204:207], a[92:95], v[156:159]
    s_waitcnt lgkmcnt(1)
    ds_read_b128 v[204:207], v0 offset:34816
    s_barrier
    v_mfma_f32_16x16x32_bf16 v[152:155], v[208:211], a[100:103], v[152:155]
    s_waitcnt lgkmcnt(1)
    ds_read_b128 v[212:215], v2 offset:6144
    ds_read_b128 v[216:219], v2 offset:7168
    v_mfma_f32_16x16x32_bf16 v[148:151], v[208:211], a[96:99], v[148:151]
    ds_read_b128 v[220:223], v2 offset:8192
    v_bfe_i32 v19, v11, 0, 1
    v_mfma_f32_16x16x32_bf16 v[156:159], v[208:211], a[104:107], v[156:159]
    ds_read_b128 v[208:211], v1 offset:34816
    v_and_b32 v19, 0x15000, v19
    v_mfma_f32_16x16x32_bf16 v[136:139], a[36:39], v[200:203], v[136:139]
    s_waitcnt lgkmcnt(4)
    v_exp_f32 v112, v112
    v_mfma_f32_16x16x32_bf16 v[140:143], a[40:43], v[200:203], v[140:143]
    v_exp_f32 v113, v113
    v_mfma_f32_16x16x32_bf16 v[144:147], a[44:47], v[200:203], v[144:147]
    v_exp_f32 v114, v114
    v_mfma_f32_16x16x32_bf16 v[152:155], v[200:203], a[112:115], v[152:155]
    s_waitcnt lgkmcnt(3)
    v_exp_f32 v115, v115
    v_mfma_f32_16x16x32_bf16 v[148:151], v[200:203], a[108:111], v[148:151]
    v_exp_f32 v116, v116
    v_mfma_f32_16x16x32_bf16 v[156:159], v[200:203], a[116:119], v[156:159]
    ds_read_b128 v[200:203], v0 offset:18432
    v_cvt_pk_bf16_f32 v112, v112, v113
    v_mfma_f32_16x16x32_bf16 v[136:139], a[48:51], v[204:207], v[136:139]
    s_waitcnt lgkmcnt(1)
    v_cvt_pk_bf16_f32 v113, v114, v115
    v_cvt_pk_bf16_f32 v114, v116, 0
    v_mfma_f32_16x16x32_bf16 v[140:143], a[52:55], v[204:207], v[140:143]
    v_mov_b32 v115, 0
    v_sub_u32 v8, v8, v19
    v_mfma_f32_16x16x32_bf16 v[144:147], a[56:59], v[204:207], v[144:147]
    ds_read_b128 v[128:131], v5 offset:2048
    ds_read_b32 v132, v7 offset:9216
    v_mfma_f32_16x16x32_bf16 v[152:155], v[204:207], a[124:127], v[152:155]
    v_add_u32 v8, 0x1f80, v8
    s_add_u32 m0, s45, 18432
    v_mfma_f32_16x16x32_bf16 v[148:151], v[204:207], a[120:123], v[148:151]
    v_bfe_i32 v19, v11, 1, 1
    v_and_b32 v19, 0x15000, v19
    v_mfma_f32_16x16x32_bf16 v[156:159], v[204:207], a[128:131], v[156:159]
    s_waitcnt lgkmcnt(2)
    ds_read_b128 v[204:207], v1 offset:18432
    v_sub_u32 v9, v9, v19
    v_mfma_f32_16x16x32_bf16 v[136:139], a[60:63], v[208:211], v[136:139]
    v_add_u32 v9, 0x1f80, v9
    v_max3_f32 v18, v18, v196, v197
    v_mfma_f32_16x16x32_bf16 v[140:143], a[64:67], v[208:211], v[140:143]
    ds_read_b128 v[108:111], v5 offset:4096
    v_mov_b32 v62, v15
    v_mfma_f32_16x16x32_bf16 v[144:147], a[68:71], v[208:211], v[144:147]
    ds_read_b32 v116, v7 offset:9296
    v_lshrrev_b32 v19, 4, v2
    v_mfma_f32_16x16x32_bf16 v[152:155], v[208:211], a[136:139], v[152:155]
    v_cvt_pk_bf16_f32 v40, v136, v137
    v_cvt_pk_bf16_f32 v41, v138, v139
    v_mfma_f32_16x16x32_bf16 v[148:151], v[208:211], a[132:135], v[148:151]
    v_cvt_pk_bf16_f32 v42, v140, v141
    v_cvt_pk_bf16_f32 v43, v142, v143
    v_mfma_f32_16x16x32_bf16 v[156:159], v[208:211], a[140:143], v[156:159]
    ds_read_b128 v[208:211], v0 offset:20480
    v_cvt_pk_bf16_f32 v44, v144, v145
    v_mfma_f32_16x16x32_bf16 v[160:163], a[144:147], v[200:203], 0
    s_waitcnt lgkmcnt(3)
    v_cvt_pk_bf16_f32 v45, v146, v147
    v_subrev_u32 v19, 0x1500, v19
    v_mfma_f32_16x16x32_bf16 v[164:167], a[148:151], v[200:203], 0
    s_lshl_b32 s79, s40, 2
    s_add_u32 s79, s79, 81920
    s_add_u32 s70, s60, 6
    v_mfma_f32_16x16x32_bf16 v[168:171], a[152:155], v[200:203], 0
    ds_read_b128 v[200:203], v1 offset:20480
    s_cmp_ge_u32 s70, 224
    s_cselect_b32 s71, 224, 0
    v_mfma_f32_16x16x32_bf16 v[160:163], a[156:159], v[204:207], v[160:163]
    s_sub_u32 s70, s70, s71
    s_lshl_b32 s3, s63, 5
    s_mul_i32 s71, s40, 96
    v_mfma_f32_16x16x32_bf16 v[164:167], a[160:163], v[204:207], v[164:167]
    s_waitcnt lgkmcnt(1)
    s_mul_i32 s70, s70, 86016
    s_add_u32 s71, s71, s3
    s_add_u32 s70, s70, s71
    v_mfma_f32_16x16x32_bf16 v[168:171], a[164:167], v[204:207], v[168:171]
    ds_read_b128 v[204:207], v0 offset:22528
    v_mfma_f32_16x16x32_bf16 v[160:163], a[168:171], v[208:211], v[160:163]
    v_mfma_f32_16x16x32_bf16 v[164:167], a[172:175], v[208:211], v[164:167]
    s_waitcnt lgkmcnt(1)
    v_mfma_f32_16x16x32_bf16 v[168:171], a[176:179], v[208:211], v[168:171]
    ds_read_b128 v[208:211], v1 offset:22528
    v_mfma_f32_16x16x32_bf16 v[160:163], a[180:183], v[200:203], v[160:163]
    v_mfma_f32_16x16x32_bf16 v[164:167], a[184:187], v[200:203], v[164:167]
    v_mfma_f32_16x16x32_bf16 v[168:171], a[188:191], v[200:203], v[168:171]
    s_waitcnt lgkmcnt(1)
    ds_read_b128 v[200:203], v0 offset:24576
    v_mfma_f32_16x16x32_bf16 v[160:163], a[192:195], v[204:207], v[160:163]
    v_mfma_f32_16x16x32_bf16 v[164:167], a[196:199], v[204:207], v[164:167]
    v_mfma_f32_16x16x32_bf16 v[168:171], a[200:203], v[204:207], v[168:171]
    s_waitcnt lgkmcnt(1)
    ds_read_b128 v[204:207], v1 offset:24576
    v_mfma_f32_16x16x32_bf16 v[160:163], a[204:207], v[208:211], v[160:163]
    v_mfma_f32_16x16x32_bf16 v[164:167], a[208:211], v[208:211], v[164:167]
    v_mfma_f32_16x16x32_bf16 v[168:171], a[212:215], v[208:211], v[168:171]
    ds_read_b128 v[208:211], v0 offset:26624
    v_mfma_f32_16x16x32_bf16 v[172:175], a[216:219], v[212:215], 0
    v_mfma_f32_16x16x32_bf16 v[176:179], a[220:223], v[212:215], 0
    v_mfma_f32_16x16x32_bf16 v[180:183], a[224:227], v[212:215], 0
    ds_read_b128 v[212:215], v2 offset:9216
    v_mfma_f32_16x16x32_bf16 v[172:175], a[228:231], v[216:219], v[172:175]
    v_mul_f32 v160, s43, v160
    v_mul_f32 v161, s43, v161
    v_mfma_f32_16x16x32_bf16 v[176:179], a[232:235], v[216:219], v[176:179]
    v_mul_f32 v162, s43, v162
    v_mul_f32 v163, s43, v163
    v_mfma_f32_16x16x32_bf16 v[180:183], a[236:239], v[216:219], v[180:183]
    v_mul_f32 v164, s43, v164
    v_mul_f32 v165, s43, v165
    v_mfma_f32_16x16x32_bf16 v[172:175], a[240:243], v[220:223], v[172:175]
    v_mul_f32 v166, s43, v166
    v_mul_f32 v167, s43, v167
    v_mfma_f32_16x16x32_bf16 v[176:179], a[244:247], v[220:223], v[176:179]
    v_mul_f32 v168, s43, v168
    v_mul_f32 v169, s43, v169
    v_mfma_f32_16x16x32_bf16 v[180:183], a[248:251], v[220:223], v[180:183]
    s_waitcnt lgkmcnt(0)
    v_mul_f32 v170, s43, v170
    v_mul_f32 v171, s43, v171
    v_mfma_f32_16x16x32_bf16 v[172:175], a[252:255], v[212:215], v[172:175]
    v_cvt_pk_bf16_f32 v56, v160, v161
    v_cvt_pk_bf16_f32 v57, v162, v163
    v_mfma_f32_16x16x32_bf16 v[160:163], a[144:147], v[200:203], 0
    v_cvt_pk_bf16_f32 v58, v164, v165
    v_cvt_pk_bf16_f32 v59, v166, v167
    v_mfma_f32_16x16x32_bf16 v[164:167], a[148:151], v[200:203], 0
    v_cvt_pk_bf16_f32 v60, v168, v169
    v_cvt_pk_bf16_f32 v61, v170, v171
    v_mfma_f32_16x16x32_bf16 v[168:171], a[152:155], v[200:203], 0
    ds_read_b128 v[200:203], v1 offset:26624
    ds_read_b128 v[216:219], v2 offset:10240
    v_mfma_f32_16x16x32_bf16 v[160:163], a[156:159], v[204:207], v[160:163]
    ds_read_b128 v[220:223], v2 offset:11264
    v_mfma_f32_16x16x32_bf16 v[164:167], a[160:163], v[204:207], v[164:167]
    v_mfma_f32_16x16x32_bf16 v[168:171], a[164:167], v[204:207], v[168:171]
    ds_read_b128 v[204:207], v0 offset:28672
    v_mfma_f32_16x16x32_bf16 v[160:163], a[168:171], v[208:211], v[160:163]
    v_mfma_f32_16x16x32_bf16 v[164:167], a[172:175], v[208:211], v[164:167]
    v_mfma_f32_16x16x32_bf16 v[168:171], a[176:179], v[208:211], v[168:171]
    s_waitcnt lgkmcnt(3)
    ds_read_b128 v[208:211], v1 offset:28672
    v_mfma_f32_16x16x32_bf16 v[160:163], a[180:183], v[200:203], v[160:163]
    s_waitcnt lgkmcnt(3)
    v_mfma_f32_16x16x32_bf16 v[164:167], a[184:187], v[200:203], v[164:167]
    v_mfma_f32_16x16x32_bf16 v[168:171], a[188:191], v[200:203], v[168:171]
    s_waitcnt lgkmcnt(1)
    ds_read_b128 v[200:203], v0 offset:30720
    v_mfma_f32_16x16x32_bf16 v[160:163], a[192:195], v[204:207], v[160:163]
    v_mfma_f32_16x16x32_bf16 v[164:167], a[196:199], v[204:207], v[164:167]
    v_mfma_f32_16x16x32_bf16 v[168:171], a[200:203], v[204:207], v[168:171]
    s_waitcnt lgkmcnt(1)
    ds_read_b128 v[204:207], v1 offset:30720
    v_mfma_f32_16x16x32_bf16 v[160:163], a[204:207], v[208:211], v[160:163]
    v_mfma_f32_16x16x32_bf16 v[164:167], a[208:211], v[208:211], v[164:167]
    v_mfma_f32_16x16x32_bf16 v[168:171], a[212:215], v[208:211], v[168:171]
    ds_read_b128 v[208:211], v0 offset:32768
    v_mfma_f32_16x16x32_bf16 v[176:179], v[224:227], v[212:215], v[176:179]
    v_mfma_f32_16x16x32_bf16 v[180:183], v[228:231], v[212:215], v[180:183]
    ds_read_b128 v[212:215], v2 offset:12288
    v_mfma_f32_16x16x32_bf16 v[172:175], v[232:235], v[216:219], v[172:175]
    v_mfma_f32_16x16x32_bf16 v[176:179], v[236:239], v[216:219], v[176:179]
    v_mul_f32 v160, s43, v160
    v_mul_f32 v161, s43, v161
    v_mfma_f32_16x16x32_bf16 v[180:183], v[240:243], v[216:219], v[180:183]
    ds_read_b128 v[216:219], v2 offset:13312
    v_mul_f32 v162, s43, v162
    v_mfma_f32_16x16x32_bf16 v[172:175], v[244:247], v[220:223], v[172:175]
    v_mul_f32 v163, s43, v163
    v_mul_f32 v164, s43, v164
    v_mfma_f32_16x16x32_bf16 v[176:179], v[248:251], v[220:223], v[176:179]
    v_mul_f32 v165, s43, v165
    v_mul_f32 v166, s43, v166
    v_mfma_f32_16x16x32_bf16 v[180:183], v[252:255], v[220:223], v[180:183]
    ds_read_b128 v[220:223], v2 offset:14336
    v_mul_f32 v167, s43, v167
    v_mfma_f32_16x16x32_bf16 v[184:187], v[84:87], v[112:115], v[184:187]
    v_mul_f32 v168, s43, v168
    v_mul_f32 v169, s43, v169
    v_mfma_f32_16x16x32_bf16 v[188:191], v[92:95], v[112:115], v[188:191]
    v_mul_f32 v170, s43, v170
    v_mul_f32 v171, s43, v171
    v_mfma_f32_16x16x32_bf16 v[192:195], v[100:103], v[112:115], v[192:195]
    v_cvt_pk_bf16_f32 v64, v160, v161
    v_cvt_pk_bf16_f32 v65, v162, v163
    s_waitcnt lgkmcnt(5)
    v_mfma_f32_16x16x32_bf16 v[160:163], a[144:147], v[200:203], 0
    s_waitcnt lgkmcnt(1)
    v_cvt_pk_bf16_f32 v66, v164, v165
    v_cvt_pk_bf16_f32 v67, v166, v167
    v_mfma_f32_16x16x32_bf16 v[164:167], a[148:151], v[200:203], 0
    v_cvt_pk_bf16_f32 v68, v168, v169
    v_cvt_pk_bf16_f32 v69, v170, v171
    v_mfma_f32_16x16x32_bf16 v[168:171], a[152:155], v[200:203], 0
    v_cvt_pk_bf16_f32 v172, v172, v173
    v_cvt_pk_bf16_f32 v173, v174, v175
    v_mfma_f32_16x16x32_bf16 v[160:163], a[156:159], v[204:207], v[160:163]
    ds_read_b128 v[200:203], v1 offset:32768
    v_cvt_pk_bf16_f32 v180, v180, v181
    v_mfma_f32_16x16x32_bf16 v[164:167], a[160:163], v[204:207], v[164:167]
    v_cvt_pk_bf16_f32 v174, v176, v177
    v_cvt_pk_bf16_f32 v175, v178, v179
    v_mfma_f32_16x16x32_bf16 v[168:171], a[164:167], v[204:207], v[168:171]
    v_cvt_pk_bf16_f32 v181, v182, v183
    v_add_u32 v182, v12, v10
    v_mfma_f32_16x16x32_bf16 v[160:163], a[168:171], v[208:211], v[160:163]
    ds_read_b128 v[204:207], v0 offset:34816
    v_cvt_pk_bf16_f32 v84, v148, v149
    v_mfma_f32_16x16x32_bf16 v[164:167], a[172:175], v[208:211], v[164:167]
    v_cvt_pk_bf16_f32 v85, v150, v151
    v_cvt_pk_bf16_f32 v92, v152, v153
    v_mfma_f32_16x16x32_bf16 v[168:171], a[176:179], v[208:211], v[168:171]
    ds_read_b128 v[208:211], v1 offset:34816
    v_cvt_pk_bf16_f32 v93, v154, v155
    v_mfma_f32_16x16x32_bf16 v[176:179], a[220:223], v[212:215], 0
    s_waitcnt lgkmcnt(2)
    v_cvt_pk_bf16_f32 v100, v156, v157
    v_cvt_pk_bf16_f32 v101, v158, v159
    v_mfma_f32_16x16x32_bf16 v[176:179], a[232:235], v[216:219], v[176:179]
    buffer_store_dwordx4 v[172:175], v12, s[36:39], 0 offen sc1
    v_mfma_f32_16x16x32_bf16 v[176:179], a[244:247], v[220:223], v[176:179]
    v_mfma_f32_16x16x32_bf16 v[120:123], v[24:27], v[56:59], v[120:123]
    v_mfma_f32_16x16x32_bf16 v[172:175], a[216:219], v[212:215], 0
    s_waitcnt lgkmcnt(0)
    s_waitcnt vmcnt(1)
    s_barrier
    v_mfma_f32_16x16x32_bf16 v[172:175], a[228:231], v[216:219], v[172:175]
    buffer_load_dwordx4 v8, s[20:23], s52 offen nt lds
    s_add_u32 m0, s45, 20352
    v_mfma_f32_16x16x32_bf16 v[172:175], a[240:243], v[220:223], v[172:175]
    v_mfma_f32_16x16x32_bf16 v[160:163], a[180:183], v[200:203], v[160:163]
    v_mfma_f32_16x16x32_bf16 v[164:167], a[184:187], v[200:203], v[164:167]
    v_mfma_f32_16x16x32_bf16 v[168:171], a[188:191], v[200:203], v[168:171]
    ds_read_b128 v[200:203], v0
    buffer_load_dwordx4 v8, s[20:23], s52 offen offset:128 nt lds
    v_mfma_f32_16x16x32_bf16 v[124:127], v[32:35], v[56:59], v[124:127]
    s_add_u32 m0, s45, 22272
    v_mfma_f32_16x16x32_bf16 v[128:131], v[40:43], v[56:59], v[128:131]
    v_mfma_f32_16x16x32_bf16 v[120:123], v[28:31], v[60:63], v[120:123]
    v_mfma_f32_16x16x32_bf16 v[160:163], a[192:195], v[204:207], v[160:163]
    v_mfma_f32_16x16x32_bf16 v[164:167], a[196:199], v[204:207], v[164:167]
    buffer_load_dwordx4 v8, s[20:23], s52 offen offset:256 nt lds
    s_add_u32 m0, s46, 18432
    v_mfma_f32_16x16x32_bf16 v[168:171], a[200:203], v[204:207], v[168:171]
    s_waitcnt lgkmcnt(0)
    ds_read_b128 v[204:207], v1
    v_mfma_f32_16x16x32_bf16 v[132:135], v[48:51], v[56:59], v[132:135]
    v_exp_f32 v120, v120
    v_mfma_f32_16x16x32_bf16 v[124:127], v[36:39], v[60:63], v[124:127]
    v_exp_f32 v121, v121
    v_mfma_f32_16x16x32_bf16 v[128:131], v[44:47], v[60:63], v[128:131]
    buffer_load_dwordx4 v9, s[20:23], s56 offen nt lds
    v_mfma_f32_16x16x32_bf16 v[160:163], a[204:207], v[208:211], v[160:163]
    s_add_u32 m0, s47, 18432
    v_exp_f32 v122, v122
    v_mfma_f32_16x16x32_bf16 v[164:167], a[208:211], v[208:211], v[164:167]
    v_exp_f32 v123, v123
    v_mfma_f32_16x16x32_bf16 v[168:171], a[212:215], v[208:211], v[168:171]
    ds_read_b128 v[208:211], v0 offset:2048
    v_cvt_pk_bf16_f32 v120, v120, v121
    v_mfma_f32_16x16x32_bf16 v[132:135], v[52:55], v[60:63], v[132:135]
    v_exp_f32 v124, v124
    v_mfma_f32_16x16x32_bf16 v[196:199], v[20:23], v[104:107], 0
    s_mov_b64 exec, s[50:51]
    buffer_load_dwordx4 v9, s[20:23], s52 offen offset:128 nt lds
    s_mov_b64 exec, -1
    v_mfma_f32_16x16x32_bf16 v[196:199], v[20:23], v[112:115], v[196:199]
    ds_read_b128 v[104:107], v5 offset:3072
    ds_read_b128 v[112:115], v5 offset:5120
    v_mfma_f32_16x16x32_bf16 v[108:111], v[32:35], v[64:67], v[108:111]
    v_exp_f32 v125, v125
    v_mfma_f32_16x16x32_bf16 v[108:111], v[36:39], v[68:71], v[108:111]
    v_exp_f32 v126, v126
    v_mfma_f32_16x16x32_bf16 v[136:139], a[0:3], v[200:203], 0
    s_waitcnt lgkmcnt(2)
    v_rcp_f32 v197, v196
    v_mfma_f32_16x16x32_bf16 v[140:143], a[4:7], v[200:203], 0
    v_mul_f32 v184, v184, v197
    v_mul_f32 v185, v185, v197
    v_mfma_f32_16x16x32_bf16 v[144:147], a[8:11], v[200:203], 0
    v_mul_f32 v186, v186, v197
    v_mul_f32 v187, v187, v197
    s_waitcnt lgkmcnt(1)
    v_mfma_f32_16x16x32_bf16 v[104:107], v[24:27], v[64:67], v[104:107]
    s_waitcnt lgkmcnt(0)
    v_cvt_pk_bf16_f32 v184, v184, v185
    v_mul_f32 v188, v188, v197
    v_mfma_f32_16x16x32_bf16 v[104:107], v[28:31], v[68:71], v[104:107]
    v_mul_f32 v189, v189, v197
    v_mul_f32 v190, v190, v197
    v_mfma_f32_16x16x32_bf16 v[148:151], v[200:203], a[72:75], 0
    v_mul_f32 v191, v191, v197
    v_mul_f32 v192, v192, v197
    v_mfma_f32_16x16x32_bf16 v[152:155], v[200:203], a[76:79], 0
    v_mul_f32 v193, v193, v197
    v_cvt_pk_bf16_f32 v185, v186, v187
    v_mfma_f32_16x16x32_bf16 v[156:159], v[200:203], a[80:83], 0
    ds_read_b128 v[200:203], v1 offset:2048
    v_mul_f32 v194, v194, v197
    v_mfma_f32_16x16x32_bf16 v[112:115], v[40:43], v[64:67], v[112:115]
    v_exp_f32 v127, v127
    v_mfma_f32_16x16x32_bf16 v[136:139], a[12:15], v[204:207], v[136:139]
    v_mul_f32 v195, v195, v197
    v_cvt_pk_bf16_f32 v192, v192, v193
    v_mfma_f32_16x16x32_bf16 v[140:143], a[16:19], v[204:207], v[140:143]
    v_cvt_pk_bf16_f32 v186, v188, v189
    v_cvt_pk_bf16_f32 v187, v190, v191
    v_mfma_f32_16x16x32_bf16 v[144:147], a[20:23], v[204:207], v[144:147]
    v_cvt_pk_bf16_f32 v193, v194, v195
    v_cvt_pk_bf16_f32 v121, v122, v123
    v_mfma_f32_16x16x32_bf16 v[148:151], v[204:207], a[84:87], v[148:151]
    v_exp_f32 v128, v128
    v_mfma_f32_16x16x32_bf16 v[152:155], v[204:207], a[88:91], v[152:155]
    v_exp_f32 v129, v129
    v_mfma_f32_16x16x32_bf16 v[156:159], v[204:207], a[92:95], v[156:159]
    ds_read_b128 v[204:207], v0 offset:4096
    v_cvt_pk_bf16_f32 v122, v124, v125
    v_mfma_f32_16x16x32_bf16 v[116:119], v[48:51], v[64:67], v[116:119]
    v_exp_f32 v130, v130
    v_mfma_f32_16x16x32_bf16 v[112:115], v[44:47], v[68:71], v[112:115]
    v_exp_f32 v131, v131
    v_mfma_f32_16x16x32_bf16 v[136:139], a[24:27], v[208:211], v[136:139]
    s_waitcnt lgkmcnt(1)
    v_cvt_pk_bf16_f32 v123, v126, v127
    v_max3_f32 v18, v18, v196, v197
    v_mfma_f32_16x16x32_bf16 v[140:143], a[28:31], v[208:211], v[140:143]
    v_exp_f32 v132, v132
    v_mfma_f32_16x16x32_bf16 v[144:147], a[32:35], v[208:211], v[144:147]
    v_cvt_pk_bf16_f32 v128, v128, v129
    v_cvt_pk_bf16_f32 v129, v130, v131
    v_mfma_f32_16x16x32_bf16 v[148:151], v[208:211], a[96:99], v[148:151]
    v_cvt_pk_bf16_f32 v130, v132, 0
    v_mov_b32 v131, 0
    v_mfma_f32_16x16x32_bf16 v[152:155], v[208:211], a[100:103], v[152:155]
    ds_read_b128 v[124:127], v5 offset:7168
    ds_read_b32 v132, v7 offset:9376
    v_mfma_f32_16x16x32_bf16 v[156:159], v[208:211], a[104:107], v[156:159]
    ds_read_b128 v[208:211], v1 offset:4096
    v_mul_f32 v160, s43, v160
    v_mfma_f32_16x16x32_bf16 v[188:191], v[88:91], v[120:123], 0
    v_mul_f32 v161, s43, v161
    v_mul_f32 v162, s43, v162
    v_mfma_f32_16x16x32_bf16 v[196:199], v[20:23], v[120:123], 0
    v_mul_f32 v163, s43, v163
    v_mul_f32 v164, s43, v164
    v_mfma_f32_16x16x32_bf16 v[116:119], v[52:55], v[68:71], v[116:119]
    v_mul_f32 v165, s43, v165
    v_mul_f32 v166, s43, v166
    v_mfma_f32_16x16x32_bf16 v[188:191], v[92:95], v[128:131], v[188:191]
    v_mul_f32 v167, s43, v167
    v_mul_f32 v168, s43, v168
    v_mfma_f32_16x16x32_bf16 v[196:199], v[20:23], v[128:131], v[196:199]
    v_mul_f32 v169, s43, v169
    v_mul_f32 v170, s43, v170
    v_mfma_f32_16x16x32_bf16 v[136:139], a[36:39], v[200:203], v[136:139]
    s_waitcnt lgkmcnt(0)
    v_mul_f32 v171, s43, v171
    v_cvt_pk_bf16_f32 v56, v160, v161
    v_mfma_f32_16x16x32_bf16 v[140:143], a[40:43], v[200:203], v[140:143]
    v_cvt_pk_bf16_f32 v57, v162, v163
    v_cvt_pk_bf16_f32 v58, v164, v165
    v_mfma_f32_16x16x32_bf16 v[144:147], a[44:47], v[200:203], v[144:147]
    v_cvt_pk_bf16_f32 v59, v166, v167
    v_cvt_pk_bf16_f32 v60, v168, v169
    v_mfma_f32_16x16x32_bf16 v[148:151], v[200:203], a[108:111], v[148:151]
    v_cvt_pk_bf16_f32 v61, v170, v171
    v_mov_b32 v62, v16
    v_mfma_f32_16x16x32_bf16 v[124:127], v[32:35], v[56:59], v[124:127]
    v_rcp_f32 v197, v196
    v_mfma_f32_16x16x32_bf16 v[132:135], v[48:51], v[56:59], v[132:135]
    v_exp_f32 v104, v104
    v_mfma_f32_16x16x32_bf16 v[124:127], v[36:39], v[60:63], v[124:127]
    v_exp_f32 v105, v105
    v_mfma_f32_16x16x32_bf16 v[132:135], v[52:55], v[60:63], v[132:135]
    v_exp_f32 v106, v106
    v_mfma_f32_16x16x32_bf16 v[152:155], v[200:203], a[112:115], v[152:155]
    v_exp_f32 v107, v107
    v_mfma_f32_16x16x32_bf16 v[156:159], v[200:203], a[116:119], v[156:159]
    ds_read_b128 v[200:203], v0 offset:6144
    v_mul_f32 v188, v188, v197
    v_mfma_f32_16x16x32_bf16 v[136:139], a[48:51], v[204:207], v[136:139]
    v_mul_f32 v189, v189, v197
    v_mul_f32 v190, v190, v197
    v_mfma_f32_16x16x32_bf16 v[140:143], a[52:55], v[204:207], v[140:143]
    v_mul_f32 v191, v191, v197
    v_cvt_pk_bf16_f32 v104, v104, v105
    v_mfma_f32_16x16x32_bf16 v[144:147], a[56:59], v[204:207], v[144:147]
    v_exp_f32 v108, v108
    v_mfma_f32_16x16x32_bf16 v[148:151], v[204:207], a[120:123], v[148:151]
    v_exp_f32 v109, v109
    v_mfma_f32_16x16x32_bf16 v[152:155], v[204:207], a[124:127], v[152:155]
    v_exp_f32 v110, v110
    v_mfma_f32_16x16x32_bf16 v[156:159], v[204:207], a[128:131], v[156:159]
    s_waitcnt lgkmcnt(0)
    ds_read_b128 v[204:207], v1 offset:6144
    v_cvt_pk_bf16_f32 v105, v106, v107
    v_mfma_f32_16x16x32_bf16 v[136:139], a[60:63], v[208:211], v[136:139]
    v_exp_f32 v111, v111
    v_mfma_f32_16x16x32_bf16 v[140:143], a[64:67], v[208:211], v[140:143]
    v_cvt_pk_bf16_f32 v106, v108, v109
    v_cvt_pk_bf16_f32 v107, v110, v111
    v_mfma_f32_16x16x32_bf16 v[144:147], a[68:71], v[208:211], v[144:147]
    v_max3_f32 v18, v18, v196, v197
    v_mfma_f32_16x16x32_bf16 v[148:151], v[208:211], a[132:135], v[148:151]
    ds_read_b128 v[108:111], v6 offset:64
    v_mfma_f32_16x16x32_bf16 v[152:155], v[208:211], a[136:139], v[152:155]
    v_exp_f32 v112, v112
    v_mfma_f32_16x16x32_bf16 v[156:159], v[208:211], a[140:143], v[156:159]
    ds_read_b128 v[208:211], v0 offset:8192
    v_mfma_f32_16x16x32_bf16 v[160:163], a[0:3], v[200:203], 0
    s_waitcnt lgkmcnt(2)
    v_exp_f32 v113, v113
    v_mfma_f32_16x16x32_bf16 v[164:167], a[4:7], v[200:203], 0
    v_exp_f32 v114, v114
    v_mfma_f32_16x16x32_bf16 v[168:171], a[8:11], v[200:203], 0
    v_exp_f32 v115, v115
    s_waitcnt lgkmcnt(1)
    v_mfma_f32_16x16x32_bf16 v[108:111], v[32:35], v[72:75], v[108:111]
    v_exp_f32 v116, v116
    v_mfma_f32_16x16x32_bf16 v[108:111], v[36:39], v[76:79], v[108:111]
    v_cvt_pk_bf16_f32 v112, v112, v113
    v_cvt_pk_bf16_f32 v113, v114, v115
    v_mfma_f32_16x16x32_bf16 v[160:163], a[12:15], v[204:207], v[160:163]
    s_waitcnt lgkmcnt(0)
    v_cvt_pk_bf16_f32 v114, v116, 0
    v_mov_b32 v115, 0
    v_mfma_f32_16x16x32_bf16 v[164:167], a[16:19], v[204:207], v[164:167]
    v_exp_f32 v124, v124
    v_mfma_f32_16x16x32_bf16 v[168:171], a[20:23], v[204:207], v[168:171]
    v_exp_f32 v125, v125
    v_mfma_f32_16x16x32_bf16 v[160:163], a[24:27], v[208:211], v[160:163]
    v_exp_f32 v126, v126
    v_mfma_f32_16x16x32_bf16 v[164:167], a[28:31], v[208:211], v[164:167]
    v_exp_f32 v127, v127
    v_mfma_f32_16x16x32_bf16 v[168:171], a[32:35], v[208:211], v[168:171]
    buffer_store_dwordx2 v[180:181], v182, s[36:39], 0 offen sc1
    v_mfma_f32_16x16x32_bf16 v[180:183], a[224:227], v[212:215], 0
    ds_read_b128 v[212:215], v2 offset:15360
    ds_read_b32 v116, v7 offset:9456
    v_mfma_f32_16x16x32_bf16 v[180:183], a[236:239], v[216:219], v[180:183]
    ds_read_b128 v[216:219], v2 offset:16384
    v_lshrrev_b32 v7, 4, v19
    v_mfma_f32_16x16x32_bf16 v[180:183], a[248:251], v[220:223], v[180:183]
    ds_read_b128 v[220:223], v2 offset:17408
    s_mov_b32 exec_lo, 0x10001
    s_mov_b32 exec_hi, 0x10001
    ds_write_b128 v3, v[184:187]
    s_mov_b64 exec, -1
    v_mfma_f32_16x16x32_bf16 v[184:187], v[80:83], v[120:123], 0
    v_exp_f32 v132, v132
    v_mfma_f32_16x16x32_bf16 v[184:187], v[84:87], v[128:131], v[184:187]
    s_waitcnt lgkmcnt(4)
    v_exp_f32 v108, v108
    v_mfma_f32_16x16x32_bf16 v[172:175], a[252:255], v[212:215], v[172:175]
    s_waitcnt lgkmcnt(3)
    v_exp_f32 v109, v109
    v_mfma_f32_16x16x32_bf16 v[176:179], v[224:227], v[212:215], v[176:179]
    s_waitcnt lgkmcnt(2)
    v_exp_f32 v110, v110
    v_mfma_f32_16x16x32_bf16 v[180:183], v[228:231], v[212:215], v[180:183]
    ds_read_b128 v[212:215], v2 offset:18432
    v_mul_f32 v184, v184, v197
    v_mfma_f32_16x16x32_bf16 v[172:175], v[232:235], v[216:219], v[172:175]
    s_waitcnt lgkmcnt(2)
    v_mul_f32 v185, v185, v197
    v_mul_f32 v186, v186, v197
    v_mfma_f32_16x16x32_bf16 v[176:179], v[236:239], v[216:219], v[176:179]
    v_mul_f32 v187, v187, v197
    v_cvt_pk_bf16_f32 v184, v184, v185
    v_mfma_f32_16x16x32_bf16 v[180:183], v[240:243], v[216:219], v[180:183]
    ds_read_b128 v[216:219], v2 offset:19456
    v_cvt_pk_bf16_f32 v185, v186, v187
    v_mfma_f32_16x16x32_bf16 v[172:175], v[244:247], v[220:223], v[172:175]
    v_cvt_pk_bf16_f32 v186, v188, v189
    v_cvt_pk_bf16_f32 v187, v190, v191
    v_mfma_f32_16x16x32_bf16 v[176:179], v[248:251], v[220:223], v[176:179]
    v_exp_f32 v111, v111
    v_mfma_f32_16x16x32_bf16 v[180:183], v[252:255], v[220:223], v[180:183]
    ds_read_b128 v[220:223], v2 offset:20480
    v_cmp_eq_u32 vcc, 2, v7
    v_mfma_f32_16x16x32_bf16 v[188:191], v[88:91], v[104:107], 0
    v_cvt_pk_bf16_f32 v172, v172, v173
    v_cvt_pk_bf16_f32 v173, v174, v175
    v_mfma_f32_16x16x32_bf16 v[188:191], v[92:95], v[112:115], v[188:191]
    v_cvt_pk_bf16_f32 v174, v176, v177
    v_cvt_pk_bf16_f32 v175, v178, v179
    s_waitcnt lgkmcnt(2)
    v_mfma_f32_16x16x32_bf16 v[176:179], a[220:223], v[212:215], 0
    s_waitcnt lgkmcnt(1)
    v_cvt_pk_bf16_f32 v180, v180, v181
    v_cvt_pk_bf16_f32 v181, v182, v183
    v_mfma_f32_16x16x32_bf16 v[176:179], a[232:235], v[216:219], v[176:179]
    v_add_u32 v182, v13, v10
    v_and_b32 v19, 15, v19
    v_mfma_f32_16x16x32_bf16 v[116:119], v[48:51], v[72:75], v[116:119]
    s_waitcnt lgkmcnt(0)
    v_mov_b32 v7, 16
    v_cndmask_b32 v19, v7, v19, vcc
    v_mfma_f32_16x16x32_bf16 v[176:179], a[244:247], v[220:223], v[176:179]
    v_lshlrev_b32 v19, 2, v19
    v_add_u32 v7, s49, v19
    v_mfma_f32_16x16x32_bf16 v[116:119], v[52:55], v[76:79], v[116:119]
    buffer_store_dwordx4 v[172:175], v13, s[36:39], 0 offen sc1
    s_mov_b32 exec_lo, 0x10001
    s_mov_b32 exec_hi, 0x10001
    ds_write_b64 v4, v[192:193]
    s_mov_b64 exec, -1
    v_mfma_f32_16x16x32_bf16 v[192:195], v[96:99], v[120:123], 0
    ds_read_b128 v[120:123], v5 offset:6144
    v_lshrrev_b32 v19, 4, v2
    v_mfma_f32_16x16x32_bf16 v[172:175], a[216:219], v[212:215], 0
    v_exp_f32 v116, v116
    v_mfma_f32_16x16x32_bf16 v[192:195], v[100:103], v[128:131], v[192:195]
    ds_read_b128 v[128:131], v5 offset:8192
    v_subrev_u32 v19, 0x1500, v19
    v_mfma_f32_16x16x32_bf16 v[172:175], a[228:231], v[216:219], v[172:175]
    buffer_store_dwordx2 v[180:181], v182, s[36:39], 0 offen sc1
    v_mfma_f32_16x16x32_bf16 v[180:183], a[224:227], v[212:215], 0
    ds_read_b128 v[212:215], v2 offset:21504
    v_mfma_f32_16x16x32_bf16 v[180:183], a[236:239], v[216:219], v[180:183]
    s_waitcnt lgkmcnt(2)
    ds_read_b128 v[216:219], v2 offset:22528
    v_mul_f32 v192, v192, v197
    v_mfma_f32_16x16x32_bf16 v[172:175], a[240:243], v[220:223], v[172:175]
    v_mul_f32 v193, v193, v197
    v_mul_f32 v194, v194, v197
    v_mfma_f32_16x16x32_bf16 v[180:183], a[248:251], v[220:223], v[180:183]
    s_waitcnt lgkmcnt(2)
    ds_read_b128 v[220:223], v2 offset:23552
    v_mul_f32 v195, v195, v197
    v_mfma_f32_16x16x32_bf16 v[120:123], v[24:27], v[56:59], v[120:123]
    v_cvt_pk_bf16_f32 v192, v192, v193
    v_cvt_pk_bf16_f32 v193, v194, v195
    v_mfma_f32_16x16x32_bf16 v[128:131], v[40:43], v[56:59], v[128:131]
    ds_write_b128 v3, v[184:187] offset:24576
    v_mfma_f32_16x16x32_bf16 v[120:123], v[28:31], v[60:63], v[120:123]
    s_waitcnt lgkmcnt(2)
    v_mfma_f32_16x16x32_bf16 v[128:131], v[44:47], v[60:63], v[128:131]
    v_mov_b32 v62, v15
    v_mfma_f32_16x16x32_bf16 v[196:199], v[20:23], v[104:107], 0
    ds_write_b64 v4, v[192:193] offset:24576
    v_mfma_f32_16x16x32_bf16 v[184:187], v[80:83], v[104:107], 0
    v_mfma_f32_16x16x32_bf16 v[192:195], v[96:99], v[104:107], 0
    ds_read_b128 v[104:107], v6
    v_mfma_f32_16x16x32_bf16 v[172:175], a[252:255], v[212:215], v[172:175]
    v_exp_f32 v120, v120
    v_mfma_f32_16x16x32_bf16 v[176:179], v[224:227], v[212:215], v[176:179]
    v_exp_f32 v121, v121
    v_mfma_f32_16x16x32_bf16 v[180:183], v[228:231], v[212:215], v[180:183]
    v_exp_f32 v122, v122
    v_mfma_f32_16x16x32_bf16 v[196:199], v[20:23], v[112:115], v[196:199]
    v_exp_f32 v123, v123
    v_mfma_f32_16x16x32_bf16 v[172:175], v[232:235], v[216:219], v[172:175]
    s_waitcnt lgkmcnt(1)
    v_cvt_pk_bf16_f32 v120, v120, v121
    v_cvt_pk_bf16_f32 v121, v122, v123
    s_waitcnt lgkmcnt(0)
    v_mfma_f32_16x16x32_bf16 v[104:107], v[24:27], v[72:75], v[104:107]
    v_exp_f32 v128, v128
    v_mfma_f32_16x16x32_bf16 v[104:107], v[28:31], v[76:79], v[104:107]
    v_rcp_f32 v197, v196
    v_mfma_f32_16x16x32_bf16 v[184:187], v[84:87], v[112:115], v[184:187]
    v_exp_f32 v129, v129
    v_mfma_f32_16x16x32_bf16 v[176:179], v[236:239], v[216:219], v[176:179]
    v_exp_f32 v130, v130
    v_mfma_f32_16x16x32_bf16 v[180:183], v[240:243], v[216:219], v[180:183]
    v_exp_f32 v131, v131
    v_mfma_f32_16x16x32_bf16 v[192:195], v[100:103], v[112:115], v[192:195]
    v_cvt_pk_bf16_f32 v122, v124, v125
    v_cvt_pk_bf16_f32 v123, v126, v127
    v_mfma_f32_16x16x32_bf16 v[172:175], v[244:247], v[220:223], v[172:175]
    v_mul_f32 v184, v184, v197
    v_mul_f32 v185, v185, v197
    v_mfma_f32_16x16x32_bf16 v[176:179], v[248:251], v[220:223], v[176:179]
    v_mul_f32 v186, v186, v197
    v_mul_f32 v187, v187, v197
    v_mfma_f32_16x16x32_bf16 v[180:183], v[252:255], v[220:223], v[180:183]
    v_cvt_pk_bf16_f32 v184, v184, v185
    v_mul_f32 v188, v188, v197
    v_cvt_pk_bf16_f32 v172, v172, v173
    v_cvt_pk_bf16_f32 v173, v174, v175
    v_mul_f32 v189, v189, v197
    v_cvt_pk_bf16_f32 v174, v176, v177
    v_cvt_pk_bf16_f32 v175, v178, v179
    v_mfma_f32_16x16x32_bf16 v[176:179], v[200:203], a[76:79], 0
    v_cvt_pk_bf16_f32 v180, v180, v181
    v_cvt_pk_bf16_f32 v181, v182, v183
    v_mfma_f32_16x16x32_bf16 v[176:179], v[204:207], a[88:91], v[176:179]
    v_add_u32 v182, v14, v10
    v_mul_f32 v190, v190, v197
    v_mfma_f32_16x16x32_bf16 v[176:179], v[208:211], a[100:103], v[176:179]
    buffer_store_dwordx4 v[172:175], v14, s[36:39], 0 offen sc1
    v_mul_f32 v191, v191, v197
    v_cvt_pk_bf16_f32 v185, v186, v187
    v_mfma_f32_16x16x32_bf16 v[172:175], v[200:203], a[72:75], 0
    v_max3_f32 v18, v18, v196, v197
    v_mul_f32 v192, v192, v197
    v_mfma_f32_16x16x32_bf16 v[172:175], v[204:207], a[84:87], v[172:175]
    v_mul_f32 v193, v193, v197
    v_mul_f32 v194, v194, v197
    v_mfma_f32_16x16x32_bf16 v[172:175], v[208:211], a[96:99], v[172:175]
    buffer_store_dwordx2 v[180:181], v182, s[36:39], 0 offen sc1
    v_mfma_f32_16x16x32_bf16 v[180:183], v[200:203], a[80:83], 0
    ds_read_b128 v[200:203], v1 offset:8192
    v_mul_f32 v195, v195, v197
    v_mfma_f32_16x16x32_bf16 v[196:199], v[20:23], v[120:123], 0
    v_cvt_pk_bf16_f32 v186, v188, v189
    v_cvt_pk_bf16_f32 v187, v190, v191
    v_mfma_f32_16x16x32_bf16 v[188:191], v[88:91], v[120:123], 0
    v_cvt_pk_bf16_f32 v128, v128, v129
    v_cvt_pk_bf16_f32 v192, v192, v193
    v_mfma_f32_16x16x32_bf16 v[180:183], v[204:207], a[92:95], v[180:183]
    ds_read_b128 v[204:207], v0 offset:10240
    v_cvt_pk_bf16_f32 v129, v130, v131
    v_mfma_f32_16x16x32_bf16 v[180:183], v[208:211], a[104:107], v[180:183]
    ds_read_b128 v[208:211], v1 offset:10240
    v_cvt_pk_bf16_f32 v193, v194, v195
    v_cvt_pk_bf16_f32 v130, v132, 0
    v_mov_b32 v131, 0
    v_cvt_pk_bf16_f32 v24, v136, v137
    s_waitcnt lgkmcnt(2)
    v_mfma_f32_16x16x32_bf16 v[160:163], a[36:39], v[200:203], v[160:163]
    v_exp_f32 v104, v104
    v_mfma_f32_16x16x32_bf16 v[196:199], v[20:23], v[128:131], v[196:199]
    v_exp_f32 v105, v105
    v_mfma_f32_16x16x32_bf16 v[188:191], v[92:95], v[128:131], v[188:191]
    v_exp_f32 v106, v106
    v_mfma_f32_16x16x32_bf16 v[164:167], a[40:43], v[200:203], v[164:167]
    s_waitcnt lgkmcnt(1)
    v_exp_f32 v107, v107
    v_mfma_f32_16x16x32_bf16 v[168:171], a[44:47], v[200:203], v[168:171]
    v_cvt_pk_bf16_f32 v104, v104, v105
    v_cvt_pk_bf16_f32 v105, v106, v107
    v_mfma_f32_16x16x32_bf16 v[172:175], v[200:203], a[108:111], v[172:175]
    v_rcp_f32 v197, v196
    v_mfma_f32_16x16x32_bf16 v[176:179], v[200:203], a[112:115], v[176:179]
    v_mul_f32 v188, v188, v197
    v_mul_f32 v189, v189, v197
    v_mfma_f32_16x16x32_bf16 v[180:183], v[200:203], a[116:119], v[180:183]
    ds_read_b128 v[200:203], v0 offset:12288
    v_mul_f32 v190, v190, v197
    v_mfma_f32_16x16x32_bf16 v[160:163], a[48:51], v[204:207], v[160:163]
    s_waitcnt lgkmcnt(1)
    v_mul_f32 v191, v191, v197
    v_cvt_pk_bf16_f32 v106, v108, v109
    v_mfma_f32_16x16x32_bf16 v[164:167], a[52:55], v[204:207], v[164:167]
    v_cvt_pk_bf16_f32 v107, v110, v111
    v_cvt_pk_bf16_f32 v25, v138, v139
    v_mfma_f32_16x16x32_bf16 v[168:171], a[56:59], v[204:207], v[168:171]
    v_cvt_pk_bf16_f32 v26, v140, v141
    v_cvt_pk_bf16_f32 v27, v142, v143
    v_mfma_f32_16x16x32_bf16 v[172:175], v[204:207], a[120:123], v[172:175]
    v_cvt_pk_bf16_f32 v28, v144, v145
    v_cvt_pk_bf16_f32 v29, v146, v147
    v_mfma_f32_16x16x32_bf16 v[176:179], v[204:207], a[124:127], v[176:179]
    ds_read_b128 v[112:115], v6 offset:128
    ds_read_b128 v[124:127], v5 offset:1024
    v_mfma_f32_16x16x32_bf16 v[180:183], v[204:207], a[128:131], v[180:183]
    s_waitcnt lgkmcnt(2)
    ds_read_b128 v[204:207], v1 offset:12288
    v_max3_f32 v18, v18, v196, v197
    v_mfma_f32_16x16x32_bf16 v[160:163], a[60:63], v[208:211], v[160:163]
    ds_read_b32 v132, v7 offset:9216
    ds_read_b128 v[108:111], v5 offset:4096
    v_mfma_f32_16x16x32_bf16 v[164:167], a[64:67], v[208:211], v[164:167]
    v_mfma_f32_16x16x32_bf16 v[168:171], a[68:71], v[208:211], v[168:171]
    ds_write_b128 v3, v[184:187] offset:30720
    v_mfma_f32_16x16x32_bf16 v[184:187], v[80:83], v[120:123], 0
    s_waitcnt lgkmcnt(5)
    v_mfma_f32_16x16x32_bf16 v[184:187], v[84:87], v[128:131], v[184:187]
    v_cvt_pk_bf16_f32 v32, v160, v161
    v_cvt_pk_bf16_f32 v33, v162, v163
    v_mfma_f32_16x16x32_bf16 v[172:175], v[208:211], a[132:135], v[172:175]
    v_cvt_pk_bf16_f32 v34, v164, v165
    v_cvt_pk_bf16_f32 v35, v166, v167
    v_mfma_f32_16x16x32_bf16 v[176:179], v[208:211], a[136:139], v[176:179]
    v_cvt_pk_bf16_f32 v36, v168, v169
    v_cvt_pk_bf16_f32 v37, v170, v171
    v_mfma_f32_16x16x32_bf16 v[180:183], v[208:211], a[140:143], v[180:183]
    ds_read_b128 v[208:211], v0 offset:14336
    v_mul_f32 v184, v184, v197
    v_mfma_f32_16x16x32_bf16 v[136:139], a[0:3], v[200:203], 0
    s_waitcnt lgkmcnt(2)
    v_mul_f32 v185, v185, v197
    v_mul_f32 v186, v186, v197
    v_mfma_f32_16x16x32_bf16 v[140:143], a[4:7], v[200:203], 0
    v_mul_f32 v187, v187, v197
    v_cvt_pk_bf16_f32 v184, v184, v185
    v_mfma_f32_16x16x32_bf16 v[144:147], a[8:11], v[200:203], 0
    v_cvt_pk_bf16_f32 v185, v186, v187
    v_cvt_pk_bf16_f32 v186, v188, v189
    v_mfma_f32_16x16x32_bf16 v[136:139], a[12:15], v[204:207], v[136:139]
    v_cvt_pk_bf16_f32 v187, v190, v191
    v_mfma_f32_16x16x32_bf16 v[188:191], v[88:91], v[104:107], 0
    v_cvt_pk_bf16_f32 v88, v152, v153
    v_cvt_pk_bf16_f32 v89, v154, v155
    v_mfma_f32_16x16x32_bf16 v[152:155], v[200:203], a[76:79], 0
    s_waitcnt lgkmcnt(0)
    v_cvt_pk_bf16_f32 v90, v176, v177
    v_cvt_pk_bf16_f32 v91, v178, v179
    v_mfma_f32_16x16x32_bf16 v[140:143], a[16:19], v[204:207], v[140:143]
    ds_write_b64 v4, v[192:193] offset:30720
    v_mfma_f32_16x16x32_bf16 v[192:195], v[96:99], v[120:123], 0
    ds_read_b128 v[120:123], v5
    v_mfma_f32_16x16x32_bf16 v[192:195], v[100:103], v[128:131], v[192:195]
    ds_read_b128 v[128:131], v5 offset:2048
    v_mfma_f32_16x16x32_bf16 v[144:147], a[20:23], v[204:207], v[144:147]
    ds_write_b128 v3, v[184:187] offset:36864
    v_mfma_f32_16x16x32_bf16 v[184:187], v[80:83], v[104:107], 0
    v_cvt_pk_bf16_f32 v80, v148, v149
    v_cvt_pk_bf16_f32 v81, v150, v151
    v_mfma_f32_16x16x32_bf16 v[148:151], v[200:203], a[72:75], 0
    v_cvt_pk_bf16_f32 v82, v172, v173
    v_mul_f32 v192, v192, v197
    v_mfma_f32_16x16x32_bf16 v[152:155], v[204:207], a[88:91], v[152:155]
    v_mul_f32 v193, v193, v197
    v_mul_f32 v194, v194, v197
    v_mfma_f32_16x16x32_bf16 v[148:151], v[204:207], a[84:87], v[148:151]
    v_mul_f32 v195, v195, v197
    v_cvt_pk_bf16_f32 v192, v192, v193
    v_mfma_f32_16x16x32_bf16 v[136:139], a[24:27], v[208:211], v[136:139]
    v_cvt_pk_bf16_f32 v193, v194, v195
    v_cvt_pk_bf16_f32 v83, v174, v175
    v_mfma_f32_16x16x32_bf16 v[140:143], a[28:31], v[208:211], v[140:143]
    ds_write_b64 v4, v[192:193] offset:36864
    v_mfma_f32_16x16x32_bf16 v[192:195], v[96:99], v[104:107], 0
    v_cvt_pk_bf16_f32 v96, v156, v157
    v_cvt_pk_bf16_f32 v97, v158, v159
    v_mfma_f32_16x16x32_bf16 v[156:159], v[200:203], a[80:83], 0
    ds_read_b128 v[200:203], v1 offset:14336
    v_cvt_pk_bf16_f32 v98, v180, v181
    v_mfma_f32_16x16x32_bf16 v[156:159], v[204:207], a[92:95], v[156:159]
    ds_read_b128 v[204:207], v0 offset:16384
    v_cvt_pk_bf16_f32 v99, v182, v183
    v_mfma_f32_16x16x32_bf16 v[144:147], a[32:35], v[208:211], v[144:147]
    v_mfma_f32_16x16x32_bf16 v[152:155], v[208:211], a[100:103], v[152:155]
    v_mfma_f32_16x16x32_bf16 v[148:151], v[208:211], a[96:99], v[148:151]
    s_waitcnt lgkmcnt(2)
    s_barrier
    v_mfma_f32_16x16x32_bf16 v[156:159], v[208:211], a[104:107], v[156:159]
    s_waitcnt lgkmcnt(1)
    ds_read_b128 v[208:211], v1 offset:16384
    ds_read_b128 v[212:215], v2 offset:24576
    v_mfma_f32_16x16x32_bf16 v[136:139], a[36:39], v[200:203], v[136:139]
    s_waitcnt lgkmcnt(2)
    ds_read_b128 v[216:219], v2 offset:25600
    v_mfma_f32_16x16x32_bf16 v[140:143], a[40:43], v[200:203], v[140:143]
    ds_read_b128 v[220:223], v2 offset:26624
    v_mfma_f32_16x16x32_bf16 v[144:147], a[44:47], v[200:203], v[144:147]
    v_mfma_f32_16x16x32_bf16 v[152:155], v[200:203], a[112:115], v[152:155]
    v_mfma_f32_16x16x32_bf16 v[148:151], v[200:203], a[108:111], v[148:151]
    v_mfma_f32_16x16x32_bf16 v[156:159], v[200:203], a[116:119], v[156:159]
    ds_read_b128 v[200:203], v0
    v_mfma_f32_16x16x32_bf16 v[136:139], a[48:51], v[204:207], v[136:139]
    s_waitcnt lgkmcnt(3)
    v_mfma_f32_16x16x32_bf16 v[140:143], a[52:55], v[204:207], v[140:143]
    v_mfma_f32_16x16x32_bf16 v[144:147], a[56:59], v[204:207], v[144:147]
    v_mfma_f32_16x16x32_bf16 v[152:155], v[204:207], a[124:127], v[152:155]
    v_mfma_f32_16x16x32_bf16 v[148:151], v[204:207], a[120:123], v[148:151]
    v_mfma_f32_16x16x32_bf16 v[156:159], v[204:207], a[128:131], v[156:159]
    s_waitcnt lgkmcnt(0)
    ds_read_b128 v[204:207], v1
    v_mfma_f32_16x16x32_bf16 v[136:139], a[60:63], v[208:211], v[136:139]
    v_mfma_f32_16x16x32_bf16 v[140:143], a[64:67], v[208:211], v[140:143]
    v_mfma_f32_16x16x32_bf16 v[144:147], a[68:71], v[208:211], v[144:147]
    v_mfma_f32_16x16x32_bf16 v[152:155], v[208:211], a[136:139], v[152:155]
    v_mfma_f32_16x16x32_bf16 v[148:151], v[208:211], a[132:135], v[148:151]
    v_mfma_f32_16x16x32_bf16 v[156:159], v[208:211], a[140:143], v[156:159]
    ds_read_b128 v[208:211], v0 offset:2048
    v_mfma_f32_16x16x32_bf16 v[160:163], a[144:147], v[200:203], 0
    s_waitcnt lgkmcnt(1)
    v_mfma_f32_16x16x32_bf16 v[164:167], a[148:151], v[200:203], 0
    v_mfma_f32_16x16x32_bf16 v[168:171], a[152:155], v[200:203], 0
    ds_read_b128 v[200:203], v1 offset:2048
    v_mfma_f32_16x16x32_bf16 v[160:163], a[156:159], v[204:207], v[160:163]
    v_mfma_f32_16x16x32_bf16 v[164:167], a[160:163], v[204:207], v[164:167]
    v_mfma_f32_16x16x32_bf16 v[168:171], a[164:167], v[204:207], v[168:171]
    s_waitcnt lgkmcnt(1)
    ds_read_b128 v[204:207], v0 offset:4096
    v_mfma_f32_16x16x32_bf16 v[160:163], a[168:171], v[208:211], v[160:163]
    v_mfma_f32_16x16x32_bf16 v[164:167], a[172:175], v[208:211], v[164:167]
    v_mfma_f32_16x16x32_bf16 v[168:171], a[176:179], v[208:211], v[168:171]
    s_waitcnt lgkmcnt(1)
    ds_read_b128 v[208:211], v1 offset:4096
    v_mfma_f32_16x16x32_bf16 v[160:163], a[180:183], v[200:203], v[160:163]
    v_mfma_f32_16x16x32_bf16 v[164:167], a[184:187], v[200:203], v[164:167]
    v_mfma_f32_16x16x32_bf16 v[168:171], a[188:191], v[200:203], v[168:171]
    s_waitcnt lgkmcnt(1)
    ds_read_b128 v[200:203], v0 offset:6144
    v_mfma_f32_16x16x32_bf16 v[160:163], a[192:195], v[204:207], v[160:163]
    v_mfma_f32_16x16x32_bf16 v[164:167], a[196:199], v[204:207], v[164:167]
    v_mfma_f32_16x16x32_bf16 v[168:171], a[200:203], v[204:207], v[168:171]
    s_waitcnt lgkmcnt(1)
    ds_read_b128 v[204:207], v1 offset:6144
    v_mfma_f32_16x16x32_bf16 v[160:163], a[204:207], v[208:211], v[160:163]
    v_mfma_f32_16x16x32_bf16 v[164:167], a[208:211], v[208:211], v[164:167]
    v_mfma_f32_16x16x32_bf16 v[168:171], a[212:215], v[208:211], v[168:171]
    ds_read_b128 v[208:211], v0 offset:8192
    v_mfma_f32_16x16x32_bf16 v[172:175], a[216:219], v[212:215], 0
    v_mfma_f32_16x16x32_bf16 v[176:179], a[220:223], v[212:215], 0
    v_mfma_f32_16x16x32_bf16 v[180:183], a[224:227], v[212:215], 0
    ds_read_b128 v[212:215], v2 offset:27648
    v_mfma_f32_16x16x32_bf16 v[172:175], a[228:231], v[216:219], v[172:175]
    v_mul_f32 v160, s43, v160
    v_mul_f32 v161, s43, v161
    v_mfma_f32_16x16x32_bf16 v[176:179], a[232:235], v[216:219], v[176:179]
    v_mul_f32 v162, s43, v162
    v_mul_f32 v163, s43, v163
    v_mfma_f32_16x16x32_bf16 v[180:183], a[236:239], v[216:219], v[180:183]
    v_mul_f32 v164, s43, v164
    v_mul_f32 v165, s43, v165
    v_mfma_f32_16x16x32_bf16 v[172:175], a[240:243], v[220:223], v[172:175]
    v_mul_f32 v166, s43, v166
    v_mul_f32 v167, s43, v167
    v_mfma_f32_16x16x32_bf16 v[176:179], a[244:247], v[220:223], v[176:179]
    v_mul_f32 v168, s43, v168
    v_mul_f32 v169, s43, v169
    v_mfma_f32_16x16x32_bf16 v[180:183], a[248:251], v[220:223], v[180:183]
    s_waitcnt lgkmcnt(0)
    v_mul_f32 v170, s43, v170
    v_mul_f32 v171, s43, v171
    v_mfma_f32_16x16x32_bf16 v[112:115], v[40:43], v[72:75], v[112:115]
    v_cvt_pk_bf16_f32 v56, v160, v161
    v_cvt_pk_bf16_f32 v57, v162, v163
    v_mfma_f32_16x16x32_bf16 v[160:163], a[144:147], v[200:203], 0
    v_cvt_pk_bf16_f32 v58, v164, v165
    v_cvt_pk_bf16_f32 v59, v166, v167
    v_mfma_f32_16x16x32_bf16 v[164:167], a[148:151], v[200:203], 0
    v_cvt_pk_bf16_f32 v60, v168, v169
    v_cvt_pk_bf16_f32 v61, v170, v171
    v_mfma_f32_16x16x32_bf16 v[168:171], a[152:155], v[200:203], 0
    ds_read_b128 v[200:203], v1 offset:8192
    ds_read_b128 v[216:219], v2 offset:28672
    v_mfma_f32_16x16x32_bf16 v[160:163], a[156:159], v[204:207], v[160:163]
    ds_read_b128 v[220:223], v2 offset:29696
    v_cvt_pk_bf16_f32 v40, v136, v137
    v_mfma_f32_16x16x32_bf16 v[164:167], a[160:163], v[204:207], v[164:167]
    v_cvt_pk_bf16_f32 v41, v138, v139
    v_cvt_pk_bf16_f32 v42, v140, v141
    v_mfma_f32_16x16x32_bf16 v[168:171], a[164:167], v[204:207], v[168:171]
    ds_read_b128 v[204:207], v0 offset:10240
    v_cvt_pk_bf16_f32 v43, v142, v143
    v_mfma_f32_16x16x32_bf16 v[160:163], a[168:171], v[208:211], v[160:163]
    v_mfma_f32_16x16x32_bf16 v[164:167], a[172:175], v[208:211], v[164:167]
    v_mfma_f32_16x16x32_bf16 v[168:171], a[176:179], v[208:211], v[168:171]
    s_waitcnt lgkmcnt(3)
    ds_read_b128 v[208:211], v1 offset:10240
    v_mfma_f32_16x16x32_bf16 v[160:163], a[180:183], v[200:203], v[160:163]
    v_mfma_f32_16x16x32_bf16 v[164:167], a[184:187], v[200:203], v[164:167]
    v_mfma_f32_16x16x32_bf16 v[168:171], a[188:191], v[200:203], v[168:171]
    s_waitcnt lgkmcnt(1)
    ds_read_b128 v[200:203], v0 offset:12288
    v_mfma_f32_16x16x32_bf16 v[160:163], a[192:195], v[204:207], v[160:163]
    v_mfma_f32_16x16x32_bf16 v[164:167], a[196:199], v[204:207], v[164:167]
    v_mfma_f32_16x16x32_bf16 v[168:171], a[200:203], v[204:207], v[168:171]
    s_waitcnt lgkmcnt(1)
    ds_read_b128 v[204:207], v1 offset:12288
    v_mfma_f32_16x16x32_bf16 v[160:163], a[204:207], v[208:211], v[160:163]
    v_mfma_f32_16x16x32_bf16 v[164:167], a[208:211], v[208:211], v[164:167]
    v_mfma_f32_16x16x32_bf16 v[168:171], a[212:215], v[208:211], v[168:171]
    ds_read_b128 v[208:211], v0 offset:14336
    v_mfma_f32_16x16x32_bf16 v[172:175], a[252:255], v[212:215], v[172:175]
    v_mfma_f32_16x16x32_bf16 v[176:179], v[224:227], v[212:215], v[176:179]
    v_mfma_f32_16x16x32_bf16 v[180:183], v[228:231], v[212:215], v[180:183]
    ds_read_b128 v[212:215], v2 offset:30720
    v_mfma_f32_16x16x32_bf16 v[112:115], v[44:47], v[76:79], v[112:115]
    v_mul_f32 v160, s43, v160
    v_mul_f32 v161, s43, v161
    v_mfma_f32_16x16x32_bf16 v[172:175], v[232:235], v[216:219], v[172:175]
    v_mul_f32 v162, s43, v162
    v_mul_f32 v163, s43, v163
    v_mfma_f32_16x16x32_bf16 v[176:179], v[236:239], v[216:219], v[176:179]
    v_mul_f32 v164, s43, v164
    v_mul_f32 v165, s43, v165
    v_mfma_f32_16x16x32_bf16 v[180:183], v[240:243], v[216:219], v[180:183]
    ds_read_b128 v[216:219], v2 offset:31744
    v_mul_f32 v166, s43, v166
    v_mfma_f32_16x16x32_bf16 v[172:175], v[244:247], v[220:223], v[172:175]
    v_mul_f32 v167, s43, v167
    v_mul_f32 v168, s43, v168
    v_mfma_f32_16x16x32_bf16 v[176:179], v[248:251], v[220:223], v[176:179]
    v_mul_f32 v169, s43, v169
    v_mul_f32 v170, s43, v170
    v_mfma_f32_16x16x32_bf16 v[180:183], v[252:255], v[220:223], v[180:183]
    ds_read_b128 v[220:223], v2 offset:32768
    v_mul_f32 v171, s43, v171
    v_mfma_f32_16x16x32_bf16 v[120:123], v[24:27], v[56:59], v[120:123]
    v_cvt_pk_bf16_f32 v64, v160, v161
    v_cvt_pk_bf16_f32 v65, v162, v163
    s_waitcnt lgkmcnt(5)
    v_mfma_f32_16x16x32_bf16 v[160:163], a[144:147], v[200:203], 0
    s_waitcnt lgkmcnt(1)
    v_cvt_pk_bf16_f32 v66, v164, v165
    v_cvt_pk_bf16_f32 v67, v166, v167
    v_mfma_f32_16x16x32_bf16 v[164:167], a[148:151], v[200:203], 0
    v_cvt_pk_bf16_f32 v68, v168, v169
    v_cvt_pk_bf16_f32 v69, v170, v171
    v_mfma_f32_16x16x32_bf16 v[168:171], a[152:155], v[200:203], 0
    v_cvt_pk_bf16_f32 v172, v172, v173
    v_cvt_pk_bf16_f32 v173, v174, v175
    v_mfma_f32_16x16x32_bf16 v[160:163], a[156:159], v[204:207], v[160:163]
    ds_read_b128 v[200:203], v1 offset:14336
    v_cvt_pk_bf16_f32 v180, v180, v181
    v_mfma_f32_16x16x32_bf16 v[164:167], a[160:163], v[204:207], v[164:167]
    v_cvt_pk_bf16_f32 v174, v176, v177
    v_cvt_pk_bf16_f32 v175, v178, v179
    v_mfma_f32_16x16x32_bf16 v[168:171], a[164:167], v[204:207], v[168:171]
    v_cvt_pk_bf16_f32 v181, v182, v183
    v_add_u32 v182, v12, v10
    v_mfma_f32_16x16x32_bf16 v[160:163], a[168:171], v[208:211], v[160:163]
    ds_read_b128 v[204:207], v0 offset:16384
    v_cvt_pk_bf16_f32 v44, v144, v145
    v_mfma_f32_16x16x32_bf16 v[164:167], a[172:175], v[208:211], v[164:167]
    v_exp_f32 v112, v112
    v_mfma_f32_16x16x32_bf16 v[168:171], a[176:179], v[208:211], v[168:171]
    ds_read_b128 v[208:211], v1 offset:16384
    v_cvt_pk_bf16_f32 v45, v146, v147
    v_mfma_f32_16x16x32_bf16 v[176:179], a[220:223], v[212:215], 0
    s_waitcnt lgkmcnt(2)
    v_exp_f32 v113, v113
    v_mfma_f32_16x16x32_bf16 v[176:179], a[232:235], v[216:219], v[176:179]
    v_exp_f32 v114, v114
    v_mfma_f32_16x16x32_bf16 v[176:179], a[244:247], v[220:223], v[176:179]
    v_exp_f32 v115, v115
    v_mfma_f32_16x16x32_bf16 v[160:163], a[180:183], v[200:203], v[160:163]
    s_waitcnt lgkmcnt(1)
    v_cvt_pk_bf16_f32 v112, v112, v113
    v_cvt_pk_bf16_f32 v113, v114, v115
    v_mfma_f32_16x16x32_bf16 v[164:167], a[184:187], v[200:203], v[164:167]
    v_cvt_pk_bf16_f32 v114, v116, 0
    v_mov_b32 v115, 0
    v_mfma_f32_16x16x32_bf16 v[168:171], a[188:191], v[200:203], v[168:171]
    s_waitcnt lgkmcnt(0)
    s_waitcnt vmcnt(5)
    s_barrier
    v_mfma_f32_16x16x32_bf16 v[184:187], v[84:87], v[112:115], v[184:187]
    ds_read_b128 v[200:203], v0 offset:18432
    v_cvt_pk_bf16_f32 v84, v148, v149
    v_mfma_f32_16x16x32_bf16 v[188:191], v[92:95], v[112:115], v[188:191]
    v_cvt_pk_bf16_f32 v85, v150, v151
    v_cvt_pk_bf16_f32 v92, v152, v153
    v_mfma_f32_16x16x32_bf16 v[192:195], v[100:103], v[112:115], v[192:195]
    v_cvt_pk_bf16_f32 v93, v154, v155
    v_cvt_pk_bf16_f32 v100, v156, v157
    v_mfma_f32_16x16x32_bf16 v[124:127], v[32:35], v[56:59], v[124:127]
    v_cvt_pk_bf16_f32 v101, v158, v159
    v_mfma_f32_16x16x32_bf16 v[128:131], v[40:43], v[56:59], v[128:131]
    ds_read_b32 v116, v7 offset:9296
    v_mfma_f32_16x16x32_bf16 v[120:123], v[28:31], v[60:63], v[120:123]
    buffer_store_dwordx4 v[172:175], v12, s[36:39], s53 offen sc1
    v_mfma_f32_16x16x32_bf16 v[160:163], a[192:195], v[204:207], v[160:163]
    s_waitcnt lgkmcnt(1)
    v_mfma_f32_16x16x32_bf16 v[172:175], a[216:219], v[212:215], 0
    v_mfma_f32_16x16x32_bf16 v[172:175], a[228:231], v[216:219], v[172:175]
    v_mfma_f32_16x16x32_bf16 v[172:175], a[240:243], v[220:223], v[172:175]
    s_waitcnt lgkmcnt(0)
    v_mfma_f32_16x16x32_bf16 v[164:167], a[196:199], v[204:207], v[164:167]
    v_exp_f32 v120, v120
    v_mfma_f32_16x16x32_bf16 v[168:171], a[200:203], v[204:207], v[168:171]
    ds_read_b128 v[204:207], v1 offset:18432
    v_mfma_f32_16x16x32_bf16 v[132:135], v[48:51], v[56:59], v[132:135]
    v_exp_f32 v121, v121
    v_mfma_f32_16x16x32_bf16 v[124:127], v[36:39], v[60:63], v[124:127]
    v_exp_f32 v122, v122
    v_mfma_f32_16x16x32_bf16 v[128:131], v[44:47], v[60:63], v[128:131]
    v_exp_f32 v123, v123
    v_mfma_f32_16x16x32_bf16 v[160:163], a[204:207], v[208:211], v[160:163]
    v_cvt_pk_bf16_f32 v120, v120, v121
    v_cvt_pk_bf16_f32 v121, v122, v123
    v_mfma_f32_16x16x32_bf16 v[164:167], a[208:211], v[208:211], v[164:167]
    buffer_store_dwordx2 v[180:181], v182, s[36:39], s53 offen sc1
    v_mfma_f32_16x16x32_bf16 v[180:183], a[224:227], v[212:215], 0
    ds_read_b128 v[212:215], v2 offset:33792
    v_mfma_f32_16x16x32_bf16 v[180:183], a[236:239], v[216:219], v[180:183]
    ds_read_b128 v[216:219], v2 offset:34816
    v_mul_f32 v160, s43, v160
    v_mfma_f32_16x16x32_bf16 v[180:183], a[248:251], v[220:223], v[180:183]
    ds_read_b128 v[220:223], v2 offset:35840
    v_mul_f32 v161, s43, v161
    v_mfma_f32_16x16x32_bf16 v[168:171], a[212:215], v[208:211], v[168:171]
    ds_read_b128 v[208:211], v0 offset:20480
    v_mul_f32 v162, s43, v162
    v_mfma_f32_16x16x32_bf16 v[132:135], v[52:55], v[60:63], v[132:135]
    v_exp_f32 v124, v124
    v_mfma_f32_16x16x32_bf16 v[196:199], v[20:23], v[104:107], 0
    ds_read_b128 v[104:107], v5 offset:3072
    v_mul_f32 v163, s43, v163
    s_waitcnt lgkmcnt(4)
    v_mfma_f32_16x16x32_bf16 v[172:175], a[252:255], v[212:215], v[172:175]
    s_waitcnt lgkmcnt(3)
    v_exp_f32 v125, v125
    v_mfma_f32_16x16x32_bf16 v[176:179], v[224:227], v[212:215], v[176:179]
    v_exp_f32 v126, v126
    v_mfma_f32_16x16x32_bf16 v[180:183], v[228:231], v[212:215], v[180:183]
    ds_read_b128 v[212:215], v2 offset:36864
    v_cvt_pk_bf16_f32 v122, v124, v125
    v_mfma_f32_16x16x32_bf16 v[172:175], v[232:235], v[216:219], v[172:175]
    s_waitcnt lgkmcnt(2)
    v_exp_f32 v127, v127
    v_mfma_f32_16x16x32_bf16 v[176:179], v[236:239], v[216:219], v[176:179]
    s_waitcnt lgkmcnt(1)
    v_exp_f32 v128, v128
    v_mfma_f32_16x16x32_bf16 v[180:183], v[240:243], v[216:219], v[180:183]
    ds_read_b128 v[216:219], v2 offset:37888
    v_cvt_pk_bf16_f32 v123, v126, v127
    v_mfma_f32_16x16x32_bf16 v[172:175], v[244:247], v[220:223], v[172:175]
    v_exp_f32 v129, v129
    v_mfma_f32_16x16x32_bf16 v[176:179], v[248:251], v[220:223], v[176:179]
    v_exp_f32 v130, v130
    v_mfma_f32_16x16x32_bf16 v[180:183], v[252:255], v[220:223], v[180:183]
    ds_read_b128 v[220:223], v2 offset:38912
    v_cvt_pk_bf16_f32 v128, v128, v129
    v_mfma_f32_16x16x32_bf16 v[104:107], v[24:27], v[64:67], v[104:107]
    v_exp_f32 v131, v131
    v_mfma_f32_16x16x32_bf16 v[196:199], v[20:23], v[112:115], v[196:199]
    v_cvt_pk_bf16_f32 v172, v172, v173
    v_cvt_pk_bf16_f32 v173, v174, v175
    v_mfma_f32_16x16x32_bf16 v[108:111], v[32:35], v[64:67], v[108:111]
    v_cvt_pk_bf16_f32 v180, v180, v181
    v_cvt_pk_bf16_f32 v174, v176, v177
    v_mfma_f32_16x16x32_bf16 v[104:107], v[28:31], v[68:71], v[104:107]
    v_cvt_pk_bf16_f32 v175, v178, v179
    v_cvt_pk_bf16_f32 v181, v182, v183
    v_mfma_f32_16x16x32_bf16 v[108:111], v[36:39], v[68:71], v[108:111]
    s_waitcnt lgkmcnt(1)
    v_add_u32 v182, v13, v10
    v_cvt_pk_bf16_f32 v129, v130, v131
    v_mfma_f32_16x16x32_bf16 v[136:139], a[0:3], v[200:203], 0
    ds_read_b128 v[112:115], v5 offset:5120
    v_mov_b32 v131, 0
    v_mfma_f32_16x16x32_bf16 v[140:143], a[4:7], v[200:203], 0
    v_rcp_f32 v197, v196
    v_mfma_f32_16x16x32_bf16 v[144:147], a[8:11], v[200:203], 0
    v_mul_f32 v184, v184, v197
    v_mul_f32 v185, v185, v197
    v_mfma_f32_16x16x32_bf16 v[148:151], v[200:203], a[72:75], 0
    v_mul_f32 v186, v186, v197
    v_mul_f32 v187, v187, v197
    v_mfma_f32_16x16x32_bf16 v[152:155], v[200:203], a[76:79], 0
    v_cvt_pk_bf16_f32 v184, v184, v185
    v_mul_f32 v188, v188, v197
    v_mfma_f32_16x16x32_bf16 v[156:159], v[200:203], a[80:83], 0
    ds_read_b128 v[200:203], v1 offset:20480
    v_mul_f32 v189, v189, v197
    v_mfma_f32_16x16x32_bf16 v[136:139], a[12:15], v[204:207], v[136:139]
    s_waitcnt lgkmcnt(1)
    v_mul_f32 v190, v190, v197
    v_mul_f32 v191, v191, v197
    v_mfma_f32_16x16x32_bf16 v[112:115], v[40:43], v[64:67], v[112:115]
    v_mul_f32 v192, v192, v197
    v_mul_f32 v193, v193, v197
    v_mfma_f32_16x16x32_bf16 v[140:143], a[16:19], v[204:207], v[140:143]
    v_cvt_pk_bf16_f32 v185, v186, v187
    v_mul_f32 v194, v194, v197
    v_mfma_f32_16x16x32_bf16 v[144:147], a[20:23], v[204:207], v[144:147]
    v_mul_f32 v195, v195, v197
    v_cvt_pk_bf16_f32 v192, v192, v193
    v_mfma_f32_16x16x32_bf16 v[148:151], v[204:207], a[84:87], v[148:151]
    v_cvt_pk_bf16_f32 v186, v188, v189
    v_cvt_pk_bf16_f32 v187, v190, v191
    v_mfma_f32_16x16x32_bf16 v[152:155], v[204:207], a[88:91], v[152:155]
    v_cvt_pk_bf16_f32 v193, v194, v195
    v_max3_f32 v18, v18, v196, v197
    v_mfma_f32_16x16x32_bf16 v[156:159], v[204:207], a[92:95], v[156:159]
    ds_read_b128 v[204:207], v0 offset:22528
    ds_read_b128 v[124:127], v5 offset:7168
    v_mfma_f32_16x16x32_bf16 v[116:119], v[48:51], v[64:67], v[116:119]
    v_exp_f32 v132, v132
    v_mfma_f32_16x16x32_bf16 v[136:139], a[24:27], v[208:211], v[136:139]
    s_waitcnt lgkmcnt(2)
    v_cvt_pk_bf16_f32 v130, v132, 0
    v_mul_f32 v164, s43, v164
    v_mfma_f32_16x16x32_bf16 v[112:115], v[44:47], v[68:71], v[112:115]
    ds_read_b32 v132, v7 offset:9376
    v_mul_f32 v165, s43, v165
    v_mfma_f32_16x16x32_bf16 v[140:143], a[28:31], v[208:211], v[140:143]
    v_mul_f32 v166, s43, v166
    v_mul_f32 v167, s43, v167
    v_mfma_f32_16x16x32_bf16 v[144:147], a[32:35], v[208:211], v[144:147]
    v_mul_f32 v168, s43, v168
    v_mul_f32 v169, s43, v169
    v_mfma_f32_16x16x32_bf16 v[148:151], v[208:211], a[96:99], v[148:151]
    v_mul_f32 v170, s43, v170
    v_mul_f32 v171, s43, v171
    v_mfma_f32_16x16x32_bf16 v[152:155], v[208:211], a[100:103], v[152:155]
    v_cvt_pk_bf16_f32 v56, v160, v161
    v_cvt_pk_bf16_f32 v57, v162, v163
    v_mfma_f32_16x16x32_bf16 v[156:159], v[208:211], a[104:107], v[156:159]
    ds_read_b128 v[208:211], v1 offset:22528
    v_cvt_pk_bf16_f32 v58, v164, v165
    v_mfma_f32_16x16x32_bf16 v[188:191], v[88:91], v[120:123], 0
    v_cvt_pk_bf16_f32 v59, v166, v167
    v_cvt_pk_bf16_f32 v60, v168, v169
    v_mfma_f32_16x16x32_bf16 v[196:199], v[20:23], v[120:123], 0
    s_waitcnt lgkmcnt(1)
    v_cvt_pk_bf16_f32 v61, v170, v171
    v_mov_b32 v62, v16
    v_mfma_f32_16x16x32_bf16 v[116:119], v[52:55], v[68:71], v[116:119]
    v_exp_f32 v104, v104
    v_mfma_f32_16x16x32_bf16 v[176:179], a[220:223], v[212:215], 0
    v_exp_f32 v105, v105
    v_mfma_f32_16x16x32_bf16 v[188:191], v[92:95], v[128:131], v[188:191]
    v_exp_f32 v106, v106
    v_mfma_f32_16x16x32_bf16 v[196:199], v[20:23], v[128:131], v[196:199]
    v_exp_f32 v107, v107
    v_mfma_f32_16x16x32_bf16 v[176:179], a[232:235], v[216:219], v[176:179]
    v_exp_f32 v108, v108
    v_mfma_f32_16x16x32_bf16 v[176:179], a[244:247], v[220:223], v[176:179]
    v_exp_f32 v109, v109
    v_mfma_f32_16x16x32_bf16 v[124:127], v[32:35], v[56:59], v[124:127]
    v_exp_f32 v110, v110
    v_mfma_f32_16x16x32_bf16 v[132:135], v[48:51], v[56:59], v[132:135]
    v_rcp_f32 v197, v196
    v_mfma_f32_16x16x32_bf16 v[124:127], v[36:39], v[60:63], v[124:127]
    v_mul_f32 v188, v188, v197
    v_mul_f32 v189, v189, v197
    v_mfma_f32_16x16x32_bf16 v[132:135], v[52:55], v[60:63], v[132:135]
    v_mul_f32 v190, v190, v197
    v_mul_f32 v191, v191, v197
    v_mfma_f32_16x16x32_bf16 v[136:139], a[36:39], v[200:203], v[136:139]
    v_exp_f32 v111, v111
    v_mfma_f32_16x16x32_bf16 v[140:143], a[40:43], v[200:203], v[140:143]
    v_cvt_pk_bf16_f32 v104, v104, v105
    v_cvt_pk_bf16_f32 v105, v106, v107
    v_mfma_f32_16x16x32_bf16 v[144:147], a[44:47], v[200:203], v[144:147]
    v_cvt_pk_bf16_f32 v106, v108, v109
    v_cvt_pk_bf16_f32 v107, v110, v111
    v_mfma_f32_16x16x32_bf16 v[148:151], v[200:203], a[108:111], v[148:151]
    v_max3_f32 v18, v18, v196, v197
    v_mfma_f32_16x16x32_bf16 v[152:155], v[200:203], a[112:115], v[152:155]
    ds_read_b128 v[108:111], v6 offset:64
    v_mfma_f32_16x16x32_bf16 v[156:159], v[200:203], a[116:119], v[156:159]
    ds_read_b128 v[200:203], v0 offset:24576
    v_mfma_f32_16x16x32_bf16 v[136:139], a[48:51], v[204:207], v[136:139]
    s_waitcnt lgkmcnt(2)
    v_exp_f32 v112, v112
    v_mfma_f32_16x16x32_bf16 v[140:143], a[52:55], v[204:207], v[140:143]
    v_exp_f32 v113, v113
    v_mfma_f32_16x16x32_bf16 v[144:147], a[56:59], v[204:207], v[144:147]
    v_exp_f32 v114, v114
    v_mfma_f32_16x16x32_bf16 v[148:151], v[204:207], a[120:123], v[148:151]
    v_exp_f32 v115, v115
    v_mfma_f32_16x16x32_bf16 v[152:155], v[204:207], a[124:127], v[152:155]
    s_waitcnt lgkmcnt(1)
    v_exp_f32 v116, v116
    v_mfma_f32_16x16x32_bf16 v[156:159], v[204:207], a[128:131], v[156:159]
    s_waitcnt lgkmcnt(0)
    ds_read_b128 v[204:207], v1 offset:24576
    v_cvt_pk_bf16_f32 v112, v112, v113
    v_mfma_f32_16x16x32_bf16 v[136:139], a[60:63], v[208:211], v[136:139]
    v_cvt_pk_bf16_f32 v113, v114, v115
    v_cvt_pk_bf16_f32 v114, v116, 0
    v_mfma_f32_16x16x32_bf16 v[140:143], a[64:67], v[208:211], v[140:143]
    v_mov_b32 v115, 0
    v_mfma_f32_16x16x32_bf16 v[144:147], a[68:71], v[208:211], v[144:147]
    v_exp_f32 v124, v124
    v_mfma_f32_16x16x32_bf16 v[148:151], v[208:211], a[132:135], v[148:151]
    v_exp_f32 v125, v125
    v_mfma_f32_16x16x32_bf16 v[152:155], v[208:211], a[136:139], v[152:155]
    v_exp_f32 v126, v126
    v_mfma_f32_16x16x32_bf16 v[156:159], v[208:211], a[140:143], v[156:159]
    ds_read_b128 v[208:211], v0 offset:26624
    ds_read_b32 v116, v7 offset:9456
    v_mfma_f32_16x16x32_bf16 v[108:111], v[32:35], v[72:75], v[108:111]
    v_exp_f32 v127, v127
    v_mfma_f32_16x16x32_bf16 v[108:111], v[36:39], v[76:79], v[108:111]
    v_exp_f32 v132, v132
    v_mfma_f32_16x16x32_bf16 v[160:163], a[0:3], v[200:203], 0
    s_waitcnt lgkmcnt(2)
    v_lshrrev_b32 v7, 4, v19
    v_cmp_eq_u32 vcc, 3, v7
    v_mfma_f32_16x16x32_bf16 v[164:167], a[4:7], v[200:203], 0
    v_and_b32 v19, 15, v19
    v_mov_b32 v7, 16
    v_mfma_f32_16x16x32_bf16 v[168:171], a[8:11], v[200:203], 0
    v_exp_f32 v108, v108
    v_mfma_f32_16x16x32_bf16 v[160:163], a[12:15], v[204:207], v[160:163]
    s_waitcnt lgkmcnt(0)
    v_exp_f32 v109, v109
    v_mfma_f32_16x16x32_bf16 v[164:167], a[16:19], v[204:207], v[164:167]
    v_exp_f32 v110, v110
    v_mfma_f32_16x16x32_bf16 v[168:171], a[20:23], v[204:207], v[168:171]
    v_exp_f32 v111, v111
    v_mfma_f32_16x16x32_bf16 v[160:163], a[24:27], v[208:211], v[160:163]
    v_cndmask_b32 v19, v7, v19, vcc
    v_lshlrev_b32 v19, 2, v19
    v_mfma_f32_16x16x32_bf16 v[164:167], a[28:31], v[208:211], v[164:167]
    v_add_u32 v7, s49, v19
    v_bfe_i32 v19, v11, 5, 1
    v_mfma_f32_16x16x32_bf16 v[168:171], a[32:35], v[208:211], v[168:171]
    buffer_store_dwordx4 v[172:175], v13, s[36:39], s53 offen sc1
    v_mfma_f32_16x16x32_bf16 v[116:119], v[48:51], v[72:75], v[116:119]
    s_mov_b32 exec_lo, 0x100010
    s_mov_b32 exec_hi, 0x100010
    ds_write_b128 v3, v[184:187]
    s_mov_b64 exec, -1
    v_mfma_f32_16x16x32_bf16 v[184:187], v[80:83], v[120:123], 0
    v_mfma_f32_16x16x32_bf16 v[172:175], a[216:219], v[212:215], 0
    buffer_store_dwordx2 v[180:181], v182, s[36:39], s53 offen sc1
    v_mfma_f32_16x16x32_bf16 v[180:183], a[224:227], v[212:215], 0
    ds_read_b128 v[212:215], v2 offset:39936
    v_mfma_f32_16x16x32_bf16 v[184:187], v[84:87], v[128:131], v[184:187]
    s_mov_b32 exec_lo, 0x100010
    s_mov_b32 exec_hi, 0x100010
    ds_write_b64 v4, v[192:193]
    s_mov_b64 exec, -1
    v_mfma_f32_16x16x32_bf16 v[192:195], v[96:99], v[120:123], 0
    ds_read_b128 v[120:123], v5 offset:6144
    v_mfma_f32_16x16x32_bf16 v[192:195], v[100:103], v[128:131], v[192:195]
    ds_read_b128 v[128:131], v5 offset:8192
    v_mul_f32 v184, v184, v197
    v_mfma_f32_16x16x32_bf16 v[172:175], a[228:231], v[216:219], v[172:175]
    v_mul_f32 v185, v185, v197
    v_mul_f32 v186, v186, v197
    v_mfma_f32_16x16x32_bf16 v[180:183], a[236:239], v[216:219], v[180:183]
    s_waitcnt lgkmcnt(3)
    ds_read_b128 v[216:219], v2 offset:40960
    v_mul_f32 v187, v187, v197
    v_mfma_f32_16x16x32_bf16 v[172:175], a[240:243], v[220:223], v[172:175]
    v_cvt_pk_bf16_f32 v184, v184, v185
    v_mul_f32 v192, v192, v197
    v_mfma_f32_16x16x32_bf16 v[180:183], a[248:251], v[220:223], v[180:183]
    ds_read_b128 v[220:223], v2 offset:41984
    v_mul_f32 v193, v193, v197
    s_waitcnt lgkmcnt(3)
    v_mfma_f32_16x16x32_bf16 v[120:123], v[24:27], v[56:59], v[120:123]
    s_waitcnt lgkmcnt(2)
    v_cvt_pk_bf16_f32 v185, v186, v187
    v_mul_f32 v194, v194, v197
    v_mfma_f32_16x16x32_bf16 v[128:131], v[40:43], v[56:59], v[128:131]
    v_mul_f32 v195, v195, v197
    v_cvt_pk_bf16_f32 v192, v192, v193
    v_mfma_f32_16x16x32_bf16 v[120:123], v[28:31], v[60:63], v[120:123]
    v_cvt_pk_bf16_f32 v186, v188, v189
    v_cvt_pk_bf16_f32 v187, v190, v191
    v_mfma_f32_16x16x32_bf16 v[128:131], v[44:47], v[60:63], v[128:131]
    v_cvt_pk_bf16_f32 v193, v194, v195
    v_mov_b32 v62, v15
    v_mfma_f32_16x16x32_bf16 v[196:199], v[20:23], v[104:107], 0
    ds_write_b128 v3, v[184:187] offset:6144
    v_mfma_f32_16x16x32_bf16 v[188:191], v[88:91], v[104:107], 0
    v_exp_f32 v120, v120
    v_mfma_f32_16x16x32_bf16 v[184:187], v[80:83], v[104:107], 0
    v_exp_f32 v121, v121
    v_mfma_f32_16x16x32_bf16 v[172:175], a[252:255], v[212:215], v[172:175]
    s_waitcnt lgkmcnt(1)
    v_exp_f32 v122, v122
    v_mfma_f32_16x16x32_bf16 v[176:179], v[224:227], v[212:215], v[176:179]
    v_exp_f32 v123, v123
    v_mfma_f32_16x16x32_bf16 v[180:183], v[228:231], v[212:215], v[180:183]
    v_cvt_pk_bf16_f32 v120, v120, v121
    v_cvt_pk_bf16_f32 v121, v122, v123
    v_mfma_f32_16x16x32_bf16 v[196:199], v[20:23], v[112:115], v[196:199]
    v_exp_f32 v128, v128
    v_mfma_f32_16x16x32_bf16 v[172:175], v[232:235], v[216:219], v[172:175]
    v_exp_f32 v129, v129
    v_mfma_f32_16x16x32_bf16 v[184:187], v[84:87], v[112:115], v[184:187]
    v_exp_f32 v130, v130
    v_mfma_f32_16x16x32_bf16 v[176:179], v[236:239], v[216:219], v[176:179]
    v_exp_f32 v131, v131
    v_mfma_f32_16x16x32_bf16 v[180:183], v[240:243], v[216:219], v[180:183]
    v_rcp_f32 v197, v196
    v_mfma_f32_16x16x32_bf16 v[188:191], v[92:95], v[112:115], v[188:191]
    v_cvt_pk_bf16_f32 v122, v124, v125
    v_cvt_pk_bf16_f32 v123, v126, v127
    v_mfma_f32_16x16x32_bf16 v[172:175], v[244:247], v[220:223], v[172:175]
    v_mul_f32 v184, v184, v197
    v_mul_f32 v185, v185, v197
    v_mfma_f32_16x16x32_bf16 v[176:179], v[248:251], v[220:223], v[176:179]
    v_mul_f32 v186, v186, v197
    v_mul_f32 v187, v187, v197
    v_mfma_f32_16x16x32_bf16 v[180:183], v[252:255], v[220:223], v[180:183]
    v_cvt_pk_bf16_f32 v184, v184, v185
    v_mul_f32 v188, v188, v197
    v_mfma_f32_16x16x32_bf16 v[116:119], v[52:55], v[76:79], v[116:119]
    v_cvt_pk_bf16_f32 v172, v172, v173
    v_cvt_pk_bf16_f32 v173, v174, v175
    v_cvt_pk_bf16_f32 v174, v176, v177
    v_cvt_pk_bf16_f32 v175, v178, v179
    v_mfma_f32_16x16x32_bf16 v[176:179], v[200:203], a[76:79], 0
    v_cvt_pk_bf16_f32 v180, v180, v181
    v_cvt_pk_bf16_f32 v181, v182, v183
    v_mfma_f32_16x16x32_bf16 v[176:179], v[204:207], a[88:91], v[176:179]
    v_add_u32 v182, v14, v10
    v_mul_f32 v189, v189, v197
    v_mfma_f32_16x16x32_bf16 v[176:179], v[208:211], a[100:103], v[176:179]
    buffer_store_dwordx4 v[172:175], v14, s[36:39], s53 offen sc1
    ds_write_b64 v4, v[192:193] offset:6144
    v_mfma_f32_16x16x32_bf16 v[192:195], v[96:99], v[104:107], 0
    ds_read_b128 v[104:107], v6
    v_mul_f32 v190, v190, v197
    v_mfma_f32_16x16x32_bf16 v[192:195], v[100:103], v[112:115], v[192:195]
    v_mul_f32 v191, v191, v197
    v_cvt_pk_bf16_f32 v185, v186, v187
    v_mfma_f32_16x16x32_bf16 v[172:175], v[200:203], a[72:75], 0
    v_max3_f32 v18, v18, v196, v197
    v_cvt_pk_bf16_f32 v186, v188, v189
    v_mfma_f32_16x16x32_bf16 v[172:175], v[204:207], a[84:87], v[172:175]
    v_cvt_pk_bf16_f32 v187, v190, v191
    v_cvt_pk_bf16_f32 v128, v128, v129
    v_mfma_f32_16x16x32_bf16 v[188:191], v[88:91], v[120:123], 0
    v_mul_f32 v192, v192, v197
    v_mul_f32 v193, v193, v197
    v_mfma_f32_16x16x32_bf16 v[172:175], v[208:211], a[96:99], v[172:175]
    buffer_store_dwordx2 v[180:181], v182, s[36:39], s53 offen sc1
    s_waitcnt lgkmcnt(0)
    v_mfma_f32_16x16x32_bf16 v[104:107], v[24:27], v[72:75], v[104:107]
    v_mul_f32 v194, v194, v197
    v_mul_f32 v195, v195, v197
    v_mfma_f32_16x16x32_bf16 v[104:107], v[28:31], v[76:79], v[104:107]
    v_cvt_pk_bf16_f32 v192, v192, v193
    v_cvt_pk_bf16_f32 v129, v130, v131
    v_mfma_f32_16x16x32_bf16 v[196:199], v[20:23], v[120:123], 0
    v_cvt_pk_bf16_f32 v193, v194, v195
    v_cvt_pk_bf16_f32 v130, v132, 0
    v_mfma_f32_16x16x32_bf16 v[180:183], v[200:203], a[80:83], 0
    ds_read_b128 v[200:203], v1 offset:26624
    v_mov_b32 v131, 0
    v_mfma_f32_16x16x32_bf16 v[180:183], v[204:207], a[92:95], v[180:183]
    ds_read_b128 v[204:207], v0 offset:28672
    v_cvt_pk_bf16_f32 v24, v136, v137
    v_mfma_f32_16x16x32_bf16 v[196:199], v[20:23], v[128:131], v[196:199]
    v_exp_f32 v104, v104
    v_mfma_f32_16x16x32_bf16 v[188:191], v[92:95], v[128:131], v[188:191]
    v_exp_f32 v105, v105
    v_mfma_f32_16x16x32_bf16 v[180:183], v[208:211], a[104:107], v[180:183]
    ds_read_b128 v[208:211], v1 offset:28672
    v_exp_f32 v106, v106
    v_exp_f32 v107, v107
    s_waitcnt lgkmcnt(2)
    v_mfma_f32_16x16x32_bf16 v[160:163], a[36:39], v[200:203], v[160:163]
    v_rcp_f32 v197, v196
    v_mfma_f32_16x16x32_bf16 v[164:167], a[40:43], v[200:203], v[164:167]
    s_waitcnt lgkmcnt(1)
    v_mul_f32 v188, v188, v197
    v_mul_f32 v189, v189, v197
    v_mfma_f32_16x16x32_bf16 v[168:171], a[44:47], v[200:203], v[168:171]
    v_mul_f32 v190, v190, v197
    v_mul_f32 v191, v191, v197
    v_mfma_f32_16x16x32_bf16 v[172:175], v[200:203], a[108:111], v[172:175]
    v_cvt_pk_bf16_f32 v104, v104, v105
    v_cvt_pk_bf16_f32 v105, v106, v107
    v_mfma_f32_16x16x32_bf16 v[176:179], v[200:203], a[112:115], v[176:179]
    v_cvt_pk_bf16_f32 v106, v108, v109
    v_cvt_pk_bf16_f32 v107, v110, v111
    v_mfma_f32_16x16x32_bf16 v[180:183], v[200:203], a[116:119], v[180:183]
    ds_read_b128 v[200:203], v0 offset:30720
    v_cvt_pk_bf16_f32 v25, v138, v139
    v_mfma_f32_16x16x32_bf16 v[160:163], a[48:51], v[204:207], v[160:163]
    s_waitcnt lgkmcnt(1)
    v_cvt_pk_bf16_f32 v26, v140, v141
    v_cvt_pk_bf16_f32 v27, v142, v143
    v_mfma_f32_16x16x32_bf16 v[164:167], a[52:55], v[204:207], v[164:167]
    v_cvt_pk_bf16_f32 v28, v144, v145
    v_cvt_pk_bf16_f32 v29, v146, v147
    v_mfma_f32_16x16x32_bf16 v[168:171], a[56:59], v[204:207], v[168:171]
    ds_read_b128 v[112:115], v6 offset:128
    ds_read_b128 v[124:127], v5 offset:1024
    v_mfma_f32_16x16x32_bf16 v[172:175], v[204:207], a[120:123], v[172:175]
    ds_read_b32 v132, v7 offset:9216
    v_max3_f32 v18, v18, v196, v197
    v_mfma_f32_16x16x32_bf16 v[176:179], v[204:207], a[124:127], v[176:179]
    v_exp_f32 v116, v116
    v_mfma_f32_16x16x32_bf16 v[180:183], v[204:207], a[128:131], v[180:183]
    s_waitcnt lgkmcnt(3)
    ds_read_b128 v[204:207], v1 offset:30720
    ds_read_b128 v[108:111], v5 offset:4096
    v_mfma_f32_16x16x32_bf16 v[160:163], a[60:63], v[208:211], v[160:163]
    v_and_b32 v30, 0xbe8ac310, v19
    v_bfe_i32 v19, v11, 6, 1
    v_mfma_f32_16x16x32_bf16 v[164:167], a[64:67], v[208:211], v[164:167]
    v_and_b32 v38, 0xbe8ac310, v19
    v_bfe_i32 v19, v11, 7, 1
    v_mfma_f32_16x16x32_bf16 v[168:171], a[68:71], v[208:211], v[168:171]
    s_waitcnt lgkmcnt(4)
    v_mfma_f32_16x16x32_bf16 v[172:175], v[208:211], a[132:135], v[172:175]
    v_cvt_pk_bf16_f32 v32, v160, v161
    v_cvt_pk_bf16_f32 v33, v162, v163
    v_mfma_f32_16x16x32_bf16 v[176:179], v[208:211], a[136:139], v[176:179]
    v_cvt_pk_bf16_f32 v34, v164, v165
    v_cvt_pk_bf16_f32 v35, v166, v167
    v_mfma_f32_16x16x32_bf16 v[180:183], v[208:211], a[140:143], v[180:183]
    ds_read_b128 v[208:211], v0 offset:32768
    v_cvt_pk_bf16_f32 v36, v168, v169
    v_mfma_f32_16x16x32_bf16 v[136:139], a[0:3], v[200:203], 0
    s_waitcnt lgkmcnt(1)
    v_cvt_pk_bf16_f32 v37, v170, v171
    v_mfma_f32_16x16x32_bf16 v[140:143], a[4:7], v[200:203], 0
    ds_write_b128 v3, v[184:187] offset:12288
    v_mfma_f32_16x16x32_bf16 v[184:187], v[80:83], v[120:123], 0
    v_mfma_f32_16x16x32_bf16 v[184:187], v[84:87], v[128:131], v[184:187]
    ds_write_b64 v4, v[192:193] offset:12288
    v_mfma_f32_16x16x32_bf16 v[192:195], v[96:99], v[120:123], 0
    ds_read_b128 v[120:123], v5
    v_mfma_f32_16x16x32_bf16 v[192:195], v[100:103], v[128:131], v[192:195]
    ds_read_b128 v[128:131], v5 offset:2048
    v_mfma_f32_16x16x32_bf16 v[144:147], a[8:11], v[200:203], 0
    v_mfma_f32_16x16x32_bf16 v[136:139], a[12:15], v[204:207], v[136:139]
    s_waitcnt lgkmcnt(4)
    v_mul_f32 v184, v184, v197
    v_mul_f32 v185, v185, v197
    v_mfma_f32_16x16x32_bf16 v[140:143], a[16:19], v[204:207], v[140:143]
    v_mul_f32 v186, v186, v197
    v_mul_f32 v187, v187, v197
    v_mfma_f32_16x16x32_bf16 v[144:147], a[20:23], v[204:207], v[144:147]
    v_cvt_pk_bf16_f32 v184, v184, v185
    v_mul_f32 v192, v192, v197
    v_mfma_f32_16x16x32_bf16 v[136:139], a[24:27], v[208:211], v[136:139]
    v_mul_f32 v193, v193, v197
    v_cvt_pk_bf16_f32 v185, v186, v187
    v_mfma_f32_16x16x32_bf16 v[140:143], a[28:31], v[208:211], v[140:143]
    v_mul_f32 v194, v194, v197
    v_mul_f32 v195, v195, v197
    v_mfma_f32_16x16x32_bf16 v[144:147], a[32:35], v[208:211], v[144:147]
    v_cvt_pk_bf16_f32 v192, v192, v193
    v_cvt_pk_bf16_f32 v186, v188, v189
    v_mfma_f32_16x16x32_bf16 v[112:115], v[40:43], v[72:75], v[112:115]
    v_cvt_pk_bf16_f32 v187, v190, v191
    v_cvt_pk_bf16_f32 v193, v194, v195
    v_mfma_f32_16x16x32_bf16 v[188:191], v[88:91], v[104:107], 0
    v_cvt_pk_bf16_f32 v88, v152, v153
    v_cvt_pk_bf16_f32 v89, v154, v155
    v_mfma_f32_16x16x32_bf16 v[152:155], v[200:203], a[76:79], 0
    v_cvt_pk_bf16_f32 v90, v176, v177
    v_cvt_pk_bf16_f32 v91, v178, v179
    v_mfma_f32_16x16x32_bf16 v[152:155], v[204:207], a[88:91], v[152:155]
    ds_write_b128 v3, v[184:187] offset:18432
    v_mfma_f32_16x16x32_bf16 v[184:187], v[80:83], v[104:107], 0
    v_cvt_pk_bf16_f32 v80, v148, v149
    v_cvt_pk_bf16_f32 v81, v150, v151
    v_mfma_f32_16x16x32_bf16 v[148:151], v[200:203], a[72:75], 0
    v_cvt_pk_bf16_f32 v82, v172, v173
    v_cvt_pk_bf16_f32 v83, v174, v175
    v_mfma_f32_16x16x32_bf16 v[148:151], v[204:207], a[84:87], v[148:151]
    ds_write_b64 v4, v[192:193] offset:18432
    v_mfma_f32_16x16x32_bf16 v[192:195], v[96:99], v[104:107], 0
    v_cvt_pk_bf16_f32 v96, v156, v157
    v_cvt_pk_bf16_f32 v97, v158, v159
    v_mfma_f32_16x16x32_bf16 v[156:159], v[200:203], a[80:83], 0
    ds_read_b128 v[200:203], v1 offset:32768
    v_cvt_pk_bf16_f32 v98, v180, v181
    v_mfma_f32_16x16x32_bf16 v[156:159], v[204:207], a[92:95], v[156:159]
    ds_read_b128 v[204:207], v0 offset:34816
    v_cvt_pk_bf16_f32 v99, v182, v183
    v_mfma_f32_16x16x32_bf16 v[152:155], v[208:211], a[100:103], v[152:155]
    v_mfma_f32_16x16x32_bf16 v[148:151], v[208:211], a[96:99], v[148:151]
    v_mfma_f32_16x16x32_bf16 v[156:159], v[208:211], a[104:107], v[156:159]
    s_waitcnt lgkmcnt(2)
    ds_read_b128 v[208:211], v1 offset:34816
    s_barrier
    s_waitcnt lgkmcnt(2)
    v_mfma_f32_16x16x32_bf16 v[136:139], a[36:39], v[200:203], v[136:139]
    s_waitcnt lgkmcnt(1)
    ds_read_b128 v[212:215], v2 offset:6144
    ds_read_b128 v[216:219], v2 offset:7168
    v_mfma_f32_16x16x32_bf16 v[140:143], a[40:43], v[200:203], v[140:143]
    ds_read_b128 v[220:223], v2 offset:8192
    v_mfma_f32_16x16x32_bf16 v[144:147], a[44:47], v[200:203], v[144:147]
    v_mfma_f32_16x16x32_bf16 v[152:155], v[200:203], a[112:115], v[152:155]
    v_mfma_f32_16x16x32_bf16 v[148:151], v[200:203], a[108:111], v[148:151]
    v_mfma_f32_16x16x32_bf16 v[156:159], v[200:203], a[116:119], v[156:159]
    ds_read_b128 v[200:203], v0 offset:18432
    v_mfma_f32_16x16x32_bf16 v[136:139], a[48:51], v[204:207], v[136:139]
    s_waitcnt lgkmcnt(3)
    v_mfma_f32_16x16x32_bf16 v[140:143], a[52:55], v[204:207], v[140:143]
    v_mfma_f32_16x16x32_bf16 v[144:147], a[56:59], v[204:207], v[144:147]
    v_mfma_f32_16x16x32_bf16 v[152:155], v[204:207], a[124:127], v[152:155]
    v_mfma_f32_16x16x32_bf16 v[148:151], v[204:207], a[120:123], v[148:151]
    v_mfma_f32_16x16x32_bf16 v[156:159], v[204:207], a[128:131], v[156:159]
    s_waitcnt lgkmcnt(0)
    ds_read_b128 v[204:207], v1 offset:18432
    v_mfma_f32_16x16x32_bf16 v[136:139], a[60:63], v[208:211], v[136:139]
    v_mfma_f32_16x16x32_bf16 v[140:143], a[64:67], v[208:211], v[140:143]
    v_mfma_f32_16x16x32_bf16 v[144:147], a[68:71], v[208:211], v[144:147]
    v_mfma_f32_16x16x32_bf16 v[152:155], v[208:211], a[136:139], v[152:155]
    v_mfma_f32_16x16x32_bf16 v[148:151], v[208:211], a[132:135], v[148:151]
    v_mfma_f32_16x16x32_bf16 v[156:159], v[208:211], a[140:143], v[156:159]
    ds_read_b128 v[208:211], v0 offset:20480
    v_mfma_f32_16x16x32_bf16 v[172:175], a[216:219], v[212:215], 0
    v_mfma_f32_16x16x32_bf16 v[176:179], a[220:223], v[212:215], 0
    v_cvt_pk_bf16_f32 v40, v136, v137
    v_cvt_pk_bf16_f32 v41, v138, v139
    v_mfma_f32_16x16x32_bf16 v[180:183], a[224:227], v[212:215], 0
    ds_read_b128 v[212:215], v2 offset:9216
    v_cvt_pk_bf16_f32 v42, v140, v141
    v_mfma_f32_16x16x32_bf16 v[172:175], a[228:231], v[216:219], v[172:175]
    v_cvt_pk_bf16_f32 v43, v142, v143
    v_mfma_f32_16x16x32_bf16 v[176:179], a[232:235], v[216:219], v[176:179]
    v_mfma_f32_16x16x32_bf16 v[180:183], a[236:239], v[216:219], v[180:183]
    ds_read_b128 v[216:219], v2 offset:10240
    v_mfma_f32_16x16x32_bf16 v[172:175], a[240:243], v[220:223], v[172:175]
    v_mfma_f32_16x16x32_bf16 v[176:179], a[244:247], v[220:223], v[176:179]
    v_mfma_f32_16x16x32_bf16 v[180:183], a[248:251], v[220:223], v[180:183]
    s_waitcnt lgkmcnt(1)
    ds_read_b128 v[220:223], v2 offset:11264
    v_mfma_f32_16x16x32_bf16 v[160:163], a[144:147], v[200:203], 0
    v_mfma_f32_16x16x32_bf16 v[164:167], a[148:151], v[200:203], 0
    v_mfma_f32_16x16x32_bf16 v[168:171], a[152:155], v[200:203], 0
    ds_read_b128 v[200:203], v1 offset:20480
    v_mfma_f32_16x16x32_bf16 v[160:163], a[156:159], v[204:207], v[160:163]
    v_mfma_f32_16x16x32_bf16 v[164:167], a[160:163], v[204:207], v[164:167]
    v_mfma_f32_16x16x32_bf16 v[168:171], a[164:167], v[204:207], v[168:171]
    ds_read_b128 v[204:207], v0 offset:22528
    v_mfma_f32_16x16x32_bf16 v[112:115], v[44:47], v[76:79], v[112:115]
    v_and_b32 v46, 0xbe8ac310, v19
    v_cvt_pk_bf16_f32 v44, v144, v145
    v_mfma_f32_16x16x32_bf16 v[160:163], a[168:171], v[208:211], v[160:163]
    v_cvt_pk_bf16_f32 v45, v146, v147
    v_bfe_i32 v19, v11, 8, 1
    v_mfma_f32_16x16x32_bf16 v[164:167], a[172:175], v[208:211], v[164:167]
    s_waitcnt lgkmcnt(1)
    v_and_b32 v54, 0xbe8ac310, v19
    v_bfe_i32 v19, v11, 2, 1
    v_mfma_f32_16x16x32_bf16 v[168:171], a[176:179], v[208:211], v[168:171]
    ds_read_b128 v[208:211], v1 offset:22528
    v_and_b32 v19, 0x15000, v19
    v_mfma_f32_16x16x32_bf16 v[172:175], a[252:255], v[212:215], v[172:175]
    v_exp_f32 v112, v112
    v_mfma_f32_16x16x32_bf16 v[176:179], v[224:227], v[212:215], v[176:179]
    v_exp_f32 v113, v113
    v_mfma_f32_16x16x32_bf16 v[180:183], v[228:231], v[212:215], v[180:183]
    ds_read_b128 v[212:215], v2 offset:12288
    v_cvt_pk_bf16_f32 v112, v112, v113
    v_mfma_f32_16x16x32_bf16 v[172:175], v[232:235], v[216:219], v[172:175]
    v_exp_f32 v114, v114
    v_mfma_f32_16x16x32_bf16 v[176:179], v[236:239], v[216:219], v[176:179]
    v_exp_f32 v115, v115
    v_mfma_f32_16x16x32_bf16 v[180:183], v[240:243], v[216:219], v[180:183]
    ds_read_b128 v[216:219], v2 offset:13312
    v_cvt_pk_bf16_f32 v113, v114, v115
    v_mfma_f32_16x16x32_bf16 v[172:175], v[244:247], v[220:223], v[172:175]
    v_cvt_pk_bf16_f32 v114, v116, 0
    v_mov_b32 v115, 0
    v_mfma_f32_16x16x32_bf16 v[176:179], v[248:251], v[220:223], v[176:179]
    ds_read_b32 v116, v7 offset:9296
    v_mfma_f32_16x16x32_bf16 v[180:183], v[252:255], v[220:223], v[180:183]
    ds_read_b128 v[220:223], v2 offset:14336
    v_mfma_f32_16x16x32_bf16 v[160:163], a[180:183], v[200:203], v[160:163]
    s_waitcnt lgkmcnt(3)
    v_cvt_pk_bf16_f32 v172, v172, v173
    v_cvt_pk_bf16_f32 v173, v174, v175
    v_mfma_f32_16x16x32_bf16 v[164:167], a[184:187], v[200:203], v[164:167]
    v_cvt_pk_bf16_f32 v174, v176, v177
    v_cvt_pk_bf16_f32 v175, v178, v179
    v_mfma_f32_16x16x32_bf16 v[168:171], a[188:191], v[200:203], v[168:171]
    ds_read_b128 v[200:203], v0 offset:24576
    v_cvt_pk_bf16_f32 v180, v180, v181
    v_mfma_f32_16x16x32_bf16 v[160:163], a[192:195], v[204:207], v[160:163]
    v_cvt_pk_bf16_f32 v181, v182, v183
    v_add_u32 v182, v12, v10
    v_mfma_f32_16x16x32_bf16 v[164:167], a[196:199], v[204:207], v[164:167]
    buffer_store_dwordx4 v[172:175], v12, s[36:39], s54 offen sc1
    v_mfma_f32_16x16x32_bf16 v[168:171], a[200:203], v[204:207], v[168:171]
    ds_read_b128 v[204:207], v1 offset:24576
    v_sub_u32 v12, v12, v19
    v_mfma_f32_16x16x32_bf16 v[196:199], v[20:23], v[104:107], 0
    ds_read_b128 v[104:107], v5 offset:3072
    v_add_u32 v12, 0x1f80, v12
    v_mfma_f32_16x16x32_bf16 v[160:163], a[204:207], v[208:211], v[160:163]
    v_bfe_i32 v19, v11, 3, 1
    v_and_b32 v19, 0x15000, v19
    v_mfma_f32_16x16x32_bf16 v[164:167], a[208:211], v[208:211], v[164:167]
    buffer_store_dwordx2 v[180:181], v182, s[36:39], s54 offen sc1
    v_mfma_f32_16x16x32_bf16 v[168:171], a[212:215], v[208:211], v[168:171]
    ds_read_b128 v[208:211], v0 offset:26624
    v_mfma_f32_16x16x32_bf16 v[184:187], v[84:87], v[112:115], v[184:187]
    v_cvt_pk_bf16_f32 v84, v148, v149
    v_mul_f32 v160, s43, v160
    v_mfma_f32_16x16x32_bf16 v[188:191], v[92:95], v[112:115], v[188:191]
    v_mul_f32 v161, s43, v161
    v_mul_f32 v162, s43, v162
    v_mfma_f32_16x16x32_bf16 v[192:195], v[100:103], v[112:115], v[192:195]
    v_mul_f32 v163, s43, v163
    v_mul_f32 v164, s43, v164
    v_mfma_f32_16x16x32_bf16 v[196:199], v[20:23], v[112:115], v[196:199]
    v_mul_f32 v165, s43, v165
    v_mul_f32 v166, s43, v166
    v_mfma_f32_16x16x32_bf16 v[176:179], a[220:223], v[212:215], 0
    s_waitcnt lgkmcnt(1)
    v_mul_f32 v167, s43, v167
    v_mul_f32 v168, s43, v168
    v_mfma_f32_16x16x32_bf16 v[172:175], a[216:219], v[212:215], 0
    v_mul_f32 v169, s43, v169
    v_mul_f32 v170, s43, v170
    v_mfma_f32_16x16x32_bf16 v[180:183], a[224:227], v[212:215], 0
    ds_read_b128 v[212:215], v2 offset:15360
    v_mul_f32 v171, s43, v171
    v_mfma_f32_16x16x32_bf16 v[176:179], a[232:235], v[216:219], v[176:179]
    v_cvt_pk_bf16_f32 v56, v160, v161
    v_cvt_pk_bf16_f32 v57, v162, v163
    v_mfma_f32_16x16x32_bf16 v[172:175], a[228:231], v[216:219], v[172:175]
    v_cvt_pk_bf16_f32 v58, v164, v165
    v_cvt_pk_bf16_f32 v59, v166, v167
    v_mfma_f32_16x16x32_bf16 v[180:183], a[236:239], v[216:219], v[180:183]
    ds_read_b128 v[216:219], v2 offset:16384
    v_cvt_pk_bf16_f32 v60, v168, v169
    v_mfma_f32_16x16x32_bf16 v[120:123], v[24:27], v[56:59], v[120:123]
    v_cvt_pk_bf16_f32 v61, v170, v171
    v_cvt_pk_bf16_f32 v85, v150, v151
    v_mfma_f32_16x16x32_bf16 v[124:127], v[32:35], v[56:59], v[124:127]
    ds_read_b128 v[112:115], v5 offset:5120
    v_cvt_pk_bf16_f32 v92, v152, v153
    v_mfma_f32_16x16x32_bf16 v[128:131], v[40:43], v[56:59], v[128:131]
    v_rcp_f32 v197, v196
    v_mfma_f32_16x16x32_bf16 v[120:123], v[28:31], v[60:63], v[120:123]
    v_mul_f32 v184, v184, v197
    v_mul_f32 v185, v185, v197
    v_mfma_f32_16x16x32_bf16 v[132:135], v[48:51], v[56:59], v[132:135]
    v_mul_f32 v186, v186, v197
    v_mul_f32 v187, v187, v197
    v_mfma_f32_16x16x32_bf16 v[124:127], v[36:39], v[60:63], v[124:127]
    v_cvt_pk_bf16_f32 v184, v184, v185
    v_mul_f32 v188, v188, v197
    v_mfma_f32_16x16x32_bf16 v[128:131], v[44:47], v[60:63], v[128:131]
    v_exp_f32 v120, v120
    v_mfma_f32_16x16x32_bf16 v[132:135], v[52:55], v[60:63], v[132:135]
    v_exp_f32 v121, v121
    v_mfma_f32_16x16x32_bf16 v[176:179], a[244:247], v[220:223], v[176:179]
    s_waitcnt lgkmcnt(0)
    v_exp_f32 v122, v122
    v_mfma_f32_16x16x32_bf16 v[172:175], a[240:243], v[220:223], v[172:175]
    v_exp_f32 v123, v123
    v_mfma_f32_16x16x32_bf16 v[180:183], a[248:251], v[220:223], v[180:183]
    ds_read_b128 v[220:223], v2 offset:17408
    v_cvt_pk_bf16_f32 v120, v120, v121
    v_mfma_f32_16x16x32_bf16 v[160:163], a[144:147], v[200:203], 0
    v_exp_f32 v124, v124
    v_mfma_f32_16x16x32_bf16 v[164:167], a[148:151], v[200:203], 0
    v_exp_f32 v125, v125
    v_mfma_f32_16x16x32_bf16 v[168:171], a[152:155], v[200:203], 0
    ds_read_b128 v[200:203], v1 offset:26624
    v_cvt_pk_bf16_f32 v121, v122, v123
    v_mfma_f32_16x16x32_bf16 v[160:163], a[156:159], v[204:207], v[160:163]
    v_exp_f32 v126, v126
    v_mfma_f32_16x16x32_bf16 v[164:167], a[160:163], v[204:207], v[164:167]
    v_exp_f32 v127, v127
    v_mfma_f32_16x16x32_bf16 v[168:171], a[164:167], v[204:207], v[168:171]
    ds_read_b128 v[204:207], v0 offset:28672
    v_mul_f32 v189, v189, v197
    v_mfma_f32_16x16x32_bf16 v[160:163], a[168:171], v[208:211], v[160:163]
    v_exp_f32 v128, v128
    v_mfma_f32_16x16x32_bf16 v[164:167], a[172:175], v[208:211], v[164:167]
    v_exp_f32 v129, v129
    v_mfma_f32_16x16x32_bf16 v[168:171], a[176:179], v[208:211], v[168:171]
    s_waitcnt lgkmcnt(1)
    ds_read_b128 v[208:211], v1 offset:28672
    v_mul_f32 v190, v190, v197
    v_mfma_f32_16x16x32_bf16 v[176:179], v[224:227], v[212:215], v[176:179]
    v_mul_f32 v191, v191, v197
    v_cvt_pk_bf16_f32 v185, v186, v187
    v_mfma_f32_16x16x32_bf16 v[172:175], a[252:255], v[212:215], v[172:175]
    v_exp_f32 v130, v130
    v_mfma_f32_16x16x32_bf16 v[180:183], v[228:231], v[212:215], v[180:183]
    ds_read_b128 v[212:215], v2 offset:18432
    v_cvt_pk_bf16_f32 v122, v124, v125
    v_mfma_f32_16x16x32_bf16 v[176:179], v[236:239], v[216:219], v[176:179]
    v_exp_f32 v131, v131
    v_mfma_f32_16x16x32_bf16 v[172:175], v[232:235], v[216:219], v[172:175]
    v_cvt_pk_bf16_f32 v123, v126, v127
    v_max3_f32 v18, v18, v196, v197
    v_mfma_f32_16x16x32_bf16 v[180:183], v[240:243], v[216:219], v[180:183]
    ds_read_b128 v[216:219], v2 offset:19456
    v_mul_f32 v192, v192, v197
    v_mfma_f32_16x16x32_bf16 v[176:179], v[248:251], v[220:223], v[176:179]
    v_mul_f32 v193, v193, v197
    v_mul_f32 v194, v194, v197
    v_mfma_f32_16x16x32_bf16 v[172:175], v[244:247], v[220:223], v[172:175]
    v_mul_f32 v195, v195, v197
    v_cvt_pk_bf16_f32 v186, v188, v189
    v_mfma_f32_16x16x32_bf16 v[196:199], v[20:23], v[120:123], 0
    v_exp_f32 v132, v132
    v_mfma_f32_16x16x32_bf16 v[180:183], v[252:255], v[220:223], v[180:183]
    ds_read_b128 v[220:223], v2 offset:20480
    v_cvt_pk_bf16_f32 v187, v190, v191
    v_mfma_f32_16x16x32_bf16 v[188:191], v[88:91], v[120:123], 0
    v_cvt_pk_bf16_f32 v172, v172, v173
    v_cvt_pk_bf16_f32 v173, v174, v175
    v_mfma_f32_16x16x32_bf16 v[160:163], a[180:183], v[200:203], v[160:163]
    s_waitcnt lgkmcnt(1)
    v_cvt_pk_bf16_f32 v174, v176, v177
    v_cvt_pk_bf16_f32 v180, v180, v181
    v_mfma_f32_16x16x32_bf16 v[164:167], a[184:187], v[200:203], v[164:167]
    v_cvt_pk_bf16_f32 v175, v178, v179
    v_cvt_pk_bf16_f32 v128, v128, v129
    v_mfma_f32_16x16x32_bf16 v[168:171], a[188:191], v[200:203], v[168:171]
    v_cvt_pk_bf16_f32 v181, v182, v183
    v_cvt_pk_bf16_f32 v192, v192, v193
    v_mfma_f32_16x16x32_bf16 v[160:163], a[192:195], v[204:207], v[160:163]
    v_cvt_pk_bf16_f32 v129, v130, v131
    v_add_u32 v182, v13, v10
    v_mfma_f32_16x16x32_bf16 v[164:167], a[196:199], v[204:207], v[164:167]
    v_cvt_pk_bf16_f32 v193, v194, v195
    v_cvt_pk_bf16_f32 v130, v132, 0
    v_mfma_f32_16x16x32_bf16 v[168:171], a[200:203], v[204:207], v[168:171]
    v_mov_b32 v131, 0
    v_cvt_pk_bf16_f32 v93, v154, v155
    v_mfma_f32_16x16x32_bf16 v[160:163], a[204:207], v[208:211], v[160:163]
    v_cvt_pk_bf16_f32 v100, v156, v157
    v_cvt_pk_bf16_f32 v101, v158, v159
    v_mfma_f32_16x16x32_bf16 v[196:199], v[20:23], v[128:131], v[196:199]
    ds_read_b128 v[200:203], v0 offset:30720
    ds_read_b128 v[204:207], v1 offset:30720
    v_mfma_f32_16x16x32_bf16 v[188:191], v[92:95], v[128:131], v[188:191]
    ds_read_b128 v[124:127], v5 offset:7168
    v_mov_b32 v62, v16
    v_mfma_f32_16x16x32_bf16 v[164:167], a[208:211], v[208:211], v[164:167]
    v_mul_f32 v160, s43, v160
    v_mul_f32 v161, s43, v161
    v_mfma_f32_16x16x32_bf16 v[168:171], a[212:215], v[208:211], v[168:171]
    v_mul_f32 v162, s43, v162
    v_mul_f32 v163, s43, v163
    v_mfma_f32_16x16x32_bf16 v[176:179], a[220:223], v[212:215], 0
    v_cvt_pk_bf16_f32 v64, v160, v161
    v_cvt_pk_bf16_f32 v65, v162, v163
    v_mfma_f32_16x16x32_bf16 v[176:179], a[232:235], v[216:219], v[176:179]
    s_waitcnt lgkmcnt(3)
    v_mul_f32 v164, s43, v164
    v_mul_f32 v165, s43, v165
    v_mfma_f32_16x16x32_bf16 v[176:179], a[244:247], v[220:223], v[176:179]
    s_waitcnt lgkmcnt(2)
    v_mul_f32 v166, s43, v166
    v_mul_f32 v167, s43, v167
    v_mfma_f32_16x16x32_bf16 v[160:163], a[144:147], v[200:203], 0
    s_waitcnt lgkmcnt(1)
    v_cvt_pk_bf16_f32 v66, v164, v165
    v_cvt_pk_bf16_f32 v67, v166, v167
    v_mfma_f32_16x16x32_bf16 v[164:167], a[148:151], v[200:203], 0
    v_mul_f32 v168, s43, v168
    v_mul_f32 v169, s43, v169
    v_mfma_f32_16x16x32_bf16 v[104:107], v[24:27], v[64:67], v[104:107]
    v_mul_f32 v170, s43, v170
    v_mul_f32 v171, s43, v171
    v_mfma_f32_16x16x32_bf16 v[108:111], v[32:35], v[64:67], v[108:111]
    v_cvt_pk_bf16_f32 v68, v168, v169
    v_cvt_pk_bf16_f32 v69, v170, v171
    v_mfma_f32_16x16x32_bf16 v[112:115], v[40:43], v[64:67], v[112:115]
    v_rcp_f32 v197, v196
    v_mfma_f32_16x16x32_bf16 v[104:107], v[28:31], v[68:71], v[104:107]
    v_mul_f32 v188, v188, v197
    v_mul_f32 v189, v189, v197
    v_mfma_f32_16x16x32_bf16 v[116:119], v[48:51], v[64:67], v[116:119]
    v_mul_f32 v190, v190, v197
    v_mul_f32 v191, v191, v197
    v_mfma_f32_16x16x32_bf16 v[108:111], v[36:39], v[68:71], v[108:111]
    v_max3_f32 v18, v18, v196, v197
    v_mfma_f32_16x16x32_bf16 v[112:115], v[44:47], v[68:71], v[112:115]
    v_exp_f32 v104, v104
    v_mfma_f32_16x16x32_bf16 v[116:119], v[52:55], v[68:71], v[116:119]
    v_exp_f32 v105, v105
    v_mfma_f32_16x16x32_bf16 v[168:171], a[152:155], v[200:203], 0
    v_exp_f32 v106, v106
    v_mfma_f32_16x16x32_bf16 v[160:163], a[156:159], v[204:207], v[160:163]
    v_exp_f32 v107, v107
    v_mfma_f32_16x16x32_bf16 v[164:167], a[160:163], v[204:207], v[164:167]
    v_exp_f32 v108, v108
    v_mfma_f32_16x16x32_bf16 v[168:171], a[164:167], v[204:207], v[168:171]
    s_mov_b32 exec_lo, 0x1000100
    s_mov_b32 exec_hi, 0x1000100
    ds_write_b128 v3, v[184:187]
    s_mov_b64 exec, -1
    v_mfma_f32_16x16x32_bf16 v[184:187], v[80:83], v[120:123], 0
    v_exp_f32 v109, v109
    v_mfma_f32_16x16x32_bf16 v[184:187], v[84:87], v[128:131], v[184:187]
    buffer_store_dwordx4 v[172:175], v13, s[36:39], s54 offen sc1
    s_mov_b32 exec_lo, 0x1000100
    s_mov_b32 exec_hi, 0x1000100
    ds_write_b64 v4, v[192:193]
    s_mov_b64 exec, -1
    v_mfma_f32_16x16x32_bf16 v[192:195], v[96:99], v[120:123], 0
    v_exp_f32 v110, v110
    v_mfma_f32_16x16x32_bf16 v[192:195], v[100:103], v[128:131], v[192:195]
    v_exp_f32 v111, v111
    v_mfma_f32_16x16x32_bf16 v[172:175], a[216:219], v[212:215], 0
    v_cvt_pk_bf16_f32 v104, v104, v105
    v_mul_f32 v184, v184, v197
    v_mfma_f32_16x16x32_bf16 v[172:175], a[228:231], v[216:219], v[172:175]
    v_mul_f32 v185, v185, v197
    v_mul_f32 v186, v186, v197
    v_mfma_f32_16x16x32_bf16 v[172:175], a[240:243], v[220:223], v[172:175]
    buffer_store_dwordx2 v[180:181], v182, s[36:39], s54 offen sc1
    v_mfma_f32_16x16x32_bf16 v[180:183], a[224:227], v[212:215], 0
    ds_read_b128 v[212:215], v2 offset:21504
    v_mul_f32 v187, v187, v197
    v_mfma_f32_16x16x32_bf16 v[180:183], a[236:239], v[216:219], v[180:183]
    ds_read_b128 v[216:219], v2 offset:22528
    v_cvt_pk_bf16_f32 v105, v106, v107
    v_mfma_f32_16x16x32_bf16 v[180:183], a[248:251], v[220:223], v[180:183]
    v_exp_f32 v112, v112
    v_exp_f32 v113, v113
    v_cvt_pk_bf16_f32 v184, v184, v185
    ds_read_b128 v[220:223], v2 offset:23552
    v_exp_f32 v114, v114
    v_exp_f32 v115, v115
    v_cvt_pk_bf16_f32 v106, v108, v109
    s_waitcnt lgkmcnt(2)
    v_mfma_f32_16x16x32_bf16 v[172:175], a[252:255], v[212:215], v[172:175]
    v_cvt_pk_bf16_f32 v107, v110, v111
    v_cvt_pk_bf16_f32 v185, v186, v187
    v_mfma_f32_16x16x32_bf16 v[176:179], v[224:227], v[212:215], v[176:179]
    s_waitcnt lgkmcnt(1)
    v_exp_f32 v116, v116
    v_mfma_f32_16x16x32_bf16 v[180:183], v[228:231], v[212:215], v[180:183]
    v_mul_f32 v192, v192, v197
    v_mul_f32 v193, v193, v197
    v_mfma_f32_16x16x32_bf16 v[172:175], v[232:235], v[216:219], v[172:175]
    s_waitcnt lgkmcnt(0)
    v_mul_f32 v194, v194, v197
    v_mul_f32 v195, v195, v197
    v_mfma_f32_16x16x32_bf16 v[196:199], v[20:23], v[104:107], 0
    v_cvt_pk_bf16_f32 v186, v188, v189
    v_cvt_pk_bf16_f32 v187, v190, v191
    v_mfma_f32_16x16x32_bf16 v[188:191], v[88:91], v[104:107], 0
    v_cvt_pk_bf16_f32 v112, v112, v113
    v_cvt_pk_bf16_f32 v192, v192, v193
    v_mfma_f32_16x16x32_bf16 v[176:179], v[236:239], v[216:219], v[176:179]
    v_cvt_pk_bf16_f32 v113, v114, v115
    v_cvt_pk_bf16_f32 v193, v194, v195
    v_mfma_f32_16x16x32_bf16 v[180:183], v[240:243], v[216:219], v[180:183]
    v_cvt_pk_bf16_f32 v114, v116, 0
    v_mov_b32 v115, 0
    v_mfma_f32_16x16x32_bf16 v[172:175], v[244:247], v[220:223], v[172:175]
    ds_read_b128 v[208:211], v0 offset:32768
    ds_read_b128 v[200:203], v1 offset:32768
    v_mfma_f32_16x16x32_bf16 v[196:199], v[20:23], v[112:115], v[196:199]
    ds_read_b128 v[204:207], v0 offset:34816
    v_sub_u32 v13, v13, v19
    v_mfma_f32_16x16x32_bf16 v[188:191], v[92:95], v[112:115], v[188:191]
    ds_read_b128 v[120:123], v5 offset:6144
    v_add_u32 v13, 0x1f80, v13
    v_mfma_f32_16x16x32_bf16 v[176:179], v[248:251], v[220:223], v[176:179]
    v_cvt_pk_bf16_f32 v172, v172, v173
    v_cvt_pk_bf16_f32 v173, v174, v175
    v_mfma_f32_16x16x32_bf16 v[180:183], v[252:255], v[220:223], v[180:183]
    ds_write_b128 v3, v[184:187] offset:24576
    v_mfma_f32_16x16x32_bf16 v[184:187], v[80:83], v[104:107], 0
    s_waitcnt lgkmcnt(4)
    v_rcp_f32 v197, v196
    v_mfma_f32_16x16x32_bf16 v[184:187], v[84:87], v[112:115], v[184:187]
    v_mul_f32 v188, v188, v197
    v_mul_f32 v189, v189, v197
    v_mfma_f32_16x16x32_bf16 v[160:163], a[168:171], v[208:211], v[160:163]
    s_waitcnt lgkmcnt(2)
    v_mul_f32 v190, v190, v197
    v_mul_f32 v191, v191, v197
    v_mfma_f32_16x16x32_bf16 v[164:167], a[172:175], v[208:211], v[164:167]
    v_cvt_pk_bf16_f32 v174, v176, v177
    v_mul_f32 v184, v184, v197
    v_mfma_f32_16x16x32_bf16 v[168:171], a[176:179], v[208:211], v[168:171]
    v_mul_f32 v185, v185, v197
    v_mul_f32 v186, v186, v197
    v_mfma_f32_16x16x32_bf16 v[160:163], a[180:183], v[200:203], v[160:163]
    v_mul_f32 v187, v187, v197
    v_cvt_pk_bf16_f32 v184, v184, v185
    v_mfma_f32_16x16x32_bf16 v[164:167], a[184:187], v[200:203], v[164:167]
    v_cvt_pk_bf16_f32 v185, v186, v187
    v_cvt_pk_bf16_f32 v186, v188, v189
    v_mfma_f32_16x16x32_bf16 v[168:171], a[188:191], v[200:203], v[168:171]
    v_cvt_pk_bf16_f32 v187, v190, v191
    v_cvt_pk_bf16_f32 v175, v178, v179
    v_mfma_f32_16x16x32_bf16 v[160:163], a[192:195], v[204:207], v[160:163]
    v_cvt_pk_bf16_f32 v180, v180, v181
    v_cvt_pk_bf16_f32 v181, v182, v183
    v_mfma_f32_16x16x32_bf16 v[164:167], a[196:199], v[204:207], v[164:167]
    v_add_u32 v182, v14, v10
    v_max3_f32 v18, v18, v196, v197
    v_mfma_f32_16x16x32_bf16 v[168:171], a[200:203], v[204:207], v[168:171]
    ds_write_b64 v4, v[192:193] offset:24576
    v_mfma_f32_16x16x32_bf16 v[192:195], v[96:99], v[104:107], 0
    ds_read_b128 v[208:211], v1 offset:34816
    ds_read_b128 v[128:131], v5 offset:8192
    v_mfma_f32_16x16x32_bf16 v[192:195], v[100:103], v[112:115], v[192:195]
    ds_write_b128 v3, v[184:187] offset:30720
    buffer_store_dwordx4 v[172:175], v14, s[36:39], s54 offen sc1
    ds_read_b32 v132, v7 offset:9376
    ds_read_b128 v[104:107], v6
    v_bfe_i32 v19, v11, 4, 1
    v_and_b32 v19, 0x15000, v19
    v_sub_u32 v14, v14, v19
    s_waitcnt lgkmcnt(4)
    v_mfma_f32_16x16x32_bf16 v[160:163], a[204:207], v[208:211], v[160:163]
    v_mul_f32 v192, v192, v197
    v_mul_f32 v193, v193, v197
    v_mfma_f32_16x16x32_bf16 v[164:167], a[208:211], v[208:211], v[164:167]
    v_mul_f32 v194, v194, v197
    v_mul_f32 v195, v195, v197
    v_mfma_f32_16x16x32_bf16 v[168:171], a[212:215], v[208:211], v[168:171]
    v_cvt_pk_bf16_f32 v192, v192, v193
    v_cvt_pk_bf16_f32 v193, v194, v195
    ds_write_b64 v4, v[192:193] offset:30720
    buffer_store_dwordx2 v[180:181], v182, s[36:39], s54 offen sc1
    v_mul_f32 v160, s43, v160
    v_mul_f32 v161, s43, v161
    v_mul_f32 v162, s43, v162
    v_mul_f32 v163, s43, v163
    s_waitcnt lgkmcnt(1)
    v_mfma_f32_16x16x32_bf16 v[104:107], v[24:27], v[72:75], v[104:107]
    v_mul_f32 v164, s43, v164
    v_mul_f32 v165, s43, v165
    v_mfma_f32_16x16x32_bf16 v[104:107], v[28:31], v[76:79], v[104:107]
    v_mul_f32 v166, s43, v166
    v_mul_f32 v167, s43, v167
    v_cvt_pk_bf16_f32 v56, v160, v161
    v_cvt_pk_bf16_f32 v57, v162, v163
    v_cvt_pk_bf16_f32 v58, v164, v165
    v_cvt_pk_bf16_f32 v59, v166, v167
    s_waitcnt lgkmcnt(0)
    s_barrier
    v_mfma_f32_16x16x32_bf16 v[120:123], v[24:27], v[56:59], v[120:123]
    ds_read_b128 v[212:215], v2 offset:24576
    ds_read_b128 v[216:219], v2 offset:25600
    v_mfma_f32_16x16x32_bf16 v[124:127], v[32:35], v[56:59], v[124:127]
    ds_read_b128 v[220:223], v2 offset:26624
    v_mul_f32 v168, s43, v168
    v_mfma_f32_16x16x32_bf16 v[128:131], v[40:43], v[56:59], v[128:131]
    v_mul_f32 v169, s43, v169
    v_mul_f32 v170, s43, v170
    v_mfma_f32_16x16x32_bf16 v[132:135], v[48:51], v[56:59], v[132:135]
    v_mul_f32 v171, s43, v171
    v_cvt_pk_bf16_f32 v60, v168, v169
    v_cvt_pk_bf16_f32 v61, v170, v171
    ds_read_b128 v[108:111], v6 offset:64
    ds_read_b128 v[112:115], v6 offset:128
    v_mfma_f32_16x16x32_bf16 v[120:123], v[28:31], v[60:63], v[120:123]
    s_waitcnt lgkmcnt(4)
    ds_read_b32 v116, v7 offset:9456
    v_add_u32 v14, 0x1f80, v14
    v_mfma_f32_16x16x32_bf16 v[124:127], v[36:39], v[60:63], v[124:127]
    v_exp_f32 v104, v104
    v_mfma_f32_16x16x32_bf16 v[172:175], a[216:219], v[212:215], 0
    s_waitcnt lgkmcnt(4)
    v_exp_f32 v105, v105
    v_mfma_f32_16x16x32_bf16 v[176:179], a[220:223], v[212:215], 0
    v_exp_f32 v120, v120
    v_mfma_f32_16x16x32_bf16 v[180:183], a[224:227], v[212:215], 0
    ds_read_b128 v[212:215], v2 offset:27648
    v_cvt_pk_bf16_f32 v104, v104, v105
    v_mfma_f32_16x16x32_bf16 v[128:131], v[44:47], v[60:63], v[128:131]
    s_waitcnt lgkmcnt(3)
    v_exp_f32 v121, v121
    v_mfma_f32_16x16x32_bf16 v[132:135], v[52:55], v[60:63], v[132:135]
    s_waitcnt lgkmcnt(1)
    v_exp_f32 v122, v122
    v_mfma_f32_16x16x32_bf16 v[172:175], a[228:231], v[216:219], v[172:175]
    v_exp_f32 v123, v123
    v_mfma_f32_16x16x32_bf16 v[176:179], a[232:235], v[216:219], v[176:179]
    v_exp_f32 v124, v124
    v_mfma_f32_16x16x32_bf16 v[180:183], a[236:239], v[216:219], v[180:183]
    ds_read_b128 v[216:219], v2 offset:28672
    v_cvt_pk_bf16_f32 v120, v120, v121
    v_mfma_f32_16x16x32_bf16 v[172:175], a[240:243], v[220:223], v[172:175]
    s_waitcnt lgkmcnt(1)
    v_exp_f32 v125, v125
    v_mfma_f32_16x16x32_bf16 v[176:179], a[244:247], v[220:223], v[176:179]
    v_exp_f32 v126, v126
    v_mfma_f32_16x16x32_bf16 v[180:183], a[248:251], v[220:223], v[180:183]
    ds_read_b128 v[220:223], v2 offset:29696
    v_cvt_pk_bf16_f32 v121, v122, v123
    v_mfma_f32_16x16x32_bf16 v[172:175], a[252:255], v[212:215], v[172:175]
    v_exp_f32 v127, v127
    v_mfma_f32_16x16x32_bf16 v[176:179], v[224:227], v[212:215], v[176:179]
    v_exp_f32 v128, v128
    v_mfma_f32_16x16x32_bf16 v[180:183], v[228:231], v[212:215], v[180:183]
    s_waitcnt lgkmcnt(1)
    ds_read_b128 v[212:215], v2 offset:30720
    v_cvt_pk_bf16_f32 v122, v124, v125
    v_mfma_f32_16x16x32_bf16 v[172:175], v[232:235], v[216:219], v[172:175]
    v_exp_f32 v129, v129
    v_mfma_f32_16x16x32_bf16 v[176:179], v[236:239], v[216:219], v[176:179]
    v_exp_f32 v130, v130
    v_mfma_f32_16x16x32_bf16 v[180:183], v[240:243], v[216:219], v[180:183]
    s_waitcnt lgkmcnt(1)
    ds_read_b128 v[216:219], v2 offset:31744
    v_cvt_pk_bf16_f32 v123, v126, v127
    v_mfma_f32_16x16x32_bf16 v[172:175], v[244:247], v[220:223], v[172:175]
    v_exp_f32 v131, v131
    v_mfma_f32_16x16x32_bf16 v[196:199], v[20:23], v[120:123], 0
    v_exp_f32 v132, v132
    v_mfma_f32_16x16x32_bf16 v[184:187], v[80:83], v[120:123], 0
    v_cvt_pk_bf16_f32 v128, v128, v129
    v_cvt_pk_bf16_f32 v129, v130, v131
    v_mfma_f32_16x16x32_bf16 v[188:191], v[88:91], v[120:123], 0
    v_cvt_pk_bf16_f32 v130, v132, 0
    v_cvt_pk_bf16_f32 v172, v172, v173
    v_mfma_f32_16x16x32_bf16 v[192:195], v[96:99], v[120:123], 0
    v_cvt_pk_bf16_f32 v173, v174, v175
    v_mov_b32 v131, 0
    v_mfma_f32_16x16x32_bf16 v[176:179], v[248:251], v[220:223], v[176:179]
    v_exp_f32 v106, v106
    v_mfma_f32_16x16x32_bf16 v[196:199], v[20:23], v[128:131], v[196:199]
    v_exp_f32 v107, v107
    v_mfma_f32_16x16x32_bf16 v[180:183], v[252:255], v[220:223], v[180:183]
    ds_read_b128 v[220:223], v2 offset:32768
    v_cvt_pk_bf16_f32 v105, v106, v107
    v_mfma_f32_16x16x32_bf16 v[184:187], v[84:87], v[128:131], v[184:187]
    v_mov_b32 v120, s79
    v_cvt_pk_bf16_f32 v174, v176, v177
    v_mfma_f32_16x16x32_bf16 v[188:191], v[92:95], v[128:131], v[188:191]
    v_cvt_pk_bf16_f32 v175, v178, v179
    v_mfma_f32_16x16x32_bf16 v[192:195], v[100:103], v[128:131], v[192:195]
    s_waitcnt lgkmcnt(1)
    v_cvt_pk_bf16_f32 v180, v180, v181
    v_cvt_pk_bf16_f32 v181, v182, v183
    v_mfma_f32_16x16x32_bf16 v[108:111], v[32:35], v[72:75], v[108:111]
    v_add_u32 v182, v12, v10
    v_mfma_f32_16x16x32_bf16 v[112:115], v[40:43], v[72:75], v[112:115]
    v_rcp_f32 v197, v196
    v_mfma_f32_16x16x32_bf16 v[116:119], v[48:51], v[72:75], v[116:119]
    v_mul_f32 v184, v184, v197
    v_mul_f32 v185, v185, v197
    v_mfma_f32_16x16x32_bf16 v[108:111], v[36:39], v[76:79], v[108:111]
    v_mul_f32 v186, v186, v197
    v_mul_f32 v187, v187, v197
    v_mfma_f32_16x16x32_bf16 v[112:115], v[44:47], v[76:79], v[112:115]
    v_cvt_pk_bf16_f32 v184, v184, v185
    v_mul_f32 v188, v188, v197
    v_mfma_f32_16x16x32_bf16 v[176:179], a[220:223], v[212:215], 0
    v_mul_f32 v189, v189, v197
    v_mul_f32 v190, v190, v197
    v_mfma_f32_16x16x32_bf16 v[116:119], v[52:55], v[76:79], v[116:119]
    v_mul_f32 v191, v191, v197
    v_mul_f32 v192, v192, v197
    v_mfma_f32_16x16x32_bf16 v[176:179], a[232:235], v[216:219], v[176:179]
    s_waitcnt lgkmcnt(0)
    v_mul_f32 v193, v193, v197
    v_cvt_pk_bf16_f32 v185, v186, v187
    v_mfma_f32_16x16x32_bf16 v[176:179], a[244:247], v[220:223], v[176:179]
    buffer_store_dwordx4 v[172:175], v12, s[36:39], 0 offen
    v_mul_f32 v194, v194, v197
    v_mul_f32 v195, v195, v197
    v_mfma_f32_16x16x32_bf16 v[172:175], a[216:219], v[212:215], 0
    v_cvt_pk_bf16_f32 v192, v192, v193
    v_cvt_pk_bf16_f32 v186, v188, v189
    v_mfma_f32_16x16x32_bf16 v[172:175], a[228:231], v[216:219], v[172:175]
    v_cvt_pk_bf16_f32 v187, v190, v191
    v_cvt_pk_bf16_f32 v193, v194, v195
    v_mfma_f32_16x16x32_bf16 v[172:175], a[240:243], v[220:223], v[172:175]
    buffer_store_dwordx2 v[180:181], v182, s[36:39], 0 offen
    v_mfma_f32_16x16x32_bf16 v[180:183], a[224:227], v[212:215], 0
    ds_read_b128 v[212:215], v2 offset:33792
    v_max3_f32 v18, v18, v196, v197
    v_mfma_f32_16x16x32_bf16 v[180:183], a[236:239], v[216:219], v[180:183]
    ds_read_b128 v[216:219], v2 offset:34816
    v_mfma_f32_16x16x32_bf16 v[180:183], a[248:251], v[220:223], v[180:183]
    ds_read_b128 v[220:223], v2 offset:35840
    ds_write_b128 v3, v[184:187] offset:36864
    v_exp_f32 v108, v108
    v_exp_f32 v109, v109
    v_exp_f32 v110, v110
    v_cvt_pk_bf16_f32 v106, v108, v109
    s_waitcnt lgkmcnt(3)
    v_mfma_f32_16x16x32_bf16 v[172:175], a[252:255], v[212:215], v[172:175]
    v_exp_f32 v111, v111
    v_mfma_f32_16x16x32_bf16 v[176:179], v[224:227], v[212:215], v[176:179]
    s_waitcnt lgkmcnt(2)
    v_exp_f32 v112, v112
    v_mfma_f32_16x16x32_bf16 v[180:183], v[228:231], v[212:215], v[180:183]
    v_exp_f32 v113, v113
    v_mfma_f32_16x16x32_bf16 v[172:175], v[232:235], v[216:219], v[172:175]
    s_waitcnt lgkmcnt(1)
    v_exp_f32 v114, v114
    v_mfma_f32_16x16x32_bf16 v[176:179], v[236:239], v[216:219], v[176:179]
    v_exp_f32 v115, v115
    v_mfma_f32_16x16x32_bf16 v[180:183], v[240:243], v[216:219], v[180:183]
    v_cvt_pk_bf16_f32 v107, v110, v111
    v_cvt_pk_bf16_f32 v112, v112, v113
    v_mfma_f32_16x16x32_bf16 v[172:175], v[244:247], v[220:223], v[172:175]
    v_exp_f32 v116, v116
    v_mfma_f32_16x16x32_bf16 v[196:199], v[20:23], v[104:107], 0
    v_cvt_pk_bf16_f32 v113, v114, v115
    v_cvt_pk_bf16_f32 v114, v116, 0
    v_mfma_f32_16x16x32_bf16 v[184:187], v[80:83], v[104:107], 0
    v_mov_b32 v115, 0
    v_mfma_f32_16x16x32_bf16 v[188:191], v[88:91], v[104:107], 0
    ds_write_b64 v4, v[192:193] offset:36864
    v_mfma_f32_16x16x32_bf16 v[196:199], v[20:23], v[112:115], v[196:199]
    v_cvt_pk_bf16_f32 v172, v172, v173
    v_cvt_pk_bf16_f32 v173, v174, v175
    v_mfma_f32_16x16x32_bf16 v[192:195], v[96:99], v[104:107], 0
    v_lshrrev_b32 v107, 4, v2
    v_subrev_u32 v107, 0x1500, v107
    v_mfma_f32_16x16x32_bf16 v[176:179], v[248:251], v[220:223], v[176:179]
    v_bfe_u32 v105, v107, 2, 2
    v_mul_u32_u24 v104, 7, v105
    v_mfma_f32_16x16x32_bf16 v[180:183], v[252:255], v[220:223], v[180:183]
    v_rcp_f32 v197, v196
    v_mfma_f32_16x16x32_bf16 v[184:187], v[84:87], v[112:115], v[184:187]
    v_max3_f32 v18, v18, v196, v197
    v_cmp_lt_f32 vcc, 0x53800000, v18
    v_mfma_f32_16x16x32_bf16 v[188:191], v[92:95], v[112:115], v[188:191]
    s_waitcnt lgkmcnt(0)
    s_barrier
    v_mfma_f32_16x16x32_bf16 v[192:195], v[100:103], v[112:115], v[192:195]
    ds_read_b128 v[212:215], v2 offset:36864
    ds_read_b128 v[216:219], v2 offset:37888
    ds_read_b128 v[220:223], v2 offset:38912
    v_cvt_pk_bf16_f32 v174, v176, v177
    v_cvt_pk_bf16_f32 v175, v178, v179
    v_cvt_pk_bf16_f32 v180, v180, v181
    v_cvt_pk_bf16_f32 v181, v182, v183
    v_add_u32 v182, v13, v10
    buffer_store_dwordx4 v[172:175], v13, s[36:39], 0 offen
    v_mul_f32 v184, v184, v197
    v_mul_f32 v185, v185, v197
    v_mul_f32 v186, v186, v197
    v_mul_f32 v187, v187, v197
    v_cvt_pk_bf16_f32 v184, v184, v185
    v_mul_f32 v188, v188, v197
    s_waitcnt lgkmcnt(2)
    v_mfma_f32_16x16x32_bf16 v[176:179], a[220:223], v[212:215], 0
    v_mul_f32 v189, v189, v197
    v_mul_f32 v190, v190, v197
    v_mfma_f32_16x16x32_bf16 v[172:175], a[216:219], v[212:215], 0
    s_waitcnt lgkmcnt(1)
    v_mul_f32 v191, v191, v197
    v_mul_f32 v192, v192, v197
    v_mfma_f32_16x16x32_bf16 v[176:179], a[232:235], v[216:219], v[176:179]
    s_waitcnt lgkmcnt(0)
    v_mul_f32 v193, v193, v197
    v_cvt_pk_bf16_f32 v185, v186, v187
    v_mfma_f32_16x16x32_bf16 v[172:175], a[228:231], v[216:219], v[172:175]
    s_cmp_lg_u64 vcc, 0
    s_cselect_b32 s78, 1, 0
    v_mul_f32 v194, v194, v197
    v_mfma_f32_16x16x32_bf16 v[176:179], a[244:247], v[220:223], v[176:179]
    v_mul_f32 v195, v195, v197
    v_cvt_pk_bf16_f32 v192, v192, v193
    v_mfma_f32_16x16x32_bf16 v[172:175], a[240:243], v[220:223], v[172:175]
    buffer_store_dwordx2 v[180:181], v182, s[36:39], 0 offen
    v_mfma_f32_16x16x32_bf16 v[180:183], a[224:227], v[212:215], 0
    ds_read_b128 v[212:215], v2 offset:39936
    v_cvt_pk_bf16_f32 v186, v188, v189
    v_mfma_f32_16x16x32_bf16 v[180:183], a[236:239], v[216:219], v[180:183]
    ds_read_b128 v[216:219], v2 offset:40960
    v_cvt_pk_bf16_f32 v187, v190, v191
    v_mfma_f32_16x16x32_bf16 v[180:183], a[248:251], v[220:223], v[180:183]
    ds_read_b128 v[220:223], v2 offset:41984
    v_mov_b32 v121, s78
    v_cvt_pk_bf16_f32 v193, v194, v195
    s_mov_b32 exec_lo, 0x10001000
    s_mov_b32 exec_hi, 0x10001000
    ds_write_b128 v3, v[184:187]
    s_mov_b64 exec, -1
    s_waitcnt lgkmcnt(3)
    v_mfma_f32_16x16x32_bf16 v[172:175], a[252:255], v[212:215], v[172:175]
    ds_write_b32 v120, v121
    v_mfma_f32_16x16x32_bf16 v[176:179], v[224:227], v[212:215], v[176:179]
    s_waitcnt lgkmcnt(3)
    v_mov_b32 v120, 0x14000
    v_add_u32 v104, s61, v104
    v_mfma_f32_16x16x32_bf16 v[180:183], v[228:231], v[212:215], v[180:183]
    v_add_u32 v104, 6, v104
    v_subrev_u32 v106, 224, v104
    v_mfma_f32_16x16x32_bf16 v[172:175], v[232:235], v[216:219], v[172:175]
    s_waitcnt lgkmcnt(2)
    v_min_u32 v104, v104, v106
    v_mul_u32_u24 v104, 384, v104
    v_mfma_f32_16x16x32_bf16 v[176:179], v[236:239], v[216:219], v[176:179]
    v_lshrrev_b32 v105, 4, v107
    v_add_u32 v104, s70, v104
    v_mfma_f32_16x16x32_bf16 v[180:183], v[240:243], v[216:219], v[180:183]
    v_lshl_add_u32 v104, v105, 4, v104
    v_and_b32 v105, 3, v107
    v_mfma_f32_16x16x32_bf16 v[172:175], v[244:247], v[220:223], v[172:175]
    v_cmp_eq_u32 vcc, 0, v105
    v_mov_b32 v106, 0x40000000
    v_mfma_f32_16x16x32_bf16 v[176:179], v[248:251], v[220:223], v[176:179]
    v_cndmask_b32 v104, v106, v104, vcc
    v_mfma_f32_16x16x32_bf16 v[180:183], v[252:255], v[220:223], v[180:183]
    s_mov_b32 exec_lo, 0x10001000
    s_mov_b32 exec_hi, 0x10001000
    ds_write_b64 v4, v[192:193]
    s_mov_b64 exec, -1
    v_cvt_pk_bf16_f32 v172, v172, v173
    v_cvt_pk_bf16_f32 v173, v174, v175
    v_cvt_pk_bf16_f32 v174, v176, v177
    v_cvt_pk_bf16_f32 v175, v178, v179
    v_cvt_pk_bf16_f32 v180, v180, v181
    v_cvt_pk_bf16_f32 v181, v182, v183
    v_add_u32 v182, v14, v10
    buffer_store_dwordx4 v[172:175], v14, s[36:39], 0 offen
    s_waitcnt lgkmcnt(0)
    s_barrier
    ds_read_b128 v[212:215], v2
    ds_read_b128 v[216:219], v2 offset:1024
    ds_read_b128 v[220:223], v2 offset:2048
    buffer_store_dwordx2 v[180:181], v182, s[36:39], 0 offen
    ds_read_b128 v[124:127], v120
    s_waitcnt lgkmcnt(3)
    v_mfma_f32_16x16x32_bf16 v[172:175], a[216:219], v[212:215], 0
    v_mfma_f32_16x16x32_bf16 v[176:179], a[220:223], v[212:215], 0
    s_waitcnt lgkmcnt(2)
    v_mfma_f32_16x16x32_bf16 v[180:183], a[224:227], v[212:215], 0
    ds_read_b128 v[212:215], v2 offset:3072
    v_mfma_f32_16x16x32_bf16 v[172:175], a[228:231], v[216:219], v[172:175]
    s_waitcnt lgkmcnt(1)
    v_or3_b32 v124, v124, v125, v126
    v_or_b32 v124, v124, v127
    v_mfma_f32_16x16x32_bf16 v[176:179], a[232:235], v[216:219], v[176:179]
    v_readfirstlane_b32 s79, v124
    v_mfma_f32_16x16x32_bf16 v[180:183], a[236:239], v[216:219], v[180:183]
    ds_read_b128 v[216:219], v2 offset:4096
    v_mfma_f32_16x16x32_bf16 v[172:175], a[240:243], v[220:223], v[172:175]
    v_mfma_f32_16x16x32_bf16 v[176:179], a[244:247], v[220:223], v[176:179]
    v_mfma_f32_16x16x32_bf16 v[180:183], a[248:251], v[220:223], v[180:183]
    s_waitcnt lgkmcnt(1)
    ds_read_b128 v[220:223], v2 offset:5120
    v_mfma_f32_16x16x32_bf16 v[172:175], a[252:255], v[212:215], v[172:175]
    v_mfma_f32_16x16x32_bf16 v[180:183], v[228:231], v[212:215], v[180:183]
    v_mfma_f32_16x16x32_bf16 v[176:179], v[224:227], v[212:215], v[176:179]
    s_waitcnt lgkmcnt(1)
    v_mfma_f32_16x16x32_bf16 v[172:175], v[232:235], v[216:219], v[172:175]
    v_mfma_f32_16x16x32_bf16 v[180:183], v[240:243], v[216:219], v[180:183]
    v_mfma_f32_16x16x32_bf16 v[176:179], v[236:239], v[216:219], v[176:179]
    s_waitcnt lgkmcnt(0)
    v_mfma_f32_16x16x32_bf16 v[172:175], v[244:247], v[220:223], v[172:175]
    v_mfma_f32_16x16x32_bf16 v[180:183], v[252:255], v[220:223], v[180:183]
    v_mfma_f32_16x16x32_bf16 v[176:179], v[248:251], v[220:223], v[176:179]
    s_nop 5
    v_cvt_pk_bf16_f32 v172, v172, v173
    v_cvt_pk_bf16_f32 v180, v180, v181
    v_cvt_pk_bf16_f32 v173, v174, v175
    v_cvt_pk_bf16_f32 v181, v182, v183
    v_cvt_pk_bf16_f32 v174, v176, v177
    v_cvt_pk_bf16_f32 v175, v178, v179
    v_add_u32 v182, v104, v10
    buffer_store_dwordx4 v[172:175], v104, s[36:39], 0 offen
    buffer_store_dwordx2 v[180:181], v182, s[36:39], 0 offen
    s_nop 1
    s_cmp_lg_u32 s79, 0
    s_cbranch_scc1 L_safe
L_exit:
    s_endpgm
L_codeend:
L_safe:
    s_waitcnt vmcnt(0) lgkmcnt(0)
    s_barrier
    v_mbcnt_lo_u32_b32 v0, -1, 0
    v_mbcnt_hi_u32_b32 v0, -1, v0
    s_lshl_b32 s3, s40, 6
    v_add_u32 v0, s3, v0
    s_load_dwordx8 s[8:15], s[0:1], 0
    s_load_dwordx2 s[16:17], s[0:1], 48
    v_lshrrev_b32 v136, 6, v0
    v_and_b32 v120, 63, v0
    v_readfirstlane_b32 s40, v136
    s_and_b32 s63, s40, 1
    s_lshr_b32 s64, s40, 1
    v_lshrrev_b32 v132, 3, v120
    s_lshl_b32 s69, s63, 3
    s_lshl_b32 s71, s64, 4
    v_add_u32 v41, s69, v132
    v_add_u32 v42, s71, v41
    v_mul_u32_u24 v43, 37, v42
    s_lshr_b32 s41, s2, 3
    v_lshrrev_b32 v43, 8, v43
    s_mul_i32 s60, s41, 7
    v_mul_u32_u24 v44, 7, v43
    s_add_u32 s60, s60, 3
    v_sub_u32 v134, v42, v44
    v_add_u32 v44, s60, v43
    s_and_b32 s42, s2, 7
    v_subrev_u32 v45, 224, v44
    s_mov_b32 s62, 86016
    s_mul_i32 s61, s42, 28
    v_min_u32 v44, v44, v45
    s_add_u32 s61, s61, 3
    v_mul_u32_u24 v8, s62, v44
    v_bfe_u32 v48, v41, 1, 3
    v_add_u32 v44, s61, v134
    v_and_b32 v133, 7, v120
    v_mul_u32_u24 v44, 384, v44
    v_xor_b32 v48, v48, v133
    v_add_u32 v8, v8, v44
    s_mov_b32 s34, 1352
    s_mov_b32 s35, 0x20000
    s_lshl_b32 s72, s63, 10
    s_mul_i32 s45, s64, 6144
    v_lshl_add_u32 v8, v48, 4, v8
    s_add_u32 s45, s45, s72
    s_mov_b32 s52, 0
    s_mov_b32 s22, 19267584
    s_mov_b32 s23, 0x20000
    s_lshl_b32 s70, s64, 3
    v_add_u32 v49, s70, v132
    v_add_u32 v50, 32, v49
    v_mul_u32_u24 v51, 37, v50
    v_lshrrev_b32 v51, 8, v51
    v_mul_u32_u24 v52, 7, v51
    v_lshlrev_b32 v41, 3, v0
    v_sub_u32 v135, v50, v52
    v_add_u32 v52, s60, v51
    v_subrev_u32 v53, 224, v52
    s_waitcnt lgkmcnt(0)
    s_mov_b32 s32, s14
    s_and_b32 s33, s15, 0xffff
    s_mov_b32 s20, s8
    s_and_b32 s21, s9, 0xffff
    v_min_u32 v52, v52, v53
    buffer_load_dwordx2 v[124:125], v41, s[32:35], 0 offen
    v_mul_u32_u24 v9, s62, v52
    s_add_u32 m0, s45, 0
    v_add_u32 v52, s61, v135
    buffer_load_dwordx4 v8, s[20:23], s52 offen nt lds
    v_bfe_u32 v40, v49, 1, 3
    v_mul_u32_u24 v52, 384, v52
    s_add_u32 m0, s45, 1920
    s_lshl_b32 s68, s63, 12
    s_lshl_b32 s73, s64, 10
    v_xor_b32 v40, v40, v133
    v_add_u32 v9, v9, v52
    s_add_u32 s46, s73, s68
    v_lshl_add_u32 v9, v40, 4, v9
    s_add_u32 s46, s46, 12288
    s_lshl_b32 s56, s63, 8
    buffer_load_dwordx4 v8, s[20:23], s52 offen offset:128 nt lds
    s_add_u32 m0, s45, 3840
    s_sub_u32 s51, 0, s63
    s_add_u32 s47, s73, 14208
    s_not_b32 s50, s51
    s_mul_i32 s76, s40, 7
    s_add_u32 s66, s60, 6
    s_mov_b32 s26, 221184
    s_mov_b32 s30, 73728
    s_mov_b32 s24, s10
    s_and_b32 s25, s11, 0xffff
    s_mov_b32 s28, s12
    s_and_b32 s29, s13, 0xffff
    s_add_u32 s76, s76, s61
    s_cmp_ge_u32 s66, 224
    s_cselect_b32 s67, 224, 0
    s_cmp_eq_u32 s40, 3
    s_cselect_b32 s12, s28, s24
    s_cselect_b32 s13, s29, s25
    s_cselect_b32 s14, s30, s26
    s_mov_b32 s15, 0x20000
    s_cselect_b32 s7, 0, s40
    s_mul_i32 s7, s7, 18
    buffer_load_dwordx4 v8, s[20:23], s52 offen offset:256 nt lds
    s_add_u32 m0, s46, 0
    s_add_u32 s76, s76, 6
    s_sub_u32 s66, s66, s67
    v_add_u32 v43, s7, v120
    s_cmp_ge_u32 s76, 224
    s_cselect_b32 s67, 224, 0
    s_mov_b32 s3, 0x2AAAAAAB
    v_lshlrev_b32 v42, 4, v120
    v_add_u32 v44, 0, v120
    v_lshlrev_b32 v43, 5, v43
    s_sub_u32 s76, s76, s67
    s_mul_i32 s66, s66, 86016
    buffer_load_dwordx4 v9, s[20:23], s56 offen nt lds
    s_add_u32 m0, s47, 0
    v_mul_hi_u32 v126, v44, s3
    v_add_u32 v43, s41, v43
    s_mul_i32 s76, s76, 384
    s_mul_i32 s67, s40, 384
    v_add_u32 v51, 64, v120
    v_lshlrev_b32 v44, 4, v44
    v_mul_u32_u24 v45, 96, v126
    v_bfe_u32 v49, v126, 2, 2
    v_and_b32 v48, 3, v126
    v_lshlrev_b32 v43, 7, v43
    s_add_u32 s76, s76, s66
    s_mul_i32 s65, s40, 96
    v_lshrrev_b32 v50, 4, v126
    v_mul_hi_u32 v127, v51, s3
    v_sub_u32 v129, v44, v45
    s_mov_b64 exec, s[50:51]
    buffer_load_dwordx4 v9, s[20:23], s52 offen offset:128 nt lds
    s_mov_b64 exec, -1
    s_add_u32 m0, s67, 36864
    v_lshl_add_u32 v49, v49, 3, v48
    s_movk_i32 s6, 0x480
    v_lshlrev_b32 v51, 4, v51
    v_mul_u32_u24 v52, 96, v127
    v_bfe_u32 v40, v127, 2, 2
    v_and_b32 v53, 3, v127
    v_add_u32 v129, s65, v129
    v_lshl_add_u32 v49, v50, 2, v49
    s_mul_i32 s48, s40, 3072
    v_lshrrev_b32 v41, 4, v127
    v_sub_u32 v130, v51, v52
    v_lshl_add_u32 v40, v40, 3, v53
    v_mad_u32_u24 v212, v49, s6, v129
    s_mov_b64 exec, 0xffffff
    buffer_load_dwordx4 v42, s[20:23], s76 offen nt lds
    s_mov_b64 exec, -1
    v_add_u32 v42, 0x80, v120
    v_mul_hi_u32 v128, v42, s3
    s_mov_b64 exec, 0x3ffff
    buffer_load_dword v254, v43, s[12:15], 0 offen
    s_mov_b64 exec, -1
    s_add_u32 s48, s48, 86016
    s_add_u32 m0, s48, 0
    v_add_u32 v130, s65, v130
    v_lshl_add_u32 v40, v41, 2, v40
    v_lshlrev_b32 v42, 4, v42
    v_bfe_u32 v45, v128, 2, 2
    v_and_b32 v44, 3, v128
    v_mul_u32_u24 v43, 96, v128
    s_mov_b32 s27, 0x20000
    s_mov_b32 s74, 384
    buffer_load_dwordx4 v212, s[24:27], s74 offen lds
    s_add_u32 m0, s48, 1024
    v_lshrrev_b32 v48, 4, v128
    v_mad_u32_u24 v213, v40, s6, v130
    v_lshl_add_u32 v45, v45, 3, v44
    v_sub_u32 v131, v42, v43
    v_lshl_add_u32 v45, v48, 2, v45
    v_add_u32 v131, s65, v131
    v_mad_u32_u24 v214, v45, s6, v131
    v_lshlrev_b32 v49, 4, v120
    v_mov_b32 v184, 0
    v_mov_b32 v185, 0
    buffer_load_dwordx4 v213, s[24:27], s74 offen lds
    s_add_u32 m0, s48, 2048
    v_mov_b32 v186, 0
    v_mov_b32 v187, 0
    v_add_u32 v49, 0x9600, v49
    s_mov_b32 exec_lo, 0xffffff
    s_mov_b32 exec_hi, 0x0
    ds_write_b128 v49, v[184:187]
    s_mov_b64 exec, -1
    s_mov_b32 s53, 2688
    s_add_u32 s57, s56, 2688
    buffer_load_dwordx4 v214, s[24:27], s74 offen lds
    s_mov_b32 s31, 0x20000
    v_lshlrev_b32 v28, 2, v120
    s_mov_b32 s54, 5376
    s_add_u32 s58, s56, 5376
    s_mov_b32 s38, 19267584
    s_mov_b32 s39, 0x20000
    s_mov_b32 s36, s16
    s_and_b32 s37, s17, 0xffff
    v_lshrrev_b32 v122, 4, v120
    v_bfe_u32 v50, v120, 2, 2
    v_lshl_add_u32 v50, v122, 2, v50
    v_mul_u32_u24 v50, 0x60, v50
    v_and_b32 v51, 3, v120
    v_add_u32 v50, s48, v50
    v_lshl_add_u32 v221, v51, 3, v50
    v_and_b32 v121, 15, v120
    s_lshl_b32 s3, s63, 5
    v_lshl_add_u32 v222, v51, 4, v50
    v_add_u32 v222, s3, v222
    s_lshl_b32 s3, s40, 8
    v_add_u32 v28, s3, v28
    v_add_u32 v28, 0x14000, v28
    v_bfe_u32 v52, v121, 1, 3
    v_xor_b32 v52, v52, v122
    v_lshlrev_b32 v52, 4, v52
    v_lshrrev_b32 v40, 2, v121
    v_and_b32 v41, 3, v121
    v_lshl_add_u32 v0, v121, 7, v52
    v_mul_u32_u24 v40, 0x180, v40
    v_cmp_eq_u32 vcc, 0, v41
    v_lshl_add_u32 v40, v122, 4, v40
    v_mov_b32 v41, 0x9600
    v_add_u32 v40, 0x9000, v40
    v_xor_b32 v1, 64, v0
    v_cndmask_b32 v223, v41, v40, vcc
    v_add_u32 v24, 0, v121
    s_mul_i32 s77, s40, 1024
    v_mul_u32_u24 v25, 37, v24
    s_add_u32 s77, s77, 81920
    v_lshrrev_b32 v25, 8, v25
    v_lshlrev_b32 v24, 2, v24
    s_add_u32 s78, s77, 336
    v_mad_u32_u24 v25, v25, 24, v24
    v_add_u32 v26, 16, v121
    v_add_u32 v104, s78, v25
    v_add_u32 v24, 32, v121
    v_mul_u32_u24 v27, 37, v26
    v_mul_u32_u24 v25, 37, v24
    v_lshrrev_b32 v27, 8, v27
    v_lshlrev_b32 v26, 2, v26
    v_lshrrev_b32 v25, 8, v25
    v_lshlrev_b32 v24, 2, v24
    v_lshlrev_b32 v107, 2, v122
    v_mad_u32_u24 v27, v27, 24, v26
    v_mad_u32_u24 v25, v25, 24, v24
    v_add_u32 v105, s78, v27
    v_add_u32 v26, 1, v107
    v_add_u32 v106, s78, v25
    v_add_u32 v24, 0, v107
    v_mul_u32_u24 v27, 37, v26
    v_mul_u32_u24 v25, 37, v24
    v_lshrrev_b32 v27, 8, v27
    v_lshlrev_b32 v26, 2, v26
    v_lshrrev_b32 v25, 8, v25
    v_lshlrev_b32 v24, 2, v24
    v_mad_u32_u24 v67, v27, 24, v26
    v_mad_u32_u24 v66, v25, 24, v24
    v_add_u32 v26, 3, v107
    v_add_u32 v24, 2, v107
    v_mul_u32_u24 v27, 37, v26
    v_mul_u32_u24 v25, 37, v24
    v_lshrrev_b32 v27, 8, v27
    s_waitcnt vmcnt(10)
    v_lshlrev_b32 v100, 16, v124
    v_and_b32 v101, 0xffff0000, v124
    v_lshlrev_b32 v102, 16, v125
    v_and_b32 v103, 0xffff0000, v125
    v_lshlrev_b32 v26, 2, v26
    v_lshrrev_b32 v25, 8, v25
    v_lshlrev_b32 v24, 2, v24
    v_mad_u32_u24 v69, v27, 24, v26
    v_mad_u32_u24 v68, v25, 24, v24
    v_add_u32 v26, 17, v107
    v_add_u32 v24, 16, v107
    v_mul_u32_u24 v27, 37, v26
    v_mul_u32_u24 v25, 37, v24
    v_lshrrev_b32 v27, 8, v27
    v_lshlrev_b32 v26, 2, v26
    v_lshrrev_b32 v25, 8, v25
    v_lshlrev_b32 v24, 2, v24
    v_mad_u32_u24 v73, v27, 24, v26
    v_mad_u32_u24 v72, v25, 24, v24
    v_add_u32 v26, 19, v107
    v_add_u32 v24, 18, v107
    v_mul_u32_u24 v27, 37, v26
    v_mul_u32_u24 v25, 37, v24
    v_lshrrev_b32 v27, 8, v27
    v_lshlrev_b32 v26, 2, v26
    v_lshrrev_b32 v25, 8, v25
    v_lshlrev_b32 v24, 2, v24
    v_mad_u32_u24 v75, v27, 24, v26
    v_mad_u32_u24 v74, v25, 24, v24
    s_mov_b32 s44, 0x3fb8aa3b
    v_mul_f32 v100, s44, v100
    v_mul_f32 v101, s44, v101
    v_mul_f32 v102, s44, v102
    v_mul_f32 v103, s44, v103
    ds_write_b32 v28, v100
    ds_write_b32 v28, v101 offset:1024
    ds_write_b32 v28, v102 offset:2048
    ds_write_b32 v28, v103 offset:3072
    v_add_u32 v26, 33, v107
    v_add_u32 v24, 32, v107
    v_mul_u32_u24 v27, 37, v26
    v_mul_u32_u24 v25, 37, v24
    v_lshrrev_b32 v37, 2, v121
    v_lshrrev_b32 v27, 8, v27
    v_lshlrev_b32 v26, 2, v26
    v_lshrrev_b32 v25, 8, v25
    v_lshlrev_b32 v24, 2, v24
    v_and_b32 v123, 3, v121
    v_lshlrev_b32 v37, 4, v37
    v_mad_u32_u24 v77, v27, 24, v26
    v_mad_u32_u24 v76, v25, 24, v24
    v_min_u32 v35, 48, v120
    v_add3_u32 v37, v37, v123, v107
    v_add_u32 v26, 35, v107
    v_add_u32 v24, 34, v107
    v_mul_u32_u24 v36, 37, v35
    v_mul_u32_u24 v123, 37, v37
    v_mul_u32_u24 v27, 37, v26
    v_mul_u32_u24 v25, 37, v24
    v_sub_u32 v225, v104, v67
    s_waitcnt lgkmcnt(0)
    s_barrier
    ds_read_b32 v81, v225
    v_sub_u32 v237, v105, v67
    ds_read_b32 v93, v237
    v_sub_u32 v249, v106, v67
    ds_read_b32 v185, v249
    v_sub_u32 v224, v104, v66
    ds_read_b32 v80, v224
    v_sub_u32 v236, v105, v66
    ds_read_b32 v92, v236
    v_sub_u32 v248, v106, v66
    ds_read_b32 v184, v248
    v_sub_u32 v227, v104, v69
    ds_read_b32 v83, v227
    v_sub_u32 v239, v105, v69
    ds_read_b32 v95, v239
    v_sub_u32 v251, v106, v69
    ds_read_b32 v187, v251
    v_sub_u32 v226, v104, v68
    ds_read_b32 v82, v226
    v_sub_u32 v238, v105, v68
    ds_read_b32 v94, v238
    v_sub_u32 v250, v106, v68
    ds_read_b32 v186, v250
    v_lshlrev_b32 v34, 2, v37
    v_lshrrev_b32 v36, 8, v36
    v_lshlrev_b32 v35, 2, v35
    v_lshrrev_b32 v123, 8, v123
    v_lshrrev_b32 v27, 8, v27
    v_lshlrev_b32 v26, 2, v26
    v_lshrrev_b32 v25, 8, v25
    v_lshlrev_b32 v24, 2, v24
    s_add_u32 s79, s77, 672
    v_sub_u32 v229, v104, v73
    ds_read_b32 v85, v229
    v_sub_u32 v241, v105, v73
    ds_read_b32 v97, v241
    v_sub_u32 v253, v106, v73
    ds_read_b32 v189, v253
    v_sub_u32 v228, v104, v72
    ds_read_b32 v84, v228
    v_sub_u32 v240, v105, v72
    ds_read_b32 v96, v240
    v_sub_u32 v252, v106, v72
    ds_read_b32 v188, v252
    v_sub_u32 v231, v104, v75
    ds_read_b32 v87, v231
    v_sub_u32 v243, v105, v75
    ds_read_b32 v99, v243
    v_sub_u32 v57, v106, v75
    ds_read_b32 v191, v57
    v_sub_u32 v230, v104, v74
    ds_read_b32 v86, v230
    v_sub_u32 v242, v105, v74
    ds_read_b32 v98, v242
    v_sub_u32 v56, v106, v74
    ds_read_b32 v190, v56
    v_mad_u32_u24 v36, v36, 24, v35
    v_mad_u32_u24 v123, v123, 24, v34
    v_mad_u32_u24 v199, v27, 24, v26
    v_mad_u32_u24 v198, v25, 24, v24
    v_sub_u32 v233, v104, v77
    ds_read_b32 v89, v233
    v_sub_u32 v245, v105, v77
    ds_read_b32 v101, v245
    v_sub_u32 v59, v106, v77
    ds_read_b32 v193, v59
    v_sub_u32 v232, v104, v76
    ds_read_b32 v88, v232
    v_sub_u32 v244, v105, v76
    ds_read_b32 v100, v244
    v_sub_u32 v58, v106, v76
    ds_read_b32 v192, v58
    v_add_u32 v64, s77, v36
    ds_read_b32 v196, v64
    v_sub_u32 v65, s79, v123
    ds_read_b32 v197, v65
    v_sub_u32 v235, v104, v199
    ds_read_b32 v91, v235
    v_sub_u32 v247, v105, v199
    ds_read_b32 v103, v247
    v_sub_u32 v61, v106, v199
    ds_read_b32 v195, v61
    v_sub_u32 v234, v104, v198
    ds_read_b32 v90, v234
    v_sub_u32 v246, v105, v198
    ds_read_b32 v102, v246
    v_sub_u32 v60, v106, v198
    ds_read_b32 v194, v60
    s_mul_i32 s49, s40, 9728
    v_lshlrev_b32 v43, 4, v120
    s_add_u32 s49, s49, 43008
    v_mul_u32_u24 v33, 80, v122
    v_add_u32 v5, s49, v43
    v_mul_u32_u24 v29, 80, v120
    v_lshl_add_u32 v33, v121, 2, v33
    v_mov_b32 v32, 0xf149f2ca
    v_add_u32 v34, s49, v34
    v_add_u32 v29, s49, v29
    v_add_u32 v33, s49, v33
    s_waitcnt lgkmcnt(15)
    ds_write_b128 v5, v[80:83]
    v_lshlrev_b32 v42, 4, v122
    v_add_u32 v42, s49, v42
    v_add_u32 v6, 0x2540, v42
    ds_write_b128 v5, v[92:95] offset:3072
    s_add_u32 m0, s48, 12288
    s_mov_b32 s75, 37248
    buffer_load_dwordx4 v212, s[24:27], s75 offen lds
    s_add_u32 m0, s48, 13312
    s_mov_b32 s74, 74112
    v_mul_u32_u24 v48, 0x180, v127
    ds_write_b128 v5, v[184:187] offset:6144
    buffer_load_dwordx4 v213, s[24:27], s75 offen lds
    s_add_u32 m0, s48, 14336
    v_mul_u32_u24 v44, 0x180, v126
    ds_write_b128 v5, v[84:87] offset:1024
    v_add_u32 v216, v48, v130
    v_add_u32 v215, v44, v129
    v_add_u32 v48, 0, v121
    v_lshrrev_b32 v45, 4, v126
    v_mul_u32_u24 v44, 37, v48
    v_mul_u32_u24 v45, 0x3000, v45
    ds_write_b128 v5, v[96:99] offset:4096
    buffer_load_dwordx4 v214, s[24:27], s75 offen lds
    s_add_u32 m0, s48, 24576
    s_mov_b32 s75, 110976
    v_lshrrev_b32 v44, 8, v44
    s_cmp_eq_u32 s42, 7
    s_cselect_b32 s68, 4, 64
    s_waitcnt lgkmcnt(15)
    ds_write_b128 v5, v[188:191] offset:7168
    v_add_u32 v218, v215, v45
    v_mul_u32_u24 v41, 7, v44
    v_cmp_le_u32 vcc, s68, v134
    buffer_load_dwordx4 v212, s[24:27], s74 offen lds
    s_waitcnt lgkmcnt(12)
    s_mov_b32 exec_lo, 0xfff0fff
    s_mov_b32 exec_hi, 0xfff0fff
    ds_write_b32 v34, v197 offset:9536
    s_mov_b64 exec, -1
    s_mov_b32 exec_lo, 0xf
    s_mov_b32 exec_hi, 0x0
    ds_write_b32 v29, v32 offset:9280
    s_mov_b64 exec, -1
    ds_write_b32 v33, v196 offset:9216
    s_waitcnt lgkmcnt(11)
    ds_write_b128 v5, v[88:91] offset:2048
    s_add_u32 m0, s48, 25600
    v_sub_u32 v45, v48, v41
    buffer_load_dwordx4 v213, s[24:27], s74 offen lds
    s_add_u32 m0, s48, 26624
    s_waitcnt lgkmcnt(11)
    ds_write_b128 v5, v[100:103] offset:5120
    v_add_u32 v41, s60, v44
    v_mov_b32 v52, 1
    buffer_load_dwordx4 v214, s[24:27], s74 offen lds
    s_waitcnt lgkmcnt(11)
    ds_write_b128 v5, v[192:195] offset:8192
    s_add_u32 m0, s48, 36864
    s_mov_b32 s74, 147840
    v_subrev_u32 v42, 224, v41
    v_cndmask_b32 v52, 0, v52, vcc
    v_min_u32 v41, v41, v42
    v_cmp_le_u32 vcc, s68, v135
    v_mul_u32_u24 v12, s62, v41
    v_add_u32 v41, s61, v45
    buffer_load_dwordx4 v212, s[24:27], s75 offen lds
    s_add_u32 m0, s48, 37888
    v_mov_b32 v53, 2
    v_mul_u32_u24 v41, 384, v41
    s_lshl_b32 s7, s63, 5
    v_cndmask_b32 v53, 0, v53, vcc
    v_add_u32 v12, v12, v41
    s_add_u32 s7, s7, s65
    v_cmp_le_u32 vcc, s68, v45
    v_lshl_add_u32 v41, v122, 4, v12
    v_mov_b32 v11, 0
    v_add_u32 v12, s7, v41
    v_or_b32 v11, v11, v52
    v_mov_b32 v41, 4
    v_or_b32 v11, v11, v53
    v_cndmask_b32 v41, 0, v41, vcc
    v_or_b32 v11, v11, v41
    buffer_load_dwordx4 v213, s[24:27], s75 offen lds
    s_add_u32 m0, s48, 38912
    s_waitcnt vmcnt(12)
    s_barrier
    ds_read_b128 v[200:203], v0
    ds_read_b128 v[204:207], v0 offset:6144
    ds_read_b128 v[108:111], v223
    ds_read_b128 v[112:115], v1
    buffer_load_dwordx4 v214, s[24:27], s75 offen lds
    s_add_u32 m0, s48, 49152
    s_mov_b32 s75, 184704
    ds_read_b128 v[116:119], v1 offset:6144
    s_waitcnt vmcnt(9)
    ds_read_b64_tr_b16 a[0:1], v221
    ds_read_b64_tr_b16 a[2:3], v221 offset:1536
    buffer_load_dwordx4 v212, s[24:27], s74 offen lds
    s_add_u32 m0, s48, 50176
    ds_read_b64_tr_b16 a[4:5], v221 offset:32
    ds_read_b64_tr_b16 a[6:7], v221 offset:1568
    ds_read_b64_tr_b16 a[8:9], v221 offset:64
    ds_read_b64_tr_b16 a[10:11], v221 offset:1600
    ds_read_b128 v[208:211], v0 offset:12288
    v_lshrrev_b32 v42, 2, v45
    v_lshrrev_b32 v41, 2, v44
    v_lshrrev_b32 v49, 4, v127
    v_lshl_add_u32 v43, v41, 1, v42
    v_mul_u32_u24 v49, 0x3000, v49
    v_cmp_eq_u32 vcc, v43, v122
    v_mul_u32_u24 v50, 0x180, v128
    s_waitcnt lgkmcnt(5)
    v_mfma_f32_16x16x32_bf16 v[136:139], a[0:3], v[200:203], 0
    v_add_u32 v219, v216, v49
    s_cmp_eq_u32 s41, 31
    s_cselect_b32 s72, 2, 0
    v_mfma_f32_16x16x32_bf16 v[148:151], a[0:3], v[204:207], 0
    buffer_load_dwordx4 v213, s[24:27], s74 offen lds
    s_add_u32 m0, s48, 51200
    s_waitcnt lgkmcnt(3)
    v_mfma_f32_16x16x32_bf16 v[140:143], a[4:7], v[200:203], 0
    v_mov_b32 v41, 0x3f803f80
    v_add_u32 v217, v50, v131
    v_mfma_f32_16x16x32_bf16 v[152:155], a[4:7], v[204:207], 0
    s_waitcnt lgkmcnt(1)
    v_xor_b32 v49, v43, v122
    v_cndmask_b32 v15, 0, v41, vcc
    v_mfma_f32_16x16x32_bf16 v[144:147], a[8:11], v[200:203], 0
    s_waitcnt lgkmcnt(0)
    ds_read_b128 v[200:203], v1 offset:12288
    v_and_b32 v50, s72, v49
    v_mfma_f32_16x16x32_bf16 v[156:159], a[8:11], v[204:207], 0
    buffer_load_dwordx4 v214, s[24:27], s74 offen lds
    s_add_u32 m0, s48, 61440
    v_mfma_f32_16x16x32_bf16 v[172:175], a[0:3], v[108:111], 0
    s_mov_b32 s74, 0
    ds_read_b128 v[204:207], v223 offset:64
    v_cmp_ne_u32 vcc, 0, v50
    v_mfma_f32_16x16x32_bf16 v[176:179], a[4:7], v[108:111], 0
    s_cmp_eq_u32 s42, 7
    s_cselect_b32 s73, 1, 0
    v_mov_b32 v41, 0xbe8ac310
    v_mfma_f32_16x16x32_bf16 v[180:183], a[8:11], v[108:111], 0
    ds_read_b128 v[108:111], v0 offset:8192
    s_or_b32 s73, s73, s72
    v_mfma_f32_16x16x32_bf16 v[160:163], a[0:3], v[208:211], 0
    v_cndmask_b32 v30, 0, v41, vcc
    v_and_b32 v50, s73, v49
    v_mfma_f32_16x16x32_bf16 v[164:167], a[4:7], v[208:211], 0
    buffer_load_dwordx4 v212, s[24:27], s75 offen lds
    s_add_u32 m0, s48, 62464
    v_mfma_f32_16x16x32_bf16 v[168:171], a[8:11], v[208:211], 0
    ds_read_b128 v[208:211], v0 offset:2048
    v_lshlrev_b32 v40, 4, v120
    v_cmp_ne_u32 vcc, 0, v50
    v_lshrrev_b32 v51, 4, v128
    v_add_u32 v42, 16, v121
    v_add_u32 v2, 0x15000, v40
    v_mov_b32 v41, 32
    v_mul_u32_u24 v51, 0x3000, v51
    v_mul_u32_u24 v40, 37, v42
    v_cndmask_b32 v41, 0, v41, vcc
    v_add_u32 v220, v217, v51
    buffer_load_dwordx4 v213, s[24:27], s75 offen lds
    s_add_u32 m0, s48, 63488
    v_lshrrev_b32 v40, 8, v40
    v_or_b32 v11, v11, v41
    v_mul_u32_u24 v51, 7, v40
    v_sub_u32 v41, v42, v51
    v_add_u32 v51, s60, v40
    v_subrev_u32 v52, 224, v51
    v_min_u32 v51, v51, v52
    v_mul_u32_u24 v13, s62, v51
    s_waitcnt vmcnt(11)
    ds_read_b64_tr_b16 a[12:13], v221 offset:12288
    ds_read_b64_tr_b16 a[14:15], v221 offset:13824
    buffer_load_dwordx4 v214, s[24:27], s75 offen lds
    s_add_u32 m0, s48, 0
    ds_read_b64_tr_b16 a[16:17], v221 offset:12320
    ds_read_b64_tr_b16 a[18:19], v221 offset:13856
    ds_read_b64_tr_b16 a[20:21], v221 offset:12352
    ds_read_b64_tr_b16 a[22:23], v221 offset:13888
    s_mov_b32 s75, 36864
    v_add_u32 v51, s61, v41
    v_mul_u32_u24 v51, 384, v51
    v_add_u32 v13, v13, v51
    v_cmp_le_u32 vcc, s68, v41
    v_lshl_add_u32 v51, v122, 4, v13
    v_add_u32 v13, s7, v51
    v_mov_b32 v51, 8
    v_cndmask_b32 v51, 0, v51, vcc
    s_waitcnt lgkmcnt(4)
    v_mfma_f32_16x16x32_bf16 v[136:139], a[12:15], v[112:115], v[136:139]
    v_or_b32 v11, v11, v51
    v_lshrrev_b32 v52, 2, v41
    v_mfma_f32_16x16x32_bf16 v[148:151], a[12:15], v[116:119], v[148:151]
    buffer_load_dwordx4 v212, s[24:27], s74 offen lds
    s_add_u32 m0, s48, 1024
    s_waitcnt lgkmcnt(2)
    v_mfma_f32_16x16x32_bf16 v[140:143], a[16:19], v[112:115], v[140:143]
    v_lshrrev_b32 v51, 2, v40
    v_lshl_add_u32 v53, v51, 1, v52
    v_mfma_f32_16x16x32_bf16 v[152:155], a[16:19], v[116:119], v[152:155]
    s_waitcnt lgkmcnt(0)
    v_cmp_eq_u32 vcc, v53, v122
    v_mov_b32 v51, 0x3f803f80
    v_mfma_f32_16x16x32_bf16 v[144:147], a[20:23], v[112:115], v[144:147]
    ds_read_b128 v[112:115], v0 offset:14336
    v_xor_b32 v43, v53, v122
    v_mfma_f32_16x16x32_bf16 v[156:159], a[20:23], v[116:119], v[156:159]
    buffer_load_dwordx4 v213, s[24:27], s74 offen lds
    s_add_u32 m0, s48, 2048
    v_mfma_f32_16x16x32_bf16 v[160:163], a[12:15], v[200:203], v[160:163]
    ds_read_b128 v[116:119], v223 offset:128
    v_cndmask_b32 v70, 0, v51, vcc
    v_mfma_f32_16x16x32_bf16 v[172:175], a[12:15], v[204:207], v[172:175]
    v_and_b32 v44, s72, v43
    v_cmp_ne_u32 vcc, 0, v44
    v_mfma_f32_16x16x32_bf16 v[164:167], a[16:19], v[200:203], v[164:167]
    v_mov_b32 v51, 0xbe8ac310
    v_and_b32 v44, s73, v43
    v_mfma_f32_16x16x32_bf16 v[176:179], a[16:19], v[204:207], v[176:179]
    v_cndmask_b32 v38, 0, v51, vcc
    v_cmp_ne_u32 vcc, 0, v44
    v_mfma_f32_16x16x32_bf16 v[168:171], a[20:23], v[200:203], v[168:171]
    buffer_load_dwordx4 v214, s[24:27], s74 offen lds
    s_add_u32 m0, s48, 12288
    v_mfma_f32_16x16x32_bf16 v[180:183], a[20:23], v[204:207], v[180:183]
    s_waitcnt vmcnt(12)
    ds_read_b64_tr_b16 a[24:25], v221 offset:24576
    ds_read_b64_tr_b16 a[26:27], v221 offset:26112
    buffer_load_dwordx4 v212, s[24:27], s75 offen lds
    s_add_u32 m0, s48, 13312
    ds_read_b64_tr_b16 a[28:29], v221 offset:24608
    ds_read_b64_tr_b16 a[30:31], v221 offset:26144
    ds_read_b64_tr_b16 a[32:33], v221 offset:24640
    ds_read_b64_tr_b16 a[34:35], v221 offset:26176
    s_mov_b32 s74, 73728
    ds_read_b128 v[200:203], v1 offset:2048
    s_waitcnt lgkmcnt(5)
    v_mfma_f32_16x16x32_bf16 v[148:151], a[24:27], v[108:111], v[148:151]
    ds_read_b128 v[204:207], v1 offset:8192
    v_add_u32 v52, 32, v121
    v_mfma_f32_16x16x32_bf16 v[160:163], a[24:27], v[112:115], v[160:163]
    v_mov_b32 v51, 64
    v_mul_u32_u24 v50, 37, v52
    v_mfma_f32_16x16x32_bf16 v[172:175], a[24:27], v[116:119], v[172:175]
    buffer_load_dwordx4 v213, s[24:27], s75 offen lds
    v_mfma_f32_16x16x32_bf16 v[136:139], a[24:27], v[208:211], v[136:139]
    s_waitcnt lgkmcnt(4)
    s_add_u32 m0, s48, 14336
    v_cndmask_b32 v51, 0, v51, vcc
    v_lshrrev_b32 v50, 8, v50
    v_mfma_f32_16x16x32_bf16 v[152:155], a[28:31], v[108:111], v[152:155]
    v_or_b32 v11, v11, v51
    v_mul_u32_u24 v45, 7, v50
    v_mfma_f32_16x16x32_bf16 v[164:167], a[28:31], v[112:115], v[164:167]
    s_waitcnt lgkmcnt(2)
    v_sub_u32 v51, v52, v45
    v_add_u32 v45, s60, v50
    v_mfma_f32_16x16x32_bf16 v[176:179], a[28:31], v[116:119], v[176:179]
    v_subrev_u32 v48, 224, v45
    v_min_u32 v45, v45, v48
    v_mfma_f32_16x16x32_bf16 v[156:159], a[32:35], v[108:111], v[156:159]
    buffer_load_dwordx4 v214, s[24:27], s75 offen lds
    s_add_u32 m0, s48, 24576
    v_mfma_f32_16x16x32_bf16 v[168:171], a[32:35], v[112:115], v[168:171]
    s_waitcnt vmcnt(12)
    ds_read_b64_tr_b16 a[36:37], v221 offset:36864
    ds_read_b64_tr_b16 a[38:39], v221 offset:38400
    v_mfma_f32_16x16x32_bf16 v[180:183], a[32:35], v[116:119], v[180:183]
    ds_read_b64_tr_b16 a[40:41], v221 offset:36896
    ds_read_b64_tr_b16 a[42:43], v221 offset:38432
    v_mfma_f32_16x16x32_bf16 v[140:143], a[28:31], v[208:211], v[140:143]
    ds_read_b64_tr_b16 a[44:45], v221 offset:36928
    ds_read_b64_tr_b16 a[46:47], v221 offset:38464
    v_mfma_f32_16x16x32_bf16 v[144:147], a[32:35], v[208:211], v[144:147]
    buffer_load_dwordx4 v212, s[24:27], s74 offen lds
    s_add_u32 m0, s48, 25600
    s_mov_b32 s75, 110592
    ds_read_b128 v[108:111], v223 offset:192
    ds_read_b128 v[112:115], v0 offset:4096
    ds_read_b128 v[116:119], v0 offset:10240
    v_mul_u32_u24 v14, s62, v45
    s_waitcnt lgkmcnt(7)
    v_mfma_f32_16x16x32_bf16 v[136:139], a[36:39], v[200:203], v[136:139]
    ds_read_b128 v[208:211], v1 offset:14336
    v_add_u32 v45, s61, v51
    v_mfma_f32_16x16x32_bf16 v[148:151], a[36:39], v[204:207], v[148:151]
    s_waitcnt lgkmcnt(5)
    v_mul_u32_u24 v45, 384, v45
    v_add_u32 v14, v14, v45
    v_mfma_f32_16x16x32_bf16 v[152:155], a[40:43], v[204:207], v[152:155]
    s_waitcnt lgkmcnt(4)
    v_cmp_le_u32 vcc, s68, v51
    v_lshl_add_u32 v45, v122, 4, v14
    v_mfma_f32_16x16x32_bf16 v[140:143], a[40:43], v[200:203], v[140:143]
    buffer_load_dwordx4 v213, s[24:27], s74 offen lds
    s_add_u32 m0, s48, 26624
    v_mfma_f32_16x16x32_bf16 v[156:159], a[44:47], v[204:207], v[156:159]
    s_waitcnt lgkmcnt(3)
    ds_read_b128 v[204:207], v223 offset:256
    v_add_u32 v14, s7, v45
    v_mfma_f32_16x16x32_bf16 v[144:147], a[44:47], v[200:203], v[144:147]
    ds_read_b128 v[200:203], v0 offset:16384
    v_mov_b32 v45, 16
    v_mfma_f32_16x16x32_bf16 v[172:175], a[36:39], v[108:111], v[172:175]
    v_cndmask_b32 v45, 0, v45, vcc
    v_or_b32 v11, v11, v45
    v_mfma_f32_16x16x32_bf16 v[176:179], a[40:43], v[108:111], v[176:179]
    s_waitcnt lgkmcnt(2)
    buffer_load_dwordx4 v214, s[24:27], s74 offen lds
    v_mfma_f32_16x16x32_bf16 v[180:183], a[44:47], v[108:111], v[180:183]
    s_add_u32 m0, s48, 36864
    s_waitcnt vmcnt(12)
    ds_read_b64_tr_b16 a[48:49], v221 offset:49152
    v_mfma_f32_16x16x32_bf16 v[160:163], a[36:39], v[208:211], v[160:163]
    ds_read_b64_tr_b16 a[50:51], v221 offset:50688
    ds_read_b64_tr_b16 a[52:53], v221 offset:49184
    v_mfma_f32_16x16x32_bf16 v[164:167], a[40:43], v[208:211], v[164:167]
    ds_read_b64_tr_b16 a[54:55], v221 offset:50720
    ds_read_b64_tr_b16 a[56:57], v221 offset:49216
    v_mfma_f32_16x16x32_bf16 v[168:171], a[44:47], v[208:211], v[168:171]
    buffer_load_dwordx4 v212, s[24:27], s75 offen lds
    s_add_u32 m0, s48, 37888
    ds_read_b64_tr_b16 a[58:59], v221 offset:50752
    s_mov_b32 s74, 147456
    ds_read_b128 v[108:111], v1 offset:10240
    ds_read_b128 v[208:211], v1 offset:4096
    v_lshrrev_b32 v48, 2, v51
    v_lshrrev_b32 v45, 2, v50
    s_waitcnt lgkmcnt(6)
    v_mfma_f32_16x16x32_bf16 v[136:139], a[48:51], v[112:115], v[136:139]
    v_lshl_add_u32 v49, v45, 1, v48
    v_cmp_eq_u32 vcc, v49, v122
    v_mfma_f32_16x16x32_bf16 v[148:151], a[48:51], v[116:119], v[148:151]
    s_waitcnt lgkmcnt(3)
    v_mov_b32 v45, 0x3f803f80
    v_xor_b32 v53, v49, v122
    v_mfma_f32_16x16x32_bf16 v[140:143], a[52:55], v[112:115], v[140:143]
    buffer_load_dwordx4 v213, s[24:27], s75 offen lds
    v_mfma_f32_16x16x32_bf16 v[152:155], a[52:55], v[116:119], v[152:155]
    s_waitcnt lgkmcnt(2)
    s_add_u32 m0, s48, 38912
    v_cndmask_b32 v16, 0, v45, vcc
    v_and_b32 v40, s72, v53
    v_mfma_f32_16x16x32_bf16 v[144:147], a[56:59], v[112:115], v[144:147]
    ds_read_b128 v[112:115], v1 offset:16384
    v_cmp_ne_u32 vcc, 0, v40
    v_mfma_f32_16x16x32_bf16 v[156:159], a[56:59], v[116:119], v[156:159]
    ds_read_b128 v[116:119], v223 offset:320
    v_mov_b32 v45, 0xbe8ac310
    v_mfma_f32_16x16x32_bf16 v[160:163], a[48:51], v[200:203], v[160:163]
    v_and_b32 v40, s73, v53
    v_cndmask_b32 v46, 0, v45, vcc
    v_mfma_f32_16x16x32_bf16 v[172:175], a[48:51], v[204:207], v[172:175]
    buffer_load_dwordx4 v214, s[24:27], s75 offen lds
    s_add_u32 m0, s48, 49152
    v_mfma_f32_16x16x32_bf16 v[164:167], a[52:55], v[200:203], v[164:167]
    s_waitcnt vmcnt(12)
    ds_read_b64_tr_b16 a[60:61], v221 offset:61440
    ds_read_b64_tr_b16 a[62:63], v221 offset:62976
    v_mfma_f32_16x16x32_bf16 v[176:179], a[52:55], v[204:207], v[176:179]
    ds_read_b64_tr_b16 a[64:65], v221 offset:61472
    ds_read_b64_tr_b16 a[66:67], v221 offset:63008
    v_mfma_f32_16x16x32_bf16 v[168:171], a[56:59], v[200:203], v[168:171]
    ds_read_b64_tr_b16 a[68:69], v221 offset:61504
    ds_read_b64_tr_b16 a[70:71], v221 offset:63040
    v_mfma_f32_16x16x32_bf16 v[180:183], a[56:59], v[204:207], v[180:183]
    buffer_load_dwordx4 v212, s[24:27], s74 offen lds
    s_add_u32 m0, s48, 50176
    s_mov_b32 s75, 184320
    ds_read_b128 v[200:203], v0
    ds_read_b128 v[204:207], v0 offset:6144
    v_cmp_ne_u32 vcc, 0, v40
    v_mov_b32 v45, 0x80
    s_waitcnt lgkmcnt(6)
    v_mfma_f32_16x16x32_bf16 v[148:151], a[60:63], v[108:111], v[148:151]
    v_mov_b32 v49, 3
    v_cndmask_b32 v45, 0, v45, vcc
    v_mfma_f32_16x16x32_bf16 v[160:163], a[60:63], v[112:115], v[160:163]
    s_waitcnt lgkmcnt(3)
    v_cmp_eq_u32 vcc, v49, v122
    v_or_b32 v11, v11, v45
    v_mfma_f32_16x16x32_bf16 v[172:175], a[60:63], v[116:119], v[172:175]
    s_waitcnt lgkmcnt(2)
    v_cvt_pk_bf16_f32 v32, v148, v149
    v_cvt_pk_bf16_f32 v33, v150, v151
    v_mfma_f32_16x16x32_bf16 v[152:155], a[64:67], v[108:111], v[152:155]
    buffer_load_dwordx4 v213, s[24:27], s74 offen lds
    s_add_u32 m0, s48, 51200
    v_mfma_f32_16x16x32_bf16 v[164:167], a[64:67], v[112:115], v[164:167]
    v_xor_b32 v53, v49, v122
    v_mov_b32 v45, 0x3f803f80
    v_mfma_f32_16x16x32_bf16 v[176:179], a[64:67], v[116:119], v[176:179]
    v_and_b32 v40, s72, v53
    v_cndmask_b32 v78, 0, v45, vcc
    v_mfma_f32_16x16x32_bf16 v[156:159], a[68:71], v[108:111], v[156:159]
    ds_read_b128 v[108:111], v223
    v_cvt_pk_bf16_f32 v34, v152, v153
    v_mfma_f32_16x16x32_bf16 v[168:171], a[68:71], v[112:115], v[168:171]
    buffer_load_dwordx4 v214, s[24:27], s74 offen lds
    v_mfma_f32_16x16x32_bf16 v[180:183], a[68:71], v[116:119], v[180:183]
    s_add_u32 m0, s48, 61440
    s_waitcnt vmcnt(12)
    ds_read_b64_tr_b16 a[144:145], v221
    v_mfma_f32_16x16x32_bf16 v[136:139], a[60:63], v[208:211], v[136:139]
    ds_read_b64_tr_b16 a[146:147], v221 offset:1536
    ds_read_b64_tr_b16 a[148:149], v221 offset:32
    v_mfma_f32_16x16x32_bf16 v[140:143], a[64:67], v[208:211], v[140:143]
    ds_read_b64_tr_b16 a[150:151], v221 offset:1568
    ds_read_b64_tr_b16 a[152:153], v221 offset:64
    v_mfma_f32_16x16x32_bf16 v[144:147], a[68:71], v[208:211], v[144:147]
    buffer_load_dwordx4 v212, s[24:27], s75 offen lds
    s_add_u32 m0, s48, 62464
    ds_read_b64_tr_b16 a[154:155], v221 offset:1600
    s_mov_b32 s74, 768
    ds_read_b128 v[112:115], v1
    ds_read_b128 v[116:119], v1 offset:6144
    ds_read_b128 v[208:211], v0 offset:12288
    v_cvt_pk_bf16_f32 v35, v154, v155
    s_waitcnt lgkmcnt(7)
    v_mfma_f32_16x16x32_bf16 v[148:151], a[144:147], v[204:207], 0
    v_cvt_pk_bf16_f32 v36, v156, v157
    v_cvt_pk_bf16_f32 v37, v158, v159
    s_waitcnt lgkmcnt(5)
    v_mfma_f32_16x16x32_bf16 v[152:155], a[148:151], v[204:207], 0
    buffer_load_dwordx4 v213, s[24:27], s75 offen lds
    s_add_u32 m0, s48, 63488
    s_waitcnt lgkmcnt(3)
    v_mfma_f32_16x16x32_bf16 v[156:159], a[152:155], v[204:207], 0
    v_cvt_pk_bf16_f32 v24, v136, v137
    v_cvt_pk_bf16_f32 v25, v138, v139
    v_mfma_f32_16x16x32_bf16 v[136:139], a[144:147], v[200:203], 0
    v_cvt_pk_bf16_f32 v26, v140, v141
    v_cvt_pk_bf16_f32 v27, v142, v143
    v_mfma_f32_16x16x32_bf16 v[140:143], a[148:151], v[200:203], 0
    v_cvt_pk_bf16_f32 v28, v144, v145
    v_cvt_pk_bf16_f32 v29, v146, v147
    v_mfma_f32_16x16x32_bf16 v[144:147], a[152:155], v[200:203], 0
    s_waitcnt vmcnt(11)
    ds_read_b64_tr_b16 a[156:157], v221 offset:12288
    buffer_load_dwordx4 v214, s[24:27], s75 offen lds
    s_add_u32 m0, s48, 0
    ds_read_b64_tr_b16 a[158:159], v221 offset:13824
    buffer_load_dwordx4 v212, s[24:27], s74 offen lds
    s_add_u32 m0, s48, 1024
    s_waitcnt lgkmcnt(0)
    v_mfma_f32_16x16x32_bf16 v[136:139], a[156:159], v[112:115], v[136:139]
    ds_read_b64_tr_b16 a[160:161], v221 offset:12320
    ds_read_b64_tr_b16 a[162:163], v221 offset:13856
    v_mfma_f32_16x16x32_bf16 v[148:151], a[156:159], v[116:119], v[148:151]
    buffer_load_dwordx4 v213, s[24:27], s74 offen lds
    s_add_u32 m0, s48, 2048
    ds_read_b64_tr_b16 a[164:165], v221 offset:12352
    ds_read_b64_tr_b16 a[166:167], v221 offset:13888
    s_mov_b32 s75, 37632
    v_cmp_ne_u32 vcc, 0, v40
    v_and_b32 v40, s73, v53
    s_waitcnt lgkmcnt(2)
    v_mfma_f32_16x16x32_bf16 v[140:143], a[160:163], v[112:115], v[140:143]
    v_cvt_pk_bf16_f32 v48, v172, v173
    v_cvt_pk_bf16_f32 v49, v174, v175
    v_mfma_f32_16x16x32_bf16 v[152:155], a[160:163], v[116:119], v[152:155]
    v_cvt_pk_bf16_f32 v50, v176, v177
    v_cvt_pk_bf16_f32 v51, v178, v179
    v_mfma_f32_16x16x32_bf16 v[172:175], a[144:147], v[108:111], 0
    s_waitcnt vmcnt(11)
    ds_read_b64_tr_b16 a[168:169], v221 offset:24576
    v_mfma_f32_16x16x32_bf16 v[176:179], a[148:151], v[108:111], 0
    buffer_load_dwordx4 v214, s[24:27], s74 offen lds
    s_add_u32 m0, s48, 12288
    s_waitcnt lgkmcnt(1)
    v_mfma_f32_16x16x32_bf16 v[144:147], a[164:167], v[112:115], v[144:147]
    ds_read_b64_tr_b16 a[170:171], v221 offset:26112
    ds_read_b64_tr_b16 a[172:173], v221 offset:24608
    v_mfma_f32_16x16x32_bf16 v[156:159], a[164:167], v[116:119], v[156:159]
    ds_read_b64_tr_b16 a[174:175], v221 offset:26144
    ds_read_b64_tr_b16 a[176:177], v221 offset:24640
    ds_read_b64_tr_b16 a[178:179], v221 offset:26176
    s_mov_b32 s74, 74496
    v_mov_b32 v45, 0xbe8ac310
    buffer_load_dwordx4 v212, s[24:27], s75 offen lds
    s_add_u32 m0, s48, 13312
    v_cvt_pk_bf16_f32 v52, v180, v181
    v_cvt_pk_bf16_f32 v53, v182, v183
    v_mfma_f32_16x16x32_bf16 v[180:183], a[152:155], v[108:111], 0
    ds_read_b128 v[204:207], v223 offset:64
    buffer_load_dwordx4 v213, s[24:27], s75 offen lds
    s_add_u32 m0, s48, 14336
    ds_read_b128 v[200:203], v1 offset:12288
    v_cndmask_b32 v54, 0, v45, vcc
    v_cmp_ne_u32 vcc, 0, v40
    v_mov_b32 v45, 0x100
    s_mul_i32 s6, s63, 96
    v_cndmask_b32 v45, 0, v45, vcc
    s_waitcnt lgkmcnt(1)
    v_mfma_f32_16x16x32_bf16 v[172:175], a[156:159], v[204:207], v[172:175]
    ds_read_b128 v[112:115], v0 offset:14336
    ds_read_b128 v[116:119], v223 offset:128
    v_mfma_f32_16x16x32_bf16 v[176:179], a[160:163], v[204:207], v[176:179]
    ds_read_b128 v[108:111], v0 offset:8192
    v_or_b32 v11, v11, v45
    v_mfma_f32_16x16x32_bf16 v[180:183], a[164:167], v[204:207], v[180:183]
    buffer_load_dwordx4 v214, s[24:27], s75 offen lds
    s_waitcnt vmcnt(12)
    ds_read_b64_tr_b16 a[180:181], v221 offset:36864
    ds_read_b64_tr_b16 a[182:183], v221 offset:38400
    ds_read_b64_tr_b16 a[184:185], v221 offset:36896
    ds_read_b64_tr_b16 a[186:187], v221 offset:38432
    ds_read_b64_tr_b16 a[188:189], v221 offset:36928
    ds_read_b64_tr_b16 a[190:191], v221 offset:38464
    s_add_u32 m0, s45, 18432
    s_mov_b32 s75, 111360
    s_sub_u32 s6, 64, s6
    v_lshlrev_b32 v45, 3, v122
    v_sub_u32 v10, s6, v45
    v_cvt_pk_bf16_f32 v41, v162, v163
    v_cvt_pk_bf16_f32 v42, v164, v165
    v_cvt_pk_bf16_f32 v43, v166, v167
    v_mfma_f32_16x16x32_bf16 v[164:167], a[148:151], v[208:211], 0
    s_waitcnt lgkmcnt(7)
    buffer_load_dwordx4 v8, s[20:23], s53 offen nt lds
    s_add_u32 m0, s48, 24576
    v_mfma_f32_16x16x32_bf16 v[164:167], a[160:163], v[200:203], v[164:167]
    s_waitcnt lgkmcnt(5)
    v_cvt_pk_bf16_f32 v44, v168, v169
    v_cvt_pk_bf16_f32 v40, v160, v161
    v_mfma_f32_16x16x32_bf16 v[160:163], a[144:147], v[208:211], 0
    v_cvt_pk_bf16_f32 v45, v170, v171
    v_lshrrev_b32 v19, 4, v2
    v_mfma_f32_16x16x32_bf16 v[168:171], a[152:155], v[208:211], 0
    ds_read_b128 v[208:211], v0 offset:2048
    ds_read_b128 v[204:207], v1 offset:8192
    v_mfma_f32_16x16x32_bf16 v[160:163], a[156:159], v[200:203], v[160:163]
    v_subrev_u32 v19, 0x1500, v19
    v_lshrrev_b32 v7, 4, v19
    v_mfma_f32_16x16x32_bf16 v[168:171], a[164:167], v[200:203], v[168:171]
    buffer_load_dwordx4 v212, s[24:27], s74 offen lds
    s_add_u32 m0, s48, 25600
    v_mfma_f32_16x16x32_bf16 v[172:175], a[168:171], v[116:119], v[172:175]
    ds_read_b128 v[200:203], v1 offset:2048
    v_cmp_eq_u32 vcc, 0, v7
    v_mfma_f32_16x16x32_bf16 v[176:179], a[172:175], v[116:119], v[176:179]
    v_and_b32 v19, 15, v19
    v_mov_b32 v7, 16
    v_mfma_f32_16x16x32_bf16 v[148:151], a[168:171], v[108:111], v[148:151]
    v_cndmask_b32 v19, v7, v19, vcc
    v_lshlrev_b32 v19, 2, v19
    v_mfma_f32_16x16x32_bf16 v[152:155], a[172:175], v[108:111], v[152:155]
    s_waitcnt lgkmcnt(2)
    v_add_u32 v7, s49, v19
    s_mov_b32 s43, 0x3e553b95
    v_mfma_f32_16x16x32_bf16 v[156:159], a[176:179], v[108:111], v[156:159]
    s_waitcnt lgkmcnt(1)
    buffer_load_dwordx4 v213, s[24:27], s74 offen lds
    s_add_u32 m0, s48, 26624
    v_mfma_f32_16x16x32_bf16 v[180:183], a[176:179], v[116:119], v[180:183]
    s_waitcnt vmcnt(12)
    ds_read_b64_tr_b16 a[192:193], v221 offset:49152
    ds_read_b64_tr_b16 a[194:195], v221 offset:50688
    v_mfma_f32_16x16x32_bf16 v[164:167], a[172:175], v[112:115], v[164:167]
    ds_read_b64_tr_b16 a[196:197], v221 offset:49184
    ds_read_b64_tr_b16 a[198:199], v221 offset:50720
    v_mfma_f32_16x16x32_bf16 v[160:163], a[168:171], v[112:115], v[160:163]
    ds_read_b64_tr_b16 a[200:201], v221 offset:49216
    ds_read_b64_tr_b16 a[202:203], v221 offset:50752
    v_mfma_f32_16x16x32_bf16 v[168:171], a[176:179], v[112:115], v[168:171]
    ds_read_b128 v[108:111], v223 offset:192
    ds_read_b128 v[116:119], v0 offset:10240
    v_mfma_f32_16x16x32_bf16 v[136:139], a[168:171], v[208:211], v[136:139]
    s_waitcnt lgkmcnt(8)
    buffer_load_dwordx4 v214, s[24:27], s74 offen lds
    s_add_u32 m0, s45, 20352
    v_mfma_f32_16x16x32_bf16 v[140:143], a[172:175], v[208:211], v[140:143]
    s_mov_b32 s74, 148224
    ds_read_b128 v[112:115], v0 offset:4096
    ds_read_b128 v[104:107], v5
    v_mfma_f32_16x16x32_bf16 v[144:147], a[176:179], v[208:211], v[144:147]
    ds_read_b128 v[208:211], v1 offset:14336
    v_mov_b32 v31, 0
    v_mfma_f32_16x16x32_bf16 v[148:151], a[180:183], v[204:207], v[148:151]
    ds_read_b128 v[184:187], v223
    v_mov_b32 v39, 0
    v_mfma_f32_16x16x32_bf16 v[152:155], a[184:187], v[204:207], v[152:155]
    buffer_load_dwordx4 v8, s[20:23], s53 offen offset:128 nt lds
    v_mfma_f32_16x16x32_bf16 v[156:159], a[188:191], v[204:207], v[156:159]
    s_waitcnt lgkmcnt(5)
    s_add_u32 m0, s48, 36864
    ds_read_b128 v[204:207], v223 offset:256
    v_mov_b32 v47, 0
    v_mfma_f32_16x16x32_bf16 v[136:139], a[180:183], v[200:203], v[136:139]
    s_waitcnt lgkmcnt(5)
    v_mov_b32 v55, 0
    v_mov_b32 v63, 0
    v_mfma_f32_16x16x32_bf16 v[140:143], a[184:187], v[200:203], v[140:143]
    s_waitcnt lgkmcnt(4)
    v_mov_b32 v62, v15
    s_lshl_b32 s3, s63, 6
    v_mfma_f32_16x16x32_bf16 v[144:147], a[188:191], v[200:203], v[144:147]
    ds_read_b128 v[200:203], v0 offset:16384
    ds_read_b128 v[188:191], v1
    v_mfma_f32_16x16x32_bf16 v[172:175], a[180:183], v[108:111], v[172:175]
    s_waitcnt lgkmcnt(4)
    buffer_load_dwordx4 v212, s[24:27], s75 offen lds
    v_mfma_f32_16x16x32_bf16 v[176:179], a[184:187], v[108:111], v[176:179]
    s_add_u32 m0, s48, 37888
    s_waitcnt vmcnt(12)
    ds_read_b64_tr_b16 a[204:205], v221 offset:61440
    v_mfma_f32_16x16x32_bf16 v[180:183], a[188:191], v[108:111], v[180:183]
    s_waitcnt lgkmcnt(3)
    ds_read_b64_tr_b16 a[206:207], v221 offset:62976
    ds_read_b64_tr_b16 a[208:209], v221 offset:61472
    v_mfma_f32_16x16x32_bf16 v[148:151], a[192:195], v[116:119], v[148:151]
    ds_read_b64_tr_b16 a[210:211], v221 offset:63008
    ds_read_b64_tr_b16 a[212:213], v221 offset:61504
    v_mfma_f32_16x16x32_bf16 v[152:155], a[196:199], v[116:119], v[152:155]
    ds_read_b64_tr_b16 a[214:215], v221 offset:63040
    ds_read_b128 v[108:111], v1 offset:10240
    v_mfma_f32_16x16x32_bf16 v[156:159], a[200:203], v[116:119], v[156:159]
    buffer_load_dwordx4 v213, s[24:27], s75 offen lds
    s_add_u32 m0, s48, 38912
    v_mfma_f32_16x16x32_bf16 v[136:139], a[192:195], v[112:115], v[136:139]
    ds_read_b128 v[116:119], v223 offset:320
    ds_read_b128 v[192:195], v1 offset:6144
    v_mfma_f32_16x16x32_bf16 v[140:143], a[196:199], v[112:115], v[140:143]
    s_sub_u32 s3, 64, s3
    ds_read_b128 v[120:123], v5 offset:3072
    v_mov_b32 v71, 0
    v_mfma_f32_16x16x32_bf16 v[144:147], a[200:203], v[112:115], v[144:147]
    ds_read_b128 v[112:115], v1 offset:16384
    v_mov_b32 v20, 0x3f803f80
    v_mfma_f32_16x16x32_bf16 v[160:163], a[180:183], v[208:211], v[160:163]
    s_waitcnt lgkmcnt(5)
    ds_read_b32 v132, v7 offset:9296
    ds_read_b128 v[124:127], v5 offset:4096
    v_mfma_f32_16x16x32_bf16 v[164:167], a[184:187], v[208:211], v[164:167]
    s_waitcnt lgkmcnt(6)
    buffer_load_dwordx4 v214, s[24:27], s75 offen lds
    s_add_u32 m0, s45, 22272
    v_mfma_f32_16x16x32_bf16 v[168:171], a[188:191], v[208:211], v[168:171]
    s_mov_b32 s75, 185088
    ds_read_b128 v[208:211], v1 offset:4096
    ds_read_b128 v[128:131], v5 offset:5120
    v_mfma_f32_16x16x32_bf16 v[172:175], a[192:195], v[204:207], v[172:175]
    s_waitcnt lgkmcnt(7)
    ds_read_b128 v[224:227], v5 offset:6144
    v_mfma_f32_16x16x32_bf16 v[176:179], a[196:199], v[204:207], v[176:179]
    v_mov_b32 v21, 0x3f803f80
    v_mov_b32 v22, 0x3f803f80
    v_mfma_f32_16x16x32_bf16 v[180:183], a[200:203], v[204:207], v[180:183]
    s_waitcnt vmcnt(11)
    ds_read_b64_tr_b16 a[72:73], v221
    v_mfma_f32_16x16x32_bf16 v[160:163], a[192:195], v[200:203], v[160:163]
    s_waitcnt lgkmcnt(6)
    ds_read_b64_tr_b16 a[74:75], v221 offset:1536
    ds_read_b64_tr_b16 a[76:77], v221 offset:32
    v_mfma_f32_16x16x32_bf16 v[164:167], a[196:199], v[200:203], v[164:167]
    ds_read_b64_tr_b16 a[78:79], v221 offset:1568
    ds_read_b64_tr_b16 a[80:81], v221 offset:64
    v_mfma_f32_16x16x32_bf16 v[168:171], a[200:203], v[200:203], v[168:171]
    ds_read_b64_tr_b16 a[82:83], v221 offset:1600
    buffer_load_dwordx4 v8, s[20:23], s53 offen offset:256 nt lds
    v_mfma_f32_16x16x32_bf16 v[148:151], a[204:207], v[108:111], v[148:151]
    s_waitcnt lgkmcnt(8)
    s_add_u32 m0, s48, 49152
    ds_read_b128 v[200:203], v0
    ds_read_b128 v[204:207], v0 offset:6144
    v_mfma_f32_16x16x32_bf16 v[152:155], a[208:211], v[108:111], v[152:155]
    ds_read_b32 v236, v7 offset:9376
    v_mov_b32 v23, 0x3f803f80
    v_mfma_f32_16x16x32_bf16 v[156:159], a[212:215], v[108:111], v[156:159]
    ds_read_b128 v[108:111], v5 offset:1024
    v_mul_f32 v148, s43, v148
    v_mfma_f32_16x16x32_bf16 v[172:175], a[204:207], v[116:119], v[172:175]
    buffer_load_dwordx4 v212, s[24:27], s74 offen lds
    s_add_u32 m0, s48, 50176
    v_mfma_f32_16x16x32_bf16 v[176:179], a[208:211], v[116:119], v[176:179]
    v_mul_f32 v149, s43, v149
    v_mul_f32 v150, s43, v150
    v_mfma_f32_16x16x32_bf16 v[180:183], a[212:215], v[116:119], v[180:183]
    ds_read_b32 v116, v7 offset:9216
    v_mul_f32 v151, s43, v151
    v_mfma_f32_16x16x32_bf16 v[160:163], a[204:207], v[112:115], v[160:163]
    v_mul_f32 v152, s43, v152
    v_mul_f32 v153, s43, v153
    v_mfma_f32_16x16x32_bf16 v[164:167], a[208:211], v[112:115], v[164:167]
    v_mul_f32 v154, s43, v154
    v_mul_f32 v155, s43, v155
    v_mfma_f32_16x16x32_bf16 v[168:171], a[212:215], v[112:115], v[168:171]
    buffer_load_dwordx4 v213, s[24:27], s74 offen lds
    s_add_u32 m0, s48, 51200
    v_mfma_f32_16x16x32_bf16 v[136:139], a[204:207], v[208:211], v[136:139]
    ds_read_b128 v[112:115], v5 offset:2048
    v_mul_f32 v156, s43, v156
    v_mfma_f32_16x16x32_bf16 v[140:143], a[208:211], v[208:211], v[140:143]
    v_mul_f32 v157, s43, v157
    v_mul_f32 v158, s43, v158
    v_mfma_f32_16x16x32_bf16 v[144:147], a[212:215], v[208:211], v[144:147]
    s_waitcnt vmcnt(11)
    ds_read_b64_tr_b16 a[84:85], v221 offset:12288
    ds_read_b64_tr_b16 a[86:87], v221 offset:13824
    ds_read_b64_tr_b16 a[88:89], v221 offset:12320
    buffer_load_dwordx4 v214, s[24:27], s74 offen lds
    ds_read_b64_tr_b16 a[90:91], v221 offset:13856
    ds_read_b64_tr_b16 a[92:93], v221 offset:12352
    ds_read_b64_tr_b16 a[94:95], v221 offset:13888
    s_add_u32 m0, s46, 18432
    s_mov_b32 s74, 0
    ds_read_b128 v[208:211], v0 offset:12288
    v_mul_f32 v136, s43, v136
    v_mul_f32 v137, s43, v137
    v_mul_f32 v138, s43, v138
    v_mul_f32 v139, s43, v139
    v_mul_f32 v140, s43, v140
    v_mul_f32 v141, s43, v141
    v_mul_f32 v142, s43, v142
    v_mul_f32 v143, s43, v143
    v_cvt_pk_bf16_f32 v56, v136, v137
    v_cvt_pk_bf16_f32 v57, v138, v139
    s_waitcnt lgkmcnt(12)
    v_mfma_f32_16x16x32_bf16 v[136:139], v[200:203], a[72:75], 0
    s_waitcnt lgkmcnt(3)
    buffer_load_dwordx4 v9, s[20:23], s57 offen nt lds
    s_add_u32 m0, s48, 61440
    v_mfma_f32_16x16x32_bf16 v[136:139], v[188:191], a[84:87], v[136:139]
    v_cvt_pk_bf16_f32 v58, v140, v141
    v_cvt_pk_bf16_f32 v59, v142, v143
    v_mfma_f32_16x16x32_bf16 v[140:143], v[200:203], a[76:79], 0
    v_mul_f32 v144, s43, v144
    v_mul_f32 v145, s43, v145
    v_mfma_f32_16x16x32_bf16 v[104:107], v[24:27], v[56:59], v[104:107]
    v_mul_f32 v146, s43, v146
    v_mul_f32 v147, s43, v147
    v_mfma_f32_16x16x32_bf16 v[108:111], v[32:35], v[56:59], v[108:111]
    v_cvt_pk_bf16_f32 v60, v144, v145
    v_cvt_pk_bf16_f32 v61, v146, v147
    v_mfma_f32_16x16x32_bf16 v[112:115], v[40:43], v[56:59], v[112:115]
    v_mul_f32 v159, s43, v159
    v_cvt_pk_bf16_f32 v64, v148, v149
    v_mfma_f32_16x16x32_bf16 v[116:119], v[48:51], v[56:59], v[116:119]
    v_cvt_pk_bf16_f32 v65, v150, v151
    v_cvt_pk_bf16_f32 v66, v152, v153
    v_mfma_f32_16x16x32_bf16 v[104:107], v[28:31], v[60:63], v[104:107]
    v_cvt_pk_bf16_f32 v67, v154, v155
    v_cvt_pk_bf16_f32 v68, v156, v157
    v_mfma_f32_16x16x32_bf16 v[108:111], v[36:39], v[60:63], v[108:111]
    v_cvt_pk_bf16_f32 v69, v158, v159
    v_mul_f32 v160, s43, v160
    v_mfma_f32_16x16x32_bf16 v[112:115], v[44:47], v[60:63], v[112:115]
    v_mul_f32 v161, s43, v161
    v_mul_f32 v162, s43, v162
    v_mfma_f32_16x16x32_bf16 v[116:119], v[52:55], v[60:63], v[116:119]
    buffer_load_dwordx4 v212, s[24:27], s75 offen lds
    s_add_u32 m0, s48, 62464
    v_mfma_f32_16x16x32_bf16 v[144:147], v[200:203], a[80:83], 0
    s_waitcnt lgkmcnt(0)
    ds_read_b128 v[200:203], v1 offset:12288
    v_mul_f32 v163, s43, v163
    v_mfma_f32_16x16x32_bf16 v[148:151], v[204:207], a[72:75], 0
    v_mul_f32 v164, s43, v164
    v_mul_f32 v165, s43, v165
    v_mfma_f32_16x16x32_bf16 v[152:155], v[204:207], a[76:79], 0
    v_mul_f32 v166, s43, v166
    v_mul_f32 v167, s43, v167
    v_mfma_f32_16x16x32_bf16 v[156:159], v[204:207], a[80:83], 0
    buffer_load_dwordx4 v213, s[24:27], s75 offen lds
    v_mfma_f32_16x16x32_bf16 v[140:143], v[188:191], a[88:91], v[140:143]
    s_add_u32 m0, s48, 63488
    v_mul_f32 v168, s43, v168
    v_mul_f32 v169, s43, v169
    v_mfma_f32_16x16x32_bf16 v[144:147], v[188:191], a[92:95], v[144:147]
    v_mul_f32 v170, s43, v170
    v_mul_f32 v171, s43, v171
    v_mfma_f32_16x16x32_bf16 v[148:151], v[192:195], a[84:87], v[148:151]
    v_cvt_pk_bf16_f32 v56, v160, v161
    v_cvt_pk_bf16_f32 v57, v162, v163
    v_mfma_f32_16x16x32_bf16 v[160:163], v[208:211], a[72:75], 0
    s_waitcnt lgkmcnt(0)
    v_cvt_pk_bf16_f32 v58, v164, v165
    v_cvt_pk_bf16_f32 v59, v166, v167
    v_mfma_f32_16x16x32_bf16 v[164:167], v[208:211], a[76:79], 0
    buffer_load_dwordx4 v214, s[24:27], s75 offen lds
    s_add_u32 m0, s47, 18432
    v_mfma_f32_16x16x32_bf16 v[160:163], v[200:203], a[84:87], v[160:163]
    s_mov_b32 s75, 18432
    v_cvt_pk_bf16_f32 v60, v168, v169
    v_cvt_pk_bf16_f32 v61, v170, v171
    v_mfma_f32_16x16x32_bf16 v[168:171], v[208:211], a[80:83], 0
    ds_read_b128 v[204:207], v223 offset:64
    ds_read_b128 v[208:211], v0 offset:2048
    v_mfma_f32_16x16x32_bf16 v[164:167], v[200:203], a[88:91], v[164:167]
    v_mul_f32 v172, s43, v172
    v_mul_f32 v173, s43, v173
    v_mfma_f32_16x16x32_bf16 v[168:171], v[200:203], a[92:95], v[168:171]
    v_mul_f32 v174, s43, v174
    v_mul_f32 v175, s43, v175
    v_mfma_f32_16x16x32_bf16 v[152:155], v[192:195], a[88:91], v[152:155]
    s_waitcnt vmcnt(12)
    ds_read_b64_tr_b16 a[96:97], v221 offset:24576
    ds_read_b64_tr_b16 a[98:99], v221 offset:26112
    v_mfma_f32_16x16x32_bf16 v[156:159], v[192:195], a[92:95], v[156:159]
    ds_read_b64_tr_b16 a[100:101], v221 offset:24608
    ds_read_b64_tr_b16 a[102:103], v221 offset:26144
    v_mfma_f32_16x16x32_bf16 v[120:123], v[24:27], v[64:67], v[120:123]
    ds_read_b64_tr_b16 a[104:105], v221 offset:24640
    ds_read_b64_tr_b16 a[106:107], v221 offset:26176
    v_mfma_f32_16x16x32_bf16 v[132:135], v[48:51], v[64:67], v[132:135]
    s_mov_b64 exec, s[50:51]
    buffer_load_dwordx4 v9, s[20:23], s53 offen offset:128 nt lds
    s_mov_b64 exec, -1
    v_mfma_f32_16x16x32_bf16 v[124:127], v[32:35], v[64:67], v[124:127]
    s_add_u32 m0, s48, 24576
    v_mul_f32 v176, s43, v176
    v_mul_f32 v177, s43, v177
    v_mfma_f32_16x16x32_bf16 v[128:131], v[40:43], v[64:67], v[128:131]
    s_waitcnt lgkmcnt(4)
    v_mul_f32 v178, s43, v178
    v_mul_f32 v179, s43, v179
    v_mfma_f32_16x16x32_bf16 v[136:139], v[208:211], a[96:99], v[136:139]
    v_mul_f32 v180, s43, v180
    v_mul_f32 v181, s43, v181
    s_waitcnt lgkmcnt(2)
    v_mfma_f32_16x16x32_bf16 v[140:143], v[208:211], a[100:103], v[140:143]
    s_waitcnt lgkmcnt(0)
    buffer_load_dwordx4 v215, s[28:31], s74 offen lds
    v_mfma_f32_16x16x32_bf16 v[144:147], v[208:211], a[104:107], v[144:147]
    s_add_u32 m0, s48, 25600
    v_mul_f32 v182, s43, v182
    v_mul_f32 v183, s43, v183
    v_mfma_f32_16x16x32_bf16 v[120:123], v[28:31], v[68:71], v[120:123]
    v_cvt_pk_bf16_f32 v72, v172, v173
    v_cvt_pk_bf16_f32 v73, v174, v175
    v_mfma_f32_16x16x32_bf16 v[172:175], v[184:187], a[72:75], 0
    v_cvt_pk_bf16_f32 v74, v176, v177
    v_cvt_pk_bf16_f32 v75, v178, v179
    v_mfma_f32_16x16x32_bf16 v[176:179], v[184:187], a[76:79], 0
    buffer_load_dwordx4 v216, s[28:31], s74 offen lds
    s_add_u32 m0, s48, 26624
    v_mfma_f32_16x16x32_bf16 v[172:175], v[204:207], a[84:87], v[172:175]
    v_cvt_pk_bf16_f32 v76, v180, v181
    v_cvt_pk_bf16_f32 v77, v182, v183
    v_mfma_f32_16x16x32_bf16 v[180:183], v[184:187], a[80:83], 0
    ds_read_b128 v[184:187], v0 offset:8192
    ds_read_b128 v[200:203], v1 offset:2048
    v_mfma_f32_16x16x32_bf16 v[176:179], v[204:207], a[88:91], v[176:179]
    ds_read_b128 v[188:191], v0 offset:14336
    v_add_u32 v212, s3, v221
    v_mfma_f32_16x16x32_bf16 v[180:183], v[204:207], a[92:95], v[180:183]
    ds_read_b128 v[204:207], v1 offset:8192
    v_max3_f32 v117, v104, v105, v106
    v_mfma_f32_16x16x32_bf16 v[132:135], v[52:55], v[68:71], v[132:135]
    buffer_load_dwordx4 v217, s[28:31], s74 offen lds
    s_add_u32 m0, s48, 36864
    v_mfma_f32_16x16x32_bf16 v[124:127], v[36:39], v[68:71], v[124:127]
    ds_read_b128 v[208:211], v1 offset:14336
    ds_read_b128 v[192:195], v223 offset:128
    v_mfma_f32_16x16x32_bf16 v[128:131], v[44:47], v[68:71], v[128:131]
    s_mov_b32 s74, 36864
    v_max3_f32 v118, v107, v108, v109
    v_max3_f32 v117, v117, v110, v111
    s_waitcnt lgkmcnt(5)
    v_mfma_f32_16x16x32_bf16 v[148:151], v[184:187], a[96:99], v[148:151]
    s_waitcnt vmcnt(12)
    ds_read_b64_tr_b16 a[108:109], v221 offset:36864
    ds_read_b64_tr_b16 a[110:111], v221 offset:38400
    v_mfma_f32_16x16x32_bf16 v[152:155], v[184:187], a[100:103], v[152:155]
    ds_read_b64_tr_b16 a[112:113], v221 offset:36896
    ds_read_b64_tr_b16 a[114:115], v221 offset:38432
    v_mfma_f32_16x16x32_bf16 v[156:159], v[184:187], a[104:107], v[156:159]
    s_waitcnt lgkmcnt(7)
    ds_read_b64_tr_b16 a[116:117], v221 offset:36928
    ds_read_b64_tr_b16 a[118:119], v221 offset:38464
    v_mfma_f32_16x16x32_bf16 v[160:163], v[188:191], a[96:99], v[160:163]
    ds_read_b128 v[184:187], v223 offset:192
    v_max3_f32 v118, v118, v112, v113
    v_mfma_f32_16x16x32_bf16 v[164:167], v[188:191], a[100:103], v[164:167]
    v_max3_f32 v117, v117, v114, v115
    v_max3_f32 v117, v117, v118, v116
    v_mfma_f32_16x16x32_bf16 v[168:171], v[188:191], a[104:107], v[168:171]
    s_waitcnt lgkmcnt(6)
    ds_read_b128 v[188:191], v0 offset:4096
    v_mov_b32 v118, v117
    v_mfma_f32_16x16x32_bf16 v[172:175], v[192:195], a[96:99], v[172:175]
    s_waitcnt lgkmcnt(5)
    v_permlane32_swap_b32 v118, v117
    v_mfma_f32_16x16x32_bf16 v[136:139], v[200:203], a[108:111], v[136:139]
    s_waitcnt lgkmcnt(4)
    ds_read_b128 v[228:231], v5 offset:7168
    ds_read_b128 v[232:235], v5 offset:8192
    v_mfma_f32_16x16x32_bf16 v[140:143], v[200:203], a[112:115], v[140:143]
    s_waitcnt lgkmcnt(4)
    buffer_load_dwordx4 v215, s[28:31], s75 offen lds
    s_add_u32 m0, s48, 37888
    v_mfma_f32_16x16x32_bf16 v[144:147], v[200:203], a[116:119], v[144:147]
    s_waitcnt lgkmcnt(3)
    ds_read_b128 v[200:203], v0 offset:16384
    v_max_f32 v117, v117, v118
    v_mfma_f32_16x16x32_bf16 v[148:151], v[204:207], a[108:111], v[148:151]
    v_mov_b32 v118, v117
    v_max3_f32 v133, v120, v121, v122
    v_mfma_f32_16x16x32_bf16 v[152:155], v[204:207], a[112:115], v[152:155]
    v_permlane16_swap_b32 v118, v117
    v_mfma_f32_16x16x32_bf16 v[156:159], v[204:207], a[116:119], v[156:159]
    buffer_load_dwordx4 v216, s[28:31], s75 offen lds
    s_add_u32 m0, s48, 38912
    v_mfma_f32_16x16x32_bf16 v[160:163], v[208:211], a[108:111], v[160:163]
    s_waitcnt lgkmcnt(2)
    ds_read_b128 v[204:207], v223 offset:256
    v_max_f32 v117, v117, v118
    v_mfma_f32_16x16x32_bf16 v[164:167], v[208:211], a[112:115], v[164:167]
    s_waitcnt lgkmcnt(2)
    v_sub_f32 v104, v104, v117
    v_sub_f32 v105, v105, v117
    v_mfma_f32_16x16x32_bf16 v[168:171], v[208:211], a[116:119], v[168:171]
    ds_read_b128 v[208:211], v1 offset:4096
    v_sub_f32 v106, v106, v117
    v_mfma_f32_16x16x32_bf16 v[176:179], v[192:195], a[100:103], v[176:179]
    v_sub_f32 v107, v107, v117
    v_sub_f32 v108, v108, v117
    v_mfma_f32_16x16x32_bf16 v[180:183], v[192:195], a[104:107], v[180:183]
    buffer_load_dwordx4 v217, s[28:31], s75 offen lds
    s_add_u32 m0, s48, 49152
    v_mfma_f32_16x16x32_bf16 v[172:175], v[184:187], a[108:111], v[172:175]
    ds_read_b128 v[192:195], v0 offset:10240
    s_mov_b32 s75, 55296
    v_mfma_f32_16x16x32_bf16 v[176:179], v[184:187], a[112:115], v[176:179]
    v_exp_f32 v104, v104
    v_mfma_f32_16x16x32_bf16 v[180:183], v[184:187], a[116:119], v[180:183]
    ds_read_b128 v[184:187], v1 offset:10240
    v_sub_f32 v109, v109, v117
    v_mfma_f32_16x16x32_bf16 v[224:227], v[24:27], v[56:59], v[224:227]
    s_waitcnt vmcnt(11)
    ds_read_b64_tr_b16 a[120:121], v221 offset:49152
    v_mfma_f32_16x16x32_bf16 v[236:239], v[48:51], v[56:59], v[236:239]
    ds_read_b64_tr_b16 a[122:123], v221 offset:50688
    ds_read_b64_tr_b16 a[124:125], v221 offset:49184
    v_mfma_f32_16x16x32_bf16 v[228:231], v[32:35], v[56:59], v[228:231]
    ds_read_b64_tr_b16 a[126:127], v221 offset:50720
    ds_read_b64_tr_b16 a[128:129], v221 offset:49216
    v_mfma_f32_16x16x32_bf16 v[232:235], v[40:43], v[56:59], v[232:235]
    ds_read_b64_tr_b16 a[130:131], v221 offset:50752
    v_exp_f32 v105, v105
    v_sub_f32 v110, v110, v117
    v_sub_f32 v111, v111, v117
    v_exp_f32 v106, v106
    v_exp_f32 v107, v107
    v_exp_f32 v108, v108
    s_waitcnt lgkmcnt(4)
    v_mfma_f32_16x16x32_bf16 v[160:163], v[200:203], a[120:123], v[160:163]
    v_exp_f32 v109, v109
    v_mfma_f32_16x16x32_bf16 v[136:139], v[188:191], a[120:123], v[136:139]
    s_waitcnt lgkmcnt(1)
    v_exp_f32 v110, v110
    v_mfma_f32_16x16x32_bf16 v[164:167], v[200:203], a[124:127], v[164:167]
    s_waitcnt lgkmcnt(0)
    buffer_load_dwordx4 v215, s[28:31], s74 offen lds
    s_add_u32 m0, s48, 50176
    v_mfma_f32_16x16x32_bf16 v[168:171], v[200:203], a[128:131], v[168:171]
    v_exp_f32 v111, v111
    v_mfma_f32_16x16x32_bf16 v[172:175], v[204:207], a[120:123], v[172:175]
    v_sub_f32 v112, v112, v117
    v_sub_f32 v113, v113, v117
    v_mfma_f32_16x16x32_bf16 v[140:143], v[188:191], a[124:127], v[140:143]
    v_cvt_pk_bf16_f32 v104, v104, v105
    v_sub_f32 v114, v114, v117
    v_mfma_f32_16x16x32_bf16 v[176:179], v[204:207], a[124:127], v[176:179]
    buffer_load_dwordx4 v216, s[28:31], s74 offen lds
    s_add_u32 m0, s48, 51200
    v_mfma_f32_16x16x32_bf16 v[144:147], v[188:191], a[128:131], v[144:147]
    ds_read_b128 v[188:191], v1 offset:16384
    v_sub_f32 v115, v115, v117
    v_mfma_f32_16x16x32_bf16 v[180:183], v[204:207], a[128:131], v[180:183]
    v_exp_f32 v112, v112
    v_mfma_f32_16x16x32_bf16 v[148:151], v[192:195], a[120:123], v[148:151]
    v_exp_f32 v113, v113
    v_mfma_f32_16x16x32_bf16 v[152:155], v[192:195], a[124:127], v[152:155]
    v_cvt_pk_bf16_f32 v105, v106, v107
    v_sub_f32 v116, v116, v117
    v_mfma_f32_16x16x32_bf16 v[156:159], v[192:195], a[128:131], v[156:159]
    buffer_load_dwordx4 v217, s[28:31], s74 offen lds
    s_add_u32 m0, s48, 61440
    s_waitcnt vmcnt(10)
    ds_read_b64_tr_b16 a[132:133], v221 offset:61440
    ds_read_b64_tr_b16 a[134:135], v221 offset:62976
    ds_read_b64_tr_b16 a[136:137], v221 offset:61472
    ds_read_b64_tr_b16 a[138:139], v221 offset:63008
    ds_read_b64_tr_b16 a[140:141], v221 offset:61504
    ds_read_b64_tr_b16 a[142:143], v221 offset:63040
    s_mov_b32 s74, 12288
    ds_read_b128 v[192:195], v223 offset:320
    v_exp_f32 v114, v114
    v_exp_f32 v115, v115
    v_cvt_pk_bf16_f32 v106, v108, v109
    v_cvt_pk_bf16_f32 v107, v110, v111
    v_exp_f32 v116, v116
    v_cvt_pk_bf16_f32 v112, v112, v113
    v_mfma_f32_16x16x32_bf16 v[196:199], v[20:23], v[104:107], 0
    v_cvt_pk_bf16_f32 v113, v114, v115
    v_cvt_pk_bf16_f32 v114, v116, 0
    v_mov_b32 v115, 0
    s_waitcnt lgkmcnt(5)
    v_mfma_f32_16x16x32_bf16 v[136:139], v[208:211], a[132:135], v[136:139]
    ds_read_b32 v116, v7 offset:9456
    ds_read_b128 v[108:111], v6 offset:64
    s_waitcnt lgkmcnt(5)
    v_mfma_f32_16x16x32_bf16 v[140:143], v[208:211], a[136:139], v[140:143]
    s_waitcnt lgkmcnt(3)
    buffer_load_dwordx4 v215, s[28:31], s75 offen lds
    v_mfma_f32_16x16x32_bf16 v[144:147], v[208:211], a[140:143], v[144:147]
    s_add_u32 m0, s48, 62464
    v_cvt_pk_bf16_f32 v80, v136, v137
    v_cvt_pk_bf16_f32 v81, v138, v139
    v_mfma_f32_16x16x32_bf16 v[148:151], v[184:187], a[132:135], v[148:151]
    s_waitcnt lgkmcnt(2)
    v_cvt_pk_bf16_f32 v88, v140, v141
    v_cvt_pk_bf16_f32 v89, v142, v143
    v_mfma_f32_16x16x32_bf16 v[152:155], v[184:187], a[136:139], v[152:155]
    v_cvt_pk_bf16_f32 v96, v144, v145
    v_cvt_pk_bf16_f32 v97, v146, v147
    v_mfma_f32_16x16x32_bf16 v[156:159], v[184:187], a[140:143], v[156:159]
    s_waitcnt lgkmcnt(1)
    buffer_load_dwordx4 v216, s[28:31], s75 offen lds
    s_add_u32 m0, s48, 63488
    v_mfma_f32_16x16x32_bf16 v[196:199], v[20:23], v[112:115], v[196:199]
    s_waitcnt lgkmcnt(0)
    s_waitcnt vmcnt(11)
    s_barrier
    v_mfma_f32_16x16x32_bf16 v[116:119], v[48:51], v[72:75], v[116:119]
    ds_read_b128 v[200:203], v0 offset:18432
    ds_read_b128 v[204:207], v1 offset:18432
    v_mfma_f32_16x16x32_bf16 v[108:111], v[32:35], v[72:75], v[108:111]
    ds_read_b128 v[208:211], v0 offset:20480
    v_cvt_pk_bf16_f32 v82, v148, v149
    v_mfma_f32_16x16x32_bf16 v[160:163], v[188:191], a[132:135], v[160:163]
    buffer_load_dwordx4 v217, s[28:31], s75 offen lds
    s_add_u32 m0, s48, 24576
    v_mfma_f32_16x16x32_bf16 v[164:167], v[188:191], a[136:139], v[164:167]
    v_cvt_pk_bf16_f32 v83, v150, v151
    v_cvt_pk_bf16_f32 v90, v152, v153
    v_mfma_f32_16x16x32_bf16 v[168:171], v[188:191], a[140:143], v[168:171]
    v_cvt_pk_bf16_f32 v91, v154, v155
    v_cvt_pk_bf16_f32 v98, v156, v157
    v_mfma_f32_16x16x32_bf16 v[184:187], v[80:83], v[104:107], 0
    v_cvt_pk_bf16_f32 v99, v158, v159
    s_mov_b32 s75, 49152
    s_waitcnt lgkmcnt(2)
    v_mfma_f32_16x16x32_bf16 v[136:139], a[0:3], v[200:203], 0
    s_waitcnt lgkmcnt(1)
    s_barrier
    v_mfma_f32_16x16x32_bf16 v[140:143], a[4:7], v[200:203], 0
    v_cvt_pk_bf16_f32 v84, v160, v161
    v_cvt_pk_bf16_f32 v85, v162, v163
    v_mfma_f32_16x16x32_bf16 v[144:147], a[8:11], v[200:203], 0
    v_cvt_pk_bf16_f32 v92, v164, v165
    v_cvt_pk_bf16_f32 v93, v166, v167
    v_mfma_f32_16x16x32_bf16 v[148:151], v[200:203], a[72:75], 0
    v_cvt_pk_bf16_f32 v100, v168, v169
    v_cvt_pk_bf16_f32 v101, v170, v171
    v_mfma_f32_16x16x32_bf16 v[152:155], v[200:203], a[76:79], 0
    v_max3_f32 v134, v123, v124, v125
    v_max3_f32 v133, v133, v126, v127
    v_mfma_f32_16x16x32_bf16 v[156:159], v[200:203], a[80:83], 0
    s_waitcnt vmcnt(9)
    ds_read_b64_tr_b16 a[216:217], v222 offset:24576
    ds_read_b64_tr_b16 a[218:219], v222 offset:26112
    v_mfma_f32_16x16x32_bf16 v[136:139], a[12:15], v[204:207], v[136:139]
    s_waitcnt lgkmcnt(2)
    ds_read_b64_tr_b16 a[220:221], v222 offset:24584
    ds_read_b64_tr_b16 a[222:223], v222 offset:26120
    v_mfma_f32_16x16x32_bf16 v[140:143], a[16:19], v[204:207], v[140:143]
    ds_read_b64_tr_b16 a[224:225], v212 offset:24576
    ds_read_b64_tr_b16 a[226:227], v212 offset:26112
    v_mfma_f32_16x16x32_bf16 v[144:147], a[20:23], v[204:207], v[144:147]
    ds_read_b128 v[200:203], v1 offset:20480
    v_max3_f32 v134, v134, v128, v129
    v_mfma_f32_16x16x32_bf16 v[148:151], v[204:207], a[84:87], v[148:151]
    v_max3_f32 v133, v133, v130, v131
    v_max3_f32 v133, v133, v134, v132
    v_mfma_f32_16x16x32_bf16 v[152:155], v[204:207], a[88:91], v[152:155]
    v_mov_b32 v134, v133
    v_mov_b32 v62, v16
    v_mfma_f32_16x16x32_bf16 v[156:159], v[204:207], a[92:95], v[156:159]
    ds_read_b128 v[204:207], v0 offset:22528
    s_lshl_b32 s69, s40, 10
    v_mfma_f32_16x16x32_bf16 v[224:227], v[28:31], v[60:63], v[224:227]
    v_permlane32_swap_b32 v134, v133
    v_mfma_f32_16x16x32_bf16 v[236:239], v[52:55], v[60:63], v[236:239]
    s_waitcnt lgkmcnt(2)
    buffer_load_dwordx4 v218, s[28:31], s74 offen lds
    s_add_u32 m0, s48, 25600
    v_mfma_f32_16x16x32_bf16 v[228:231], v[36:39], v[60:63], v[228:231]
    v_max_f32 v133, v133, v134
    v_mov_b32 v134, v133
    v_mfma_f32_16x16x32_bf16 v[232:235], v[44:47], v[60:63], v[232:235]
    v_rcp_f32 v197, v196
    v_mfma_f32_16x16x32_bf16 v[136:139], a[24:27], v[208:211], v[136:139]
    s_waitcnt lgkmcnt(1)
    v_permlane16_swap_b32 v134, v133
    v_mfma_f32_16x16x32_bf16 v[140:143], a[28:31], v[208:211], v[140:143]
    buffer_load_dwordx4 v219, s[28:31], s74 offen lds
    s_add_u32 m0, s48, 26624
    v_mfma_f32_16x16x32_bf16 v[144:147], a[32:35], v[208:211], v[144:147]
    v_max_f32 v133, v133, v134
    v_sub_f32 v120, v120, v133
    v_mfma_f32_16x16x32_bf16 v[148:151], v[208:211], a[96:99], v[148:151]
    v_sub_f32 v121, v121, v133
    v_sub_f32 v122, v122, v133
    v_mfma_f32_16x16x32_bf16 v[152:155], v[208:211], a[100:103], v[152:155]
    s_waitcnt vmcnt(8)
    ds_read_b64_tr_b16 a[228:229], v222 offset:36864
    ds_read_b64_tr_b16 a[230:231], v222 offset:38400
    v_mfma_f32_16x16x32_bf16 v[156:159], v[208:211], a[104:107], v[156:159]
    ds_read_b64_tr_b16 a[232:233], v222 offset:36872
    ds_read_b64_tr_b16 a[234:235], v222 offset:38408
    v_mfma_f32_16x16x32_bf16 v[188:191], v[88:91], v[104:107], 0
    buffer_load_dwordx4 v220, s[28:31], s74 offen lds
    s_add_u32 m0, s48, 36864
    v_mfma_f32_16x16x32_bf16 v[136:139], a[36:39], v[200:203], v[136:139]
    s_waitcnt lgkmcnt(4)
    ds_read_b64_tr_b16 a[236:237], v212 offset:36864
    ds_read_b64_tr_b16 a[238:239], v212 offset:38400
    v_mfma_f32_16x16x32_bf16 v[140:143], a[40:43], v[200:203], v[140:143]
    ds_read_b128 v[208:211], v1 offset:22528
    v_sub_f32 v123, v123, v133
    v_mfma_f32_16x16x32_bf16 v[144:147], a[44:47], v[200:203], v[144:147]
    v_exp_f32 v120, v120
    v_mfma_f32_16x16x32_bf16 v[148:151], v[200:203], a[108:111], v[148:151]
    v_exp_f32 v121, v121
    v_mfma_f32_16x16x32_bf16 v[152:155], v[200:203], a[112:115], v[152:155]
    v_max3_f32 v237, v224, v225, v226
    v_sub_f32 v124, v124, v133
    v_mfma_f32_16x16x32_bf16 v[156:159], v[200:203], a[116:119], v[156:159]
    ds_read_b128 v[200:203], v0 offset:24576
    v_sub_f32 v125, v125, v133
    v_mfma_f32_16x16x32_bf16 v[136:139], a[48:51], v[204:207], v[136:139]
    s_waitcnt lgkmcnt(2)
    buffer_load_dwordx4 v218, s[28:31], s75 offen lds
    s_add_u32 m0, s48, 37888
    v_mfma_f32_16x16x32_bf16 v[140:143], a[52:55], v[204:207], v[140:143]
    s_waitcnt lgkmcnt(1)
    v_sub_f32 v126, v126, v133
    v_sub_f32 v127, v127, v133
    v_mfma_f32_16x16x32_bf16 v[144:147], a[56:59], v[204:207], v[144:147]
    v_exp_f32 v122, v122
    v_mfma_f32_16x16x32_bf16 v[148:151], v[204:207], a[120:123], v[148:151]
    v_exp_f32 v123, v123
    v_mfma_f32_16x16x32_bf16 v[152:155], v[204:207], a[124:127], v[152:155]
    buffer_load_dwordx4 v219, s[28:31], s75 offen lds
    s_add_u32 m0, s48, 38912
    v_mfma_f32_16x16x32_bf16 v[156:159], v[204:207], a[128:131], v[156:159]
    s_waitcnt lgkmcnt(0)
    s_waitcnt vmcnt(8)
    ds_read_b64_tr_b16 a[240:241], v222 offset:49152
    ds_read_b64_tr_b16 a[242:243], v222 offset:50688
    v_mfma_f32_16x16x32_bf16 v[136:139], a[60:63], v[208:211], v[136:139]
    ds_read_b64_tr_b16 a[244:245], v222 offset:49160
    ds_read_b64_tr_b16 a[246:247], v222 offset:50696
    v_mfma_f32_16x16x32_bf16 v[140:143], a[64:67], v[208:211], v[140:143]
    ds_read_b64_tr_b16 a[248:249], v212 offset:49152
    ds_read_b64_tr_b16 a[250:251], v212 offset:50688
    v_mfma_f32_16x16x32_bf16 v[144:147], a[68:71], v[208:211], v[144:147]
    ds_read_b128 v[204:207], v1 offset:24576
    v_max3_f32 v238, v227, v228, v229
    v_mfma_f32_16x16x32_bf16 v[148:151], v[208:211], a[132:135], v[148:151]
    buffer_load_dwordx4 v220, s[28:31], s75 offen lds
    s_add_u32 m0, s45, 0
    v_mfma_f32_16x16x32_bf16 v[152:155], v[208:211], a[136:139], v[152:155]
    v_max3_f32 v237, v237, v230, v231
    v_sub_f32 v128, v128, v133
    v_mfma_f32_16x16x32_bf16 v[156:159], v[208:211], a[140:143], v[156:159]
    ds_read_b128 v[208:211], v0 offset:26624
    v_sub_f32 v129, v129, v133
    v_mfma_f32_16x16x32_bf16 v[172:175], v[192:195], a[132:135], v[172:175]
    v_exp_f32 v124, v124
    v_mfma_f32_16x16x32_bf16 v[176:179], v[192:195], a[136:139], v[176:179]
    buffer_load_dwordx4 v8, s[20:23], s54 offen nt lds
    v_mfma_f32_16x16x32_bf16 v[180:183], v[192:195], a[140:143], v[180:183]
    s_add_u32 m0, s45, 1920
    v_exp_f32 v125, v125
    v_mfma_f32_16x16x32_bf16 v[192:195], v[96:99], v[104:107], 0
    ds_read_b128 v[104:107], v6
    v_cvt_pk_bf16_f32 v86, v172, v173
    v_mfma_f32_16x16x32_bf16 v[160:163], a[0:3], v[200:203], 0
    s_waitcnt lgkmcnt(2)
    v_cvt_pk_bf16_f32 v87, v174, v175
    v_cvt_pk_bf16_f32 v94, v176, v177
    v_mfma_f32_16x16x32_bf16 v[164:167], a[4:7], v[200:203], 0
    v_cvt_pk_bf16_f32 v95, v178, v179
    v_cvt_pk_bf16_f32 v102, v180, v181
    v_mfma_f32_16x16x32_bf16 v[184:187], v[84:87], v[112:115], v[184:187]
    buffer_load_dwordx4 v8, s[20:23], s54 offen offset:128 nt lds
    s_add_u32 m0, s45, 3840
    v_mfma_f32_16x16x32_bf16 v[188:191], v[92:95], v[112:115], v[188:191]
    s_waitcnt vmcnt(8)
    ds_read_b64_tr_b16 a[252:253], v222 offset:61440
    v_mfma_f32_16x16x32_bf16 v[168:171], a[8:11], v[200:203], 0
    ds_read_b64_tr_b16 a[254:255], v222 offset:62976
    v_cvt_pk_bf16_f32 v103, v182, v183
    s_waitcnt lgkmcnt(2)
    v_mfma_f32_16x16x32_bf16 v[104:107], v[24:27], v[72:75], v[104:107]
    v_exp_f32 v126, v126
    v_mfma_f32_16x16x32_bf16 v[192:195], v[100:103], v[112:115], v[192:195]
    ds_read_b128 v[112:115], v6 offset:128
    v_cvt_pk_bf16_f32 v120, v120, v121
    v_mfma_f32_16x16x32_bf16 v[172:175], v[200:203], a[72:75], 0
    buffer_load_dwordx4 v8, s[20:23], s54 offen offset:256 nt lds
    s_add_u32 m0, s46, 0
    v_mfma_f32_16x16x32_bf16 v[176:179], v[200:203], a[76:79], 0
    v_exp_f32 v127, v127
    v_mfma_f32_16x16x32_bf16 v[180:183], v[200:203], a[80:83], 0
    ds_read_b128 v[200:203], v1 offset:26624
    v_max3_f32 v238, v238, v232, v233
    v_mfma_f32_16x16x32_bf16 v[160:163], a[12:15], v[204:207], v[160:163]
    v_max3_f32 v237, v237, v234, v235
    v_mul_f32 v184, v184, v197
    v_mfma_f32_16x16x32_bf16 v[164:167], a[16:19], v[204:207], v[164:167]
    v_mul_f32 v185, v185, v197
    v_sub_f32 v130, v130, v133
    s_waitcnt lgkmcnt(1)
    v_mfma_f32_16x16x32_bf16 v[112:115], v[40:43], v[72:75], v[112:115]
    buffer_load_dwordx4 v9, s[20:23], s58 offen nt lds
    s_add_u32 m0, s47, 0
    v_mfma_f32_16x16x32_bf16 v[168:171], a[20:23], v[204:207], v[168:171]
    v_sub_f32 v131, v131, v133
    v_mul_f32 v186, v186, v197
    v_mfma_f32_16x16x32_bf16 v[172:175], v[204:207], a[84:87], v[172:175]
    v_exp_f32 v128, v128
    v_mfma_f32_16x16x32_bf16 v[176:179], v[204:207], a[88:91], v[176:179]
    v_exp_f32 v129, v129
    v_mfma_f32_16x16x32_bf16 v[180:183], v[204:207], a[92:95], v[180:183]
    s_mov_b64 exec, s[50:51]
    buffer_load_dwordx4 v9, s[20:23], s54 offen offset:128 nt lds
    s_mov_b64 exec, -1
    v_mfma_f32_16x16x32_bf16 v[160:163], a[24:27], v[208:211], v[160:163]
    s_waitcnt lgkmcnt(0)
    ds_read_b128 v[204:207], v0 offset:28672
    v_mul_f32 v187, v187, v197
    v_mfma_f32_16x16x32_bf16 v[164:167], a[28:31], v[208:211], v[164:167]
    v_cvt_pk_bf16_f32 v121, v122, v123
    v_max3_f32 v237, v237, v238, v236
    v_mfma_f32_16x16x32_bf16 v[168:171], a[32:35], v[208:211], v[168:171]
    v_cvt_pk_bf16_f32 v184, v184, v185
    v_add_u32 v3, s69, v2
    v_mfma_f32_16x16x32_bf16 v[172:175], v[208:211], a[96:99], v[172:175]
    v_sub_f32 v132, v132, v133
    v_mul_f32 v188, v188, v197
    v_mfma_f32_16x16x32_bf16 v[176:179], v[208:211], a[100:103], v[176:179]
    s_waitcnt vmcnt(8)
    ds_read_b64_tr_b16 v[240:241], v212 offset:24576
    ds_read_b64_tr_b16 v[242:243], v212 offset:26112
    v_mfma_f32_16x16x32_bf16 v[180:183], v[208:211], a[104:107], v[180:183]
    ds_read_b128 v[208:211], v1 offset:28672
    v_mul_f32 v189, v189, v197
    v_mfma_f32_16x16x32_bf16 v[160:163], a[36:39], v[200:203], v[160:163]
    s_waitcnt lgkmcnt(3)
    v_mul_f32 v190, v190, v197
    v_mul_f32 v191, v191, v197
    v_mfma_f32_16x16x32_bf16 v[164:167], a[40:43], v[200:203], v[164:167]
    v_exp_f32 v130, v130
    v_mfma_f32_16x16x32_bf16 v[168:171], a[44:47], v[200:203], v[168:171]
    v_exp_f32 v131, v131
    v_mfma_f32_16x16x32_bf16 v[172:175], v[200:203], a[108:111], v[172:175]
    v_cvt_pk_bf16_f32 v122, v124, v125
    v_cvt_pk_bf16_f32 v123, v126, v127
    v_mfma_f32_16x16x32_bf16 v[176:179], v[200:203], a[112:115], v[176:179]
    v_mov_b32 v238, v237
    v_cvt_pk_bf16_f32 v185, v186, v187
    v_mfma_f32_16x16x32_bf16 v[180:183], v[200:203], a[116:119], v[180:183]
    s_lshl_b32 s70, s63, 3
    v_mul_f32 v192, v192, v197
    v_mul_f32 v193, v193, v197
    v_mfma_f32_16x16x32_bf16 v[160:163], a[48:51], v[204:207], v[160:163]
    s_waitcnt lgkmcnt(0)
    v_mul_f32 v194, v194, v197
    v_mul_f32 v195, v195, v197
    v_mfma_f32_16x16x32_bf16 v[196:199], v[20:23], v[120:123], 0
    s_lshl_b32 s69, s64, 10
    v_exp_f32 v132, v132
    v_mfma_f32_16x16x32_bf16 v[164:167], a[52:55], v[204:207], v[164:167]
    v_cvt_pk_bf16_f32 v186, v188, v189
    v_cvt_pk_bf16_f32 v187, v190, v191
    v_mfma_f32_16x16x32_bf16 v[188:191], v[88:91], v[120:123], 0
    v_cvt_pk_bf16_f32 v128, v128, v129
    s_add_u32 s69, s69, s70
    v_mfma_f32_16x16x32_bf16 v[168:171], a[56:59], v[204:207], v[168:171]
    v_permlane32_swap_b32 v238, v237
    v_mfma_f32_16x16x32_bf16 v[172:175], v[204:207], a[120:123], v[172:175]
    v_cvt_pk_bf16_f32 v192, v192, v193
    v_cvt_pk_bf16_f32 v129, v130, v131
    v_mfma_f32_16x16x32_bf16 v[176:179], v[204:207], a[124:127], v[176:179]
    s_add_u32 s69, s69, 4096
    v_cvt_pk_bf16_f32 v193, v194, v195
    v_cvt_pk_bf16_f32 v130, v132, 0
    v_mfma_f32_16x16x32_bf16 v[180:183], v[204:207], a[128:131], v[180:183]
    v_mov_b32 v131, 0
    v_add_u32 v4, s69, v2
    v_mfma_f32_16x16x32_bf16 v[160:163], a[60:63], v[208:211], v[160:163]
    s_waitcnt vmcnt(5)
    ds_read_b64_tr_b16 v[244:245], v222 offset:36864
    ds_read_b64_tr_b16 v[246:247], v222 offset:38400
    v_mfma_f32_16x16x32_bf16 v[196:199], v[20:23], v[128:131], v[196:199]
    ds_read_b64_tr_b16 v[248:249], v222 offset:36872
    ds_read_b64_tr_b16 v[250:251], v222 offset:38408
    v_mfma_f32_16x16x32_bf16 v[188:191], v[92:95], v[128:131], v[188:191]
    ds_read_b64_tr_b16 v[252:253], v212 offset:36864
    ds_read_b64_tr_b16 v[254:255], v212 offset:38400
    v_mfma_f32_16x16x32_bf16 v[164:167], a[64:67], v[208:211], v[164:167]
    v_max_f32 v237, v237, v238
    v_mov_b32 v238, v237
    v_mfma_f32_16x16x32_bf16 v[168:171], a[68:71], v[208:211], v[168:171]
    v_mov_b32 v79, 0
    v_cvt_pk_bf16_f32 v24, v136, v137
    v_mfma_f32_16x16x32_bf16 v[172:175], v[208:211], a[132:135], v[172:175]
    v_permlane16_swap_b32 v238, v237
    v_mfma_f32_16x16x32_bf16 v[104:107], v[28:31], v[76:79], v[104:107]
    v_max_f32 v237, v237, v238
    v_sub_f32 v224, v224, v237
    v_mfma_f32_16x16x32_bf16 v[116:119], v[52:55], v[76:79], v[116:119]
    ds_read_b64_tr_b16 v[238:239], v222 offset:26120
    v_sub_f32 v225, v225, v237
    v_mfma_f32_16x16x32_bf16 v[108:111], v[36:39], v[76:79], v[108:111]
    v_rcp_f32 v197, v196
    v_mfma_f32_16x16x32_bf16 v[112:115], v[44:47], v[76:79], v[112:115]
    v_sub_f32 v226, v226, v237
    v_sub_f32 v227, v227, v237
    v_mfma_f32_16x16x32_bf16 v[176:179], v[208:211], a[136:139], v[176:179]
    v_exp_f32 v224, v224
    v_mfma_f32_16x16x32_bf16 v[180:183], v[208:211], a[140:143], v[180:183]
    ds_write_b128 v3, v[184:187] offset:6144
    v_mfma_f32_16x16x32_bf16 v[184:187], v[80:83], v[120:123], 0
    v_exp_f32 v225, v225
    v_mfma_f32_16x16x32_bf16 v[184:187], v[84:87], v[128:131], v[184:187]
    ds_write_b64 v4, v[192:193] offset:6144
    v_mfma_f32_16x16x32_bf16 v[192:195], v[96:99], v[120:123], 0
    v_sub_f32 v228, v228, v237
    v_sub_f32 v229, v229, v237
    v_mfma_f32_16x16x32_bf16 v[192:195], v[100:103], v[128:131], v[192:195]
    v_sub_f32 v230, v230, v237
    v_sub_f32 v231, v231, v237
    v_exp_f32 v226, v226
    v_exp_f32 v227, v227
    v_exp_f32 v228, v228
    v_exp_f32 v229, v229
    v_exp_f32 v230, v230
    v_exp_f32 v231, v231
    v_sub_f32 v232, v232, v237
    v_sub_f32 v233, v233, v237
    v_cvt_pk_bf16_f32 v224, v224, v225
    v_mul_f32 v184, v184, v197
    v_mul_f32 v185, v185, v197
    ds_read_b128 v[200:203], v0 offset:30720
    v_sub_f32 v234, v234, v237
    v_sub_f32 v235, v235, v237
    v_mul_f32 v186, v186, v197
    v_mul_f32 v187, v187, v197
    v_exp_f32 v232, v232
    v_exp_f32 v233, v233
    v_cvt_pk_bf16_f32 v225, v226, v227
    v_cvt_pk_bf16_f32 v184, v184, v185
    v_sub_f32 v236, v236, v237
    v_max3_f32 v117, v104, v105, v106
    v_mul_f32 v188, v188, v197
    v_mul_f32 v189, v189, v197
    v_mul_f32 v190, v190, v197
    v_mul_f32 v191, v191, v197
    v_exp_f32 v234, v234
    v_exp_f32 v235, v235
    v_cvt_pk_bf16_f32 v226, v228, v229
    ds_read_b64_tr_b16 v[228:229], v212 offset:61440
    v_cvt_pk_bf16_f32 v227, v230, v231
    ds_read_b64_tr_b16 v[230:231], v212 offset:62976
    v_cvt_pk_bf16_f32 v185, v186, v187
    v_max3_f32 v118, v107, v108, v109
    v_mul_f32 v192, v192, v197
    v_mul_f32 v193, v193, v197
    v_mul_f32 v194, v194, v197
    v_mul_f32 v195, v195, v197
    v_mfma_f32_16x16x32_bf16 v[196:199], v[20:23], v[224:227], 0
    v_exp_f32 v236, v236
    v_max3_f32 v117, v117, v110, v111
    v_cvt_pk_bf16_f32 v186, v188, v189
    v_cvt_pk_bf16_f32 v187, v190, v191
    v_mfma_f32_16x16x32_bf16 v[188:191], v[88:91], v[224:227], 0
    v_cvt_pk_bf16_f32 v232, v232, v233
    v_max3_f32 v118, v118, v112, v113
    v_cvt_pk_bf16_f32 v192, v192, v193
    v_max3_f32 v117, v117, v114, v115
    ds_read_b128 v[204:207], v1 offset:30720
    v_cvt_pk_bf16_f32 v233, v234, v235
    v_cvt_pk_bf16_f32 v193, v194, v195
    v_max3_f32 v117, v117, v118, v116
    ds_write_b128 v3, v[184:187] offset:12288
    v_mfma_f32_16x16x32_bf16 v[184:187], v[80:83], v[224:227], 0
    v_cvt_pk_bf16_f32 v234, v236, 0
    ds_read_b64_tr_b16 v[236:237], v222 offset:24584
    v_mov_b32 v235, 0
    v_mov_b32 v118, v117
    ds_write_b64 v4, v[192:193] offset:12288
    v_mfma_f32_16x16x32_bf16 v[196:199], v[20:23], v[232:235], v[196:199]
    ds_read_b128 v[208:211], v0 offset:32768
    v_cvt_pk_bf16_f32 v25, v138, v139
    v_mfma_f32_16x16x32_bf16 v[192:195], v[96:99], v[224:227], 0
    s_waitcnt lgkmcnt(4)
    ds_read_b64_tr_b16 v[224:225], v222 offset:61448
    ds_read_b64_tr_b16 v[226:227], v222 offset:62984
    v_mfma_f32_16x16x32_bf16 v[184:187], v[84:87], v[232:235], v[184:187]
    v_permlane32_swap_b32 v118, v117
    v_mfma_f32_16x16x32_bf16 v[188:191], v[92:95], v[232:235], v[188:191]
    v_max_f32 v117, v117, v118
    v_mov_b32 v118, v117
    v_mfma_f32_16x16x32_bf16 v[192:195], v[100:103], v[232:235], v[192:195]
    ds_read_b64_tr_b16 v[232:233], v222 offset:24576
    ds_read_b64_tr_b16 v[234:235], v222 offset:26112
    v_mfma_f32_16x16x32_bf16 v[136:139], a[0:3], v[200:203], 0
    v_permlane16_swap_b32 v118, v117
    v_mfma_f32_16x16x32_bf16 v[136:139], a[12:15], v[204:207], v[136:139]
    s_waitcnt lgkmcnt(4)
    v_rcp_f32 v197, v196
    v_mfma_f32_16x16x32_bf16 v[136:139], a[24:27], v[208:211], v[136:139]
    v_max_f32 v117, v117, v118
    v_mul_f32 v184, v184, v197
    v_mul_f32 v185, v185, v197
    v_sub_f32 v104, v104, v117
    v_sub_f32 v105, v105, v117
    v_mul_f32 v186, v186, v197
    v_mul_f32 v187, v187, v197
    v_sub_f32 v106, v106, v117
    v_sub_f32 v107, v107, v117
    v_cvt_pk_bf16_f32 v184, v184, v185
    v_exp_f32 v104, v104
    v_exp_f32 v105, v105
    v_mul_f32 v188, v188, v197
    v_mul_f32 v189, v189, v197
    v_mul_f32 v190, v190, v197
    v_mul_f32 v191, v191, v197
    v_mul_f32 v192, v192, v197
    v_mul_f32 v193, v193, v197
    v_sub_f32 v108, v108, v117
    v_sub_f32 v109, v109, v117
    v_sub_f32 v110, v110, v117
    v_sub_f32 v111, v111, v117
    v_exp_f32 v106, v106
    v_exp_f32 v107, v107
    v_cvt_pk_bf16_f32 v185, v186, v187
    v_mul_f32 v194, v194, v197
    v_mul_f32 v195, v195, v197
    v_cvt_pk_bf16_f32 v192, v192, v193
    v_exp_f32 v108, v108
    v_exp_f32 v109, v109
    v_exp_f32 v110, v110
    v_exp_f32 v111, v111
    v_cvt_pk_bf16_f32 v186, v188, v189
    v_cvt_pk_bf16_f32 v187, v190, v191
    v_cvt_pk_bf16_f32 v104, v104, v105
    v_cvt_pk_bf16_f32 v193, v194, v195
    v_cvt_pk_bf16_f32 v105, v106, v107
    ds_write_b128 v3, v[184:187] offset:18432
    v_cvt_pk_bf16_f32 v106, v108, v109
    v_cvt_pk_bf16_f32 v107, v110, v111
    v_cvt_pk_bf16_f32 v26, v140, v141
    ds_write_b64 v4, v[192:193] offset:18432
    v_mfma_f32_16x16x32_bf16 v[184:187], v[80:83], v[104:107], 0
    v_cvt_pk_bf16_f32 v27, v142, v143
    v_cvt_pk_bf16_f32 v28, v144, v145
    v_mfma_f32_16x16x32_bf16 v[188:191], v[88:91], v[104:107], 0
    v_cvt_pk_bf16_f32 v29, v146, v147
    v_cvt_pk_bf16_f32 v80, v148, v149
    v_mfma_f32_16x16x32_bf16 v[192:195], v[96:99], v[104:107], 0
    v_cvt_pk_bf16_f32 v81, v150, v151
    v_cvt_pk_bf16_f32 v88, v152, v153
    v_mfma_f32_16x16x32_bf16 v[140:143], a[4:7], v[200:203], 0
    v_cvt_pk_bf16_f32 v89, v154, v155
    v_cvt_pk_bf16_f32 v96, v156, v157
    v_mfma_f32_16x16x32_bf16 v[144:147], a[8:11], v[200:203], 0
    v_cvt_pk_bf16_f32 v97, v158, v159
    v_cvt_pk_bf16_f32 v32, v160, v161
    v_mfma_f32_16x16x32_bf16 v[148:151], v[200:203], a[72:75], 0
    v_cvt_pk_bf16_f32 v33, v162, v163
    v_cvt_pk_bf16_f32 v34, v164, v165
    v_mfma_f32_16x16x32_bf16 v[152:155], v[200:203], a[76:79], 0
    s_waitcnt lgkmcnt(0)
    v_cvt_pk_bf16_f32 v35, v166, v167
    v_cvt_pk_bf16_f32 v36, v168, v169
    v_mfma_f32_16x16x32_bf16 v[156:159], v[200:203], a[80:83], 0
    ds_read_b128 v[200:203], v1 offset:32768
    v_cvt_pk_bf16_f32 v37, v170, v171
    v_mfma_f32_16x16x32_bf16 v[140:143], a[16:19], v[204:207], v[140:143]
    s_barrier
    v_mfma_f32_16x16x32_bf16 v[144:147], a[20:23], v[204:207], v[144:147]
    ds_read_b128 v[212:215], v2 offset:6144
    ds_read_b128 v[216:219], v2 offset:7168
    v_mfma_f32_16x16x32_bf16 v[148:151], v[204:207], a[84:87], v[148:151]
    ds_read_b128 v[220:223], v2 offset:8192
    v_cvt_pk_bf16_f32 v82, v172, v173
    v_mfma_f32_16x16x32_bf16 v[152:155], v[204:207], a[88:91], v[152:155]
    v_cvt_pk_bf16_f32 v83, v174, v175
    v_cvt_pk_bf16_f32 v90, v176, v177
    v_mfma_f32_16x16x32_bf16 v[156:159], v[204:207], a[92:95], v[156:159]
    s_waitcnt lgkmcnt(3)
    ds_read_b128 v[204:207], v0 offset:34816
    v_cvt_pk_bf16_f32 v91, v178, v179
    v_mfma_f32_16x16x32_bf16 v[140:143], a[28:31], v[208:211], v[140:143]
    v_cvt_pk_bf16_f32 v98, v180, v181
    v_cvt_pk_bf16_f32 v99, v182, v183
    v_mfma_f32_16x16x32_bf16 v[144:147], a[32:35], v[208:211], v[144:147]
    v_lshrrev_b32 v19, 4, v2
    v_subrev_u32 v19, 0x1500, v19
    v_mfma_f32_16x16x32_bf16 v[148:151], v[208:211], a[96:99], v[148:151]
    s_waitcnt lgkmcnt(3)
    v_lshrrev_b32 v7, 4, v19
    v_cmp_eq_u32 vcc, 1, v7
    v_mfma_f32_16x16x32_bf16 v[152:155], v[208:211], a[100:103], v[152:155]
    v_and_b32 v19, 15, v19
    v_mov_b32 v7, 16
    v_mfma_f32_16x16x32_bf16 v[156:159], v[208:211], a[104:107], v[156:159]
    ds_read_b128 v[208:211], v1 offset:34816
    v_cndmask_b32 v19, v7, v19, vcc
    v_mfma_f32_16x16x32_bf16 v[136:139], a[36:39], v[200:203], v[136:139]
    s_waitcnt lgkmcnt(1)
    v_lshlrev_b32 v19, 2, v19
    v_add_u32 v7, s49, v19
    v_mfma_f32_16x16x32_bf16 v[140:143], a[40:43], v[200:203], v[140:143]
    ds_read_b128 v[120:123], v5
    ds_read_b32 v132, v7 offset:9216
    v_mfma_f32_16x16x32_bf16 v[144:147], a[44:47], v[200:203], v[144:147]
    ds_read_b128 v[124:127], v5 offset:1024
    ds_read_b128 v[128:131], v5 offset:2048
    v_mfma_f32_16x16x32_bf16 v[148:151], v[200:203], a[108:111], v[148:151]
    v_sub_f32 v112, v112, v117
    v_sub_f32 v113, v113, v117
    v_mfma_f32_16x16x32_bf16 v[152:155], v[200:203], a[112:115], v[152:155]
    v_sub_f32 v114, v114, v117
    v_sub_f32 v115, v115, v117
    v_mfma_f32_16x16x32_bf16 v[156:159], v[200:203], a[116:119], v[156:159]
    ds_read_b128 v[200:203], v0 offset:18432
    v_sub_f32 v116, v116, v117
    v_mfma_f32_16x16x32_bf16 v[136:139], a[48:51], v[204:207], v[136:139]
    s_waitcnt lgkmcnt(5)
    v_exp_f32 v112, v112
    v_mfma_f32_16x16x32_bf16 v[140:143], a[52:55], v[204:207], v[140:143]
    v_exp_f32 v113, v113
    v_mfma_f32_16x16x32_bf16 v[144:147], a[56:59], v[204:207], v[144:147]
    v_exp_f32 v114, v114
    v_mfma_f32_16x16x32_bf16 v[148:151], v[204:207], a[120:123], v[148:151]
    v_exp_f32 v115, v115
    v_mfma_f32_16x16x32_bf16 v[152:155], v[204:207], a[124:127], v[152:155]
    v_exp_f32 v116, v116
    v_mfma_f32_16x16x32_bf16 v[156:159], v[204:207], a[128:131], v[156:159]
    s_waitcnt lgkmcnt(0)
    ds_read_b128 v[204:207], v1 offset:18432
    v_cvt_pk_bf16_f32 v112, v112, v113
    v_mfma_f32_16x16x32_bf16 v[136:139], a[60:63], v[208:211], v[136:139]
    v_cvt_pk_bf16_f32 v113, v114, v115
    v_cvt_pk_bf16_f32 v114, v116, 0
    v_mfma_f32_16x16x32_bf16 v[140:143], a[64:67], v[208:211], v[140:143]
    v_mov_b32 v115, 0
    v_mov_b32 v62, v15
    v_mfma_f32_16x16x32_bf16 v[144:147], a[68:71], v[208:211], v[144:147]
    ds_read_b32 v116, v7 offset:9296
    ds_read_b128 v[108:111], v5 offset:4096
    v_mfma_f32_16x16x32_bf16 v[148:151], v[208:211], a[132:135], v[148:151]
    v_cvt_pk_bf16_f32 v40, v136, v137
    v_cvt_pk_bf16_f32 v41, v138, v139
    v_mfma_f32_16x16x32_bf16 v[152:155], v[208:211], a[136:139], v[152:155]
    v_cvt_pk_bf16_f32 v42, v140, v141
    v_cvt_pk_bf16_f32 v43, v142, v143
    v_mfma_f32_16x16x32_bf16 v[156:159], v[208:211], a[140:143], v[156:159]
    ds_read_b128 v[208:211], v0 offset:20480
    v_cvt_pk_bf16_f32 v44, v144, v145
    v_mfma_f32_16x16x32_bf16 v[160:163], a[144:147], v[200:203], 0
    s_waitcnt lgkmcnt(3)
    v_cvt_pk_bf16_f32 v45, v146, v147
    v_bfe_i32 v19, v11, 0, 1
    v_mfma_f32_16x16x32_bf16 v[164:167], a[148:151], v[200:203], 0
    v_and_b32 v19, 0x15000, v19
    v_sub_u32 v8, v8, v19
    v_mfma_f32_16x16x32_bf16 v[168:171], a[152:155], v[200:203], 0
    ds_read_b128 v[200:203], v1 offset:20480
    v_add_u32 v8, 0x1f80, v8
    v_mfma_f32_16x16x32_bf16 v[160:163], a[156:159], v[204:207], v[160:163]
    s_add_u32 m0, s45, 18432
    v_bfe_i32 v19, v11, 1, 1
    v_and_b32 v19, 0x15000, v19
    v_mfma_f32_16x16x32_bf16 v[164:167], a[160:163], v[204:207], v[164:167]
    v_sub_u32 v9, v9, v19
    v_add_u32 v9, 0x1f80, v9
    v_mfma_f32_16x16x32_bf16 v[168:171], a[164:167], v[204:207], v[168:171]
    s_waitcnt lgkmcnt(1)
    ds_read_b128 v[204:207], v0 offset:22528
    v_lshrrev_b32 v19, 4, v2
    v_mfma_f32_16x16x32_bf16 v[160:163], a[168:171], v[208:211], v[160:163]
    v_subrev_u32 v19, 0x1500, v19
    s_add_u32 s70, s60, 6
    v_mfma_f32_16x16x32_bf16 v[164:167], a[172:175], v[208:211], v[164:167]
    s_cmp_ge_u32 s70, 224
    s_cselect_b32 s71, 224, 0
    s_sub_u32 s70, s70, s71
    v_mfma_f32_16x16x32_bf16 v[168:171], a[176:179], v[208:211], v[168:171]
    s_waitcnt lgkmcnt(1)
    ds_read_b128 v[208:211], v1 offset:22528
    s_lshl_b32 s3, s63, 5
    v_mfma_f32_16x16x32_bf16 v[160:163], a[180:183], v[200:203], v[160:163]
    s_mul_i32 s71, s40, 96
    s_mul_i32 s70, s70, 86016
    s_add_u32 s71, s71, s3
    v_mfma_f32_16x16x32_bf16 v[164:167], a[184:187], v[200:203], v[164:167]
    s_add_u32 s70, s70, s71
    v_mfma_f32_16x16x32_bf16 v[168:171], a[188:191], v[200:203], v[168:171]
    s_waitcnt lgkmcnt(1)
    ds_read_b128 v[200:203], v0 offset:24576
    v_mfma_f32_16x16x32_bf16 v[160:163], a[192:195], v[204:207], v[160:163]
    v_mfma_f32_16x16x32_bf16 v[164:167], a[196:199], v[204:207], v[164:167]
    v_mfma_f32_16x16x32_bf16 v[168:171], a[200:203], v[204:207], v[168:171]
    s_waitcnt lgkmcnt(1)
    ds_read_b128 v[204:207], v1 offset:24576
    v_mfma_f32_16x16x32_bf16 v[160:163], a[204:207], v[208:211], v[160:163]
    v_mfma_f32_16x16x32_bf16 v[164:167], a[208:211], v[208:211], v[164:167]
    v_mfma_f32_16x16x32_bf16 v[168:171], a[212:215], v[208:211], v[168:171]
    ds_read_b128 v[208:211], v0 offset:26624
    v_mfma_f32_16x16x32_bf16 v[172:175], a[216:219], v[212:215], 0
    v_mfma_f32_16x16x32_bf16 v[176:179], a[220:223], v[212:215], 0
    v_mfma_f32_16x16x32_bf16 v[180:183], a[224:227], v[212:215], 0
    ds_read_b128 v[212:215], v2 offset:9216
    v_mfma_f32_16x16x32_bf16 v[172:175], a[228:231], v[216:219], v[172:175]
    v_mul_f32 v160, s43, v160
    v_mul_f32 v161, s43, v161
    v_mfma_f32_16x16x32_bf16 v[176:179], a[232:235], v[216:219], v[176:179]
    v_mul_f32 v162, s43, v162
    v_mul_f32 v163, s43, v163
    v_mfma_f32_16x16x32_bf16 v[180:183], a[236:239], v[216:219], v[180:183]
    v_mul_f32 v164, s43, v164
    v_mul_f32 v165, s43, v165
    v_mfma_f32_16x16x32_bf16 v[172:175], a[240:243], v[220:223], v[172:175]
    v_mul_f32 v166, s43, v166
    v_mul_f32 v167, s43, v167
    v_mfma_f32_16x16x32_bf16 v[176:179], a[244:247], v[220:223], v[176:179]
    v_mul_f32 v168, s43, v168
    v_mul_f32 v169, s43, v169
    v_mfma_f32_16x16x32_bf16 v[180:183], a[248:251], v[220:223], v[180:183]
    s_waitcnt lgkmcnt(0)
    v_mul_f32 v170, s43, v170
    v_mul_f32 v171, s43, v171
    v_mfma_f32_16x16x32_bf16 v[172:175], a[252:255], v[212:215], v[172:175]
    v_cvt_pk_bf16_f32 v56, v160, v161
    v_cvt_pk_bf16_f32 v57, v162, v163
    v_mfma_f32_16x16x32_bf16 v[160:163], a[144:147], v[200:203], 0
    v_cvt_pk_bf16_f32 v58, v164, v165
    v_cvt_pk_bf16_f32 v59, v166, v167
    v_mfma_f32_16x16x32_bf16 v[164:167], a[148:151], v[200:203], 0
    v_cvt_pk_bf16_f32 v60, v168, v169
    v_cvt_pk_bf16_f32 v61, v170, v171
    v_mfma_f32_16x16x32_bf16 v[168:171], a[152:155], v[200:203], 0
    ds_read_b128 v[200:203], v1 offset:26624
    ds_read_b128 v[216:219], v2 offset:10240
    v_mfma_f32_16x16x32_bf16 v[160:163], a[156:159], v[204:207], v[160:163]
    ds_read_b128 v[220:223], v2 offset:11264
    v_mfma_f32_16x16x32_bf16 v[164:167], a[160:163], v[204:207], v[164:167]
    v_mfma_f32_16x16x32_bf16 v[168:171], a[164:167], v[204:207], v[168:171]
    ds_read_b128 v[204:207], v0 offset:28672
    v_mfma_f32_16x16x32_bf16 v[160:163], a[168:171], v[208:211], v[160:163]
    v_mfma_f32_16x16x32_bf16 v[164:167], a[172:175], v[208:211], v[164:167]
    v_mfma_f32_16x16x32_bf16 v[168:171], a[176:179], v[208:211], v[168:171]
    s_waitcnt lgkmcnt(3)
    ds_read_b128 v[208:211], v1 offset:28672
    v_mfma_f32_16x16x32_bf16 v[160:163], a[180:183], v[200:203], v[160:163]
    s_waitcnt lgkmcnt(3)
    v_mfma_f32_16x16x32_bf16 v[164:167], a[184:187], v[200:203], v[164:167]
    v_mfma_f32_16x16x32_bf16 v[168:171], a[188:191], v[200:203], v[168:171]
    s_waitcnt lgkmcnt(1)
    ds_read_b128 v[200:203], v0 offset:30720
    v_mfma_f32_16x16x32_bf16 v[160:163], a[192:195], v[204:207], v[160:163]
    v_mfma_f32_16x16x32_bf16 v[164:167], a[196:199], v[204:207], v[164:167]
    v_mfma_f32_16x16x32_bf16 v[168:171], a[200:203], v[204:207], v[168:171]
    s_waitcnt lgkmcnt(1)
    ds_read_b128 v[204:207], v1 offset:30720
    v_mfma_f32_16x16x32_bf16 v[160:163], a[204:207], v[208:211], v[160:163]
    v_mfma_f32_16x16x32_bf16 v[164:167], a[208:211], v[208:211], v[164:167]
    v_mfma_f32_16x16x32_bf16 v[168:171], a[212:215], v[208:211], v[168:171]
    ds_read_b128 v[208:211], v0 offset:32768
    v_mfma_f32_16x16x32_bf16 v[176:179], v[224:227], v[212:215], v[176:179]
    v_mfma_f32_16x16x32_bf16 v[180:183], v[228:231], v[212:215], v[180:183]
    ds_read_b128 v[212:215], v2 offset:12288
    v_mfma_f32_16x16x32_bf16 v[172:175], v[232:235], v[216:219], v[172:175]
    v_mfma_f32_16x16x32_bf16 v[176:179], v[236:239], v[216:219], v[176:179]
    v_mul_f32 v160, s43, v160
    v_mul_f32 v161, s43, v161
    v_mfma_f32_16x16x32_bf16 v[180:183], v[240:243], v[216:219], v[180:183]
    ds_read_b128 v[216:219], v2 offset:13312
    v_mul_f32 v162, s43, v162
    v_mfma_f32_16x16x32_bf16 v[172:175], v[244:247], v[220:223], v[172:175]
    v_mul_f32 v163, s43, v163
    v_mul_f32 v164, s43, v164
    v_mfma_f32_16x16x32_bf16 v[176:179], v[248:251], v[220:223], v[176:179]
    v_mul_f32 v165, s43, v165
    v_mul_f32 v166, s43, v166
    v_mfma_f32_16x16x32_bf16 v[180:183], v[252:255], v[220:223], v[180:183]
    ds_read_b128 v[220:223], v2 offset:14336
    v_mul_f32 v167, s43, v167
    v_mfma_f32_16x16x32_bf16 v[120:123], v[24:27], v[56:59], v[120:123]
    v_mul_f32 v168, s43, v168
    v_mul_f32 v169, s43, v169
    v_mfma_f32_16x16x32_bf16 v[132:135], v[48:51], v[56:59], v[132:135]
    v_mul_f32 v170, s43, v170
    v_mul_f32 v171, s43, v171
    v_mfma_f32_16x16x32_bf16 v[124:127], v[32:35], v[56:59], v[124:127]
    v_cvt_pk_bf16_f32 v64, v160, v161
    v_cvt_pk_bf16_f32 v65, v162, v163
    v_mfma_f32_16x16x32_bf16 v[128:131], v[40:43], v[56:59], v[128:131]
    s_waitcnt lgkmcnt(1)
    v_cvt_pk_bf16_f32 v66, v164, v165
    v_cvt_pk_bf16_f32 v67, v166, v167
    v_mfma_f32_16x16x32_bf16 v[120:123], v[28:31], v[60:63], v[120:123]
    v_cvt_pk_bf16_f32 v68, v168, v169
    v_cvt_pk_bf16_f32 v69, v170, v171
    v_mfma_f32_16x16x32_bf16 v[132:135], v[52:55], v[60:63], v[132:135]
    v_cvt_pk_bf16_f32 v172, v172, v173
    v_cvt_pk_bf16_f32 v173, v174, v175
    v_mfma_f32_16x16x32_bf16 v[160:163], a[144:147], v[200:203], 0
    v_cvt_pk_bf16_f32 v180, v180, v181
    v_cvt_pk_bf16_f32 v174, v176, v177
    v_mfma_f32_16x16x32_bf16 v[164:167], a[148:151], v[200:203], 0
    v_cvt_pk_bf16_f32 v175, v178, v179
    v_cvt_pk_bf16_f32 v181, v182, v183
    v_mfma_f32_16x16x32_bf16 v[168:171], a[152:155], v[200:203], 0
    ds_read_b128 v[200:203], v1 offset:32768
    v_add_u32 v182, v12, v10
    v_mfma_f32_16x16x32_bf16 v[124:127], v[36:39], v[60:63], v[124:127]
    v_max3_f32 v133, v120, v121, v122
    v_mfma_f32_16x16x32_bf16 v[128:131], v[44:47], v[60:63], v[128:131]
    v_mov_b32 v62, v16
    v_mfma_f32_16x16x32_bf16 v[160:163], a[156:159], v[204:207], v[160:163]
    buffer_store_dwordx4 v[172:175], v12, s[36:39], 0 offen sc1
    v_mfma_f32_16x16x32_bf16 v[164:167], a[160:163], v[204:207], v[164:167]
    v_mfma_f32_16x16x32_bf16 v[168:171], a[164:167], v[204:207], v[168:171]
    ds_read_b128 v[204:207], v0 offset:34816
    v_max3_f32 v134, v123, v124, v125
    v_mfma_f32_16x16x32_bf16 v[196:199], v[20:23], v[104:107], 0
    ds_read_b128 v[104:107], v5 offset:3072
    v_max3_f32 v133, v133, v126, v127
    v_mfma_f32_16x16x32_bf16 v[160:163], a[168:171], v[208:211], v[160:163]
    s_waitcnt lgkmcnt(2)
    v_max3_f32 v134, v134, v128, v129
    v_max3_f32 v133, v133, v130, v131
    v_mfma_f32_16x16x32_bf16 v[164:167], a[172:175], v[208:211], v[164:167]
    v_max3_f32 v133, v133, v134, v132
    v_mov_b32 v134, v133
    v_mfma_f32_16x16x32_bf16 v[168:171], a[176:179], v[208:211], v[168:171]
    ds_read_b128 v[208:211], v1 offset:34816
    v_mfma_f32_16x16x32_bf16 v[184:187], v[84:87], v[112:115], v[184:187]
    v_cvt_pk_bf16_f32 v84, v148, v149
    v_cvt_pk_bf16_f32 v85, v150, v151
    v_mfma_f32_16x16x32_bf16 v[188:191], v[92:95], v[112:115], v[188:191]
    v_cvt_pk_bf16_f32 v92, v152, v153
    v_cvt_pk_bf16_f32 v93, v154, v155
    v_mfma_f32_16x16x32_bf16 v[192:195], v[100:103], v[112:115], v[192:195]
    s_waitcnt lgkmcnt(1)
    v_cvt_pk_bf16_f32 v100, v156, v157
    v_cvt_pk_bf16_f32 v101, v158, v159
    v_mfma_f32_16x16x32_bf16 v[176:179], a[220:223], v[212:215], 0
    v_permlane32_swap_b32 v134, v133
    v_mfma_f32_16x16x32_bf16 v[172:175], a[216:219], v[212:215], 0
    v_max_f32 v133, v133, v134
    v_mov_b32 v134, v133
    v_mfma_f32_16x16x32_bf16 v[196:199], v[20:23], v[112:115], v[196:199]
    s_waitcnt lgkmcnt(0)
    s_waitcnt vmcnt(1)
    s_barrier
    v_mfma_f32_16x16x32_bf16 v[176:179], a[232:235], v[216:219], v[176:179]
    ds_read_b128 v[112:115], v5 offset:5120
    buffer_load_dwordx4 v8, s[20:23], s52 offen nt lds
    v_mfma_f32_16x16x32_bf16 v[172:175], a[228:231], v[216:219], v[172:175]
    s_add_u32 m0, s45, 20352
    v_permlane16_swap_b32 v134, v133
    v_mfma_f32_16x16x32_bf16 v[176:179], a[244:247], v[220:223], v[176:179]
    v_rcp_f32 v197, v196
    v_mfma_f32_16x16x32_bf16 v[172:175], a[240:243], v[220:223], v[172:175]
    v_max_f32 v133, v133, v134
    v_mul_f32 v184, v184, v197
    v_mfma_f32_16x16x32_bf16 v[116:119], v[48:51], v[64:67], v[116:119]
    buffer_load_dwordx4 v8, s[20:23], s52 offen offset:128 nt lds
    s_add_u32 m0, s45, 22272
    v_mfma_f32_16x16x32_bf16 v[104:107], v[24:27], v[64:67], v[104:107]
    v_mul_f32 v185, v185, v197
    v_sub_f32 v120, v120, v133
    v_mfma_f32_16x16x32_bf16 v[108:111], v[32:35], v[64:67], v[108:111]
    s_waitcnt lgkmcnt(0)
    v_sub_f32 v121, v121, v133
    v_mul_f32 v186, v186, v197
    v_mfma_f32_16x16x32_bf16 v[112:115], v[40:43], v[64:67], v[112:115]
    v_mul_f32 v187, v187, v197
    v_sub_f32 v122, v122, v133
    v_mfma_f32_16x16x32_bf16 v[116:119], v[52:55], v[68:71], v[116:119]
    v_sub_f32 v123, v123, v133
    v_cvt_pk_bf16_f32 v184, v184, v185
    v_mfma_f32_16x16x32_bf16 v[104:107], v[28:31], v[68:71], v[104:107]
    buffer_load_dwordx4 v8, s[20:23], s52 offen offset:256 nt lds
    s_add_u32 m0, s46, 18432
    v_mfma_f32_16x16x32_bf16 v[108:111], v[36:39], v[68:71], v[108:111]
    v_exp_f32 v120, v120
    v_mfma_f32_16x16x32_bf16 v[112:115], v[44:47], v[68:71], v[112:115]
    v_exp_f32 v121, v121
    v_mfma_f32_16x16x32_bf16 v[160:163], a[180:183], v[200:203], v[160:163]
    v_mul_f32 v188, v188, v197
    v_mul_f32 v189, v189, v197
    v_mfma_f32_16x16x32_bf16 v[164:167], a[184:187], v[200:203], v[164:167]
    v_mul_f32 v190, v190, v197
    v_mul_f32 v191, v191, v197
    v_mfma_f32_16x16x32_bf16 v[168:171], a[188:191], v[200:203], v[168:171]
    ds_read_b128 v[200:203], v0
    buffer_load_dwordx4 v9, s[20:23], s56 offen nt lds
    v_mfma_f32_16x16x32_bf16 v[160:163], a[192:195], v[204:207], v[160:163]
    s_add_u32 m0, s47, 18432
    v_mul_f32 v192, v192, v197
    v_mul_f32 v193, v193, v197
    v_mfma_f32_16x16x32_bf16 v[164:167], a[196:199], v[204:207], v[164:167]
    v_sub_f32 v124, v124, v133
    v_sub_f32 v125, v125, v133
    v_mfma_f32_16x16x32_bf16 v[168:171], a[200:203], v[204:207], v[168:171]
    ds_read_b128 v[204:207], v1
    v_sub_f32 v126, v126, v133
    v_mfma_f32_16x16x32_bf16 v[160:163], a[204:207], v[208:211], v[160:163]
    s_mov_b64 exec, s[50:51]
    buffer_load_dwordx4 v9, s[20:23], s52 offen offset:128 nt lds
    s_mov_b64 exec, -1
    v_mfma_f32_16x16x32_bf16 v[164:167], a[208:211], v[208:211], v[164:167]
    s_waitcnt lgkmcnt(1)
    v_sub_f32 v127, v127, v133
    v_cvt_pk_bf16_f32 v185, v186, v187
    v_mfma_f32_16x16x32_bf16 v[168:171], a[212:215], v[208:211], v[168:171]
    ds_read_b128 v[208:211], v0 offset:2048
    v_mul_f32 v194, v194, v197
    v_mfma_f32_16x16x32_bf16 v[136:139], a[0:3], v[200:203], 0
    v_exp_f32 v122, v122
    v_mfma_f32_16x16x32_bf16 v[140:143], a[4:7], v[200:203], 0
    s_waitcnt lgkmcnt(1)
    v_exp_f32 v123, v123
    v_mfma_f32_16x16x32_bf16 v[144:147], a[8:11], v[200:203], 0
    v_mul_f32 v195, v195, v197
    v_cvt_pk_bf16_f32 v192, v192, v193
    v_mfma_f32_16x16x32_bf16 v[148:151], v[200:203], a[72:75], 0
    v_exp_f32 v124, v124
    v_mfma_f32_16x16x32_bf16 v[152:155], v[200:203], a[76:79], 0
    v_exp_f32 v125, v125
    v_mfma_f32_16x16x32_bf16 v[156:159], v[200:203], a[80:83], 0
    ds_read_b128 v[200:203], v1 offset:2048
    v_cvt_pk_bf16_f32 v186, v188, v189
    v_mfma_f32_16x16x32_bf16 v[136:139], a[12:15], v[204:207], v[136:139]
    s_waitcnt lgkmcnt(1)
    v_exp_f32 v126, v126
    v_mfma_f32_16x16x32_bf16 v[140:143], a[16:19], v[204:207], v[140:143]
    v_exp_f32 v127, v127
    v_mfma_f32_16x16x32_bf16 v[144:147], a[20:23], v[204:207], v[144:147]
    v_cvt_pk_bf16_f32 v187, v190, v191
    v_sub_f32 v128, v128, v133
    v_mfma_f32_16x16x32_bf16 v[148:151], v[204:207], a[84:87], v[148:151]
    v_sub_f32 v129, v129, v133
    v_cvt_pk_bf16_f32 v120, v120, v121
    v_mfma_f32_16x16x32_bf16 v[152:155], v[204:207], a[88:91], v[152:155]
    v_cvt_pk_bf16_f32 v193, v194, v195
    v_sub_f32 v130, v130, v133
    v_mfma_f32_16x16x32_bf16 v[156:159], v[204:207], a[92:95], v[156:159]
    ds_read_b128 v[204:207], v0 offset:4096
    v_sub_f32 v131, v131, v133
    v_mfma_f32_16x16x32_bf16 v[136:139], a[24:27], v[208:211], v[136:139]
    s_waitcnt lgkmcnt(1)
    v_exp_f32 v128, v128
    v_mfma_f32_16x16x32_bf16 v[140:143], a[28:31], v[208:211], v[140:143]
    v_exp_f32 v129, v129
    v_mfma_f32_16x16x32_bf16 v[144:147], a[32:35], v[208:211], v[144:147]
    v_cvt_pk_bf16_f32 v121, v122, v123
    v_sub_f32 v132, v132, v133
    v_mfma_f32_16x16x32_bf16 v[148:151], v[208:211], a[96:99], v[148:151]
    v_max3_f32 v117, v104, v105, v106
    v_cvt_pk_bf16_f32 v122, v124, v125
    v_mfma_f32_16x16x32_bf16 v[152:155], v[208:211], a[100:103], v[152:155]
    v_exp_f32 v130, v130
    v_mfma_f32_16x16x32_bf16 v[156:159], v[208:211], a[104:107], v[156:159]
    ds_read_b128 v[208:211], v1 offset:4096
    v_cvt_pk_bf16_f32 v123, v126, v127
    v_mfma_f32_16x16x32_bf16 v[136:139], a[36:39], v[200:203], v[136:139]
    s_waitcnt lgkmcnt(1)
    v_exp_f32 v131, v131
    v_mfma_f32_16x16x32_bf16 v[196:199], v[20:23], v[120:123], 0
    v_max3_f32 v118, v107, v108, v109
    v_max3_f32 v117, v117, v110, v111
    v_mfma_f32_16x16x32_bf16 v[188:191], v[88:91], v[120:123], 0
    v_exp_f32 v132, v132
    v_mfma_f32_16x16x32_bf16 v[140:143], a[40:43], v[200:203], v[140:143]
    v_cvt_pk_bf16_f32 v128, v128, v129
    v_max3_f32 v118, v118, v112, v113
    v_mfma_f32_16x16x32_bf16 v[144:147], a[44:47], v[200:203], v[144:147]
    v_max3_f32 v117, v117, v114, v115
    v_cvt_pk_bf16_f32 v129, v130, v131
    v_mfma_f32_16x16x32_bf16 v[148:151], v[200:203], a[108:111], v[148:151]
    v_max3_f32 v117, v117, v118, v116
    v_cvt_pk_bf16_f32 v130, v132, 0
    v_mfma_f32_16x16x32_bf16 v[152:155], v[200:203], a[112:115], v[152:155]
    v_mov_b32 v131, 0
    v_mov_b32 v118, v117
    v_mfma_f32_16x16x32_bf16 v[156:159], v[200:203], a[116:119], v[156:159]
    ds_read_b128 v[200:203], v0 offset:6144
    ds_read_b32 v132, v7 offset:9376
    v_mfma_f32_16x16x32_bf16 v[196:199], v[20:23], v[128:131], v[196:199]
    v_permlane32_swap_b32 v118, v117
    v_mfma_f32_16x16x32_bf16 v[188:191], v[92:95], v[128:131], v[188:191]
    ds_read_b128 v[124:127], v5 offset:7168
    v_max_f32 v117, v117, v118
    v_mfma_f32_16x16x32_bf16 v[136:139], a[48:51], v[204:207], v[136:139]
    s_waitcnt lgkmcnt(3)
    v_mov_b32 v118, v117
    v_mul_f32 v160, s43, v160
    v_mfma_f32_16x16x32_bf16 v[140:143], a[52:55], v[204:207], v[140:143]
    v_permlane16_swap_b32 v118, v117
    v_mfma_f32_16x16x32_bf16 v[144:147], a[56:59], v[204:207], v[144:147]
    v_rcp_f32 v197, v196
    v_mfma_f32_16x16x32_bf16 v[148:151], v[204:207], a[120:123], v[148:151]
    v_max_f32 v117, v117, v118
    v_sub_f32 v104, v104, v117
    v_mfma_f32_16x16x32_bf16 v[152:155], v[204:207], a[124:127], v[152:155]
    v_sub_f32 v105, v105, v117
    v_sub_f32 v106, v106, v117
    v_mfma_f32_16x16x32_bf16 v[156:159], v[204:207], a[128:131], v[156:159]
    ds_read_b128 v[204:207], v1 offset:6144
    v_sub_f32 v107, v107, v117
    v_mfma_f32_16x16x32_bf16 v[136:139], a[60:63], v[208:211], v[136:139]
    v_exp_f32 v104, v104
    v_mfma_f32_16x16x32_bf16 v[140:143], a[64:67], v[208:211], v[140:143]
    v_exp_f32 v105, v105
    v_mfma_f32_16x16x32_bf16 v[144:147], a[68:71], v[208:211], v[144:147]
    v_mul_f32 v188, v188, v197
    v_mul_f32 v189, v189, v197
    v_mfma_f32_16x16x32_bf16 v[148:151], v[208:211], a[132:135], v[148:151]
    v_mul_f32 v190, v190, v197
    v_mul_f32 v191, v191, v197
    v_mfma_f32_16x16x32_bf16 v[152:155], v[208:211], a[136:139], v[152:155]
    v_sub_f32 v108, v108, v117
    v_sub_f32 v109, v109, v117
    v_mfma_f32_16x16x32_bf16 v[156:159], v[208:211], a[140:143], v[156:159]
    buffer_store_dwordx2 v[180:181], v182, s[36:39], 0 offen sc1
    v_mfma_f32_16x16x32_bf16 v[180:183], a[224:227], v[212:215], 0
    ds_read_b128 v[212:215], v2 offset:15360
    ds_read_b128 v[208:211], v0 offset:8192
    v_mfma_f32_16x16x32_bf16 v[180:183], a[236:239], v[216:219], v[180:183]
    ds_read_b128 v[216:219], v2 offset:16384
    v_sub_f32 v110, v110, v117
    v_mfma_f32_16x16x32_bf16 v[180:183], a[248:251], v[220:223], v[180:183]
    ds_read_b128 v[220:223], v2 offset:17408
    s_mov_b32 exec_lo, 0x10001
    s_mov_b32 exec_hi, 0x10001
    ds_write_b128 v3, v[184:187]
    s_mov_b64 exec, -1
    v_mfma_f32_16x16x32_bf16 v[184:187], v[80:83], v[120:123], 0
    v_sub_f32 v111, v111, v117
    v_sub_f32 v112, v112, v117
    v_mfma_f32_16x16x32_bf16 v[184:187], v[84:87], v[128:131], v[184:187]
    s_waitcnt lgkmcnt(4)
    v_exp_f32 v106, v106
    v_mfma_f32_16x16x32_bf16 v[172:175], a[252:255], v[212:215], v[172:175]
    v_exp_f32 v107, v107
    v_mfma_f32_16x16x32_bf16 v[176:179], v[224:227], v[212:215], v[176:179]
    s_waitcnt lgkmcnt(2)
    v_exp_f32 v108, v108
    v_mfma_f32_16x16x32_bf16 v[180:183], v[228:231], v[212:215], v[180:183]
    ds_read_b128 v[212:215], v2 offset:18432
    v_mul_f32 v184, v184, v197
    v_mfma_f32_16x16x32_bf16 v[172:175], v[232:235], v[216:219], v[172:175]
    s_waitcnt lgkmcnt(2)
    v_mul_f32 v185, v185, v197
    v_mul_f32 v186, v186, v197
    v_mfma_f32_16x16x32_bf16 v[176:179], v[236:239], v[216:219], v[176:179]
    v_mul_f32 v187, v187, v197
    v_cvt_pk_bf16_f32 v184, v184, v185
    v_mfma_f32_16x16x32_bf16 v[180:183], v[240:243], v[216:219], v[180:183]
    ds_read_b128 v[216:219], v2 offset:19456
    v_cvt_pk_bf16_f32 v185, v186, v187
    v_mfma_f32_16x16x32_bf16 v[172:175], v[244:247], v[220:223], v[172:175]
    v_exp_f32 v109, v109
    v_mfma_f32_16x16x32_bf16 v[176:179], v[248:251], v[220:223], v[176:179]
    v_exp_f32 v110, v110
    v_mfma_f32_16x16x32_bf16 v[180:183], v[252:255], v[220:223], v[180:183]
    ds_read_b128 v[220:223], v2 offset:20480
    s_mov_b32 exec_lo, 0x10001
    s_mov_b32 exec_hi, 0x10001
    ds_write_b64 v4, v[192:193]
    s_mov_b64 exec, -1
    v_mfma_f32_16x16x32_bf16 v[192:195], v[96:99], v[120:123], 0
    v_cvt_pk_bf16_f32 v172, v172, v173
    v_cvt_pk_bf16_f32 v173, v174, v175
    v_mfma_f32_16x16x32_bf16 v[192:195], v[100:103], v[128:131], v[192:195]
    v_cvt_pk_bf16_f32 v180, v180, v181
    v_cvt_pk_bf16_f32 v174, v176, v177
    v_cvt_pk_bf16_f32 v175, v178, v179
    s_waitcnt lgkmcnt(3)
    v_mfma_f32_16x16x32_bf16 v[176:179], a[220:223], v[212:215], 0
    s_waitcnt lgkmcnt(2)
    v_cvt_pk_bf16_f32 v181, v182, v183
    v_add_u32 v182, v13, v10
    v_mfma_f32_16x16x32_bf16 v[176:179], a[232:235], v[216:219], v[176:179]
    s_waitcnt lgkmcnt(1)
    ds_read_b128 v[120:123], v5 offset:6144
    ds_read_b128 v[128:131], v5 offset:8192
    v_mfma_f32_16x16x32_bf16 v[176:179], a[244:247], v[220:223], v[176:179]
    buffer_store_dwordx4 v[172:175], v13, s[36:39], 0 offen sc1
    v_mul_f32 v192, v192, v197
    v_mul_f32 v193, v193, v197
    v_mfma_f32_16x16x32_bf16 v[172:175], a[216:219], v[212:215], 0
    v_exp_f32 v111, v111
    v_mfma_f32_16x16x32_bf16 v[172:175], a[228:231], v[216:219], v[172:175]
    v_cvt_pk_bf16_f32 v186, v188, v189
    v_cvt_pk_bf16_f32 v187, v190, v191
    v_mfma_f32_16x16x32_bf16 v[172:175], a[240:243], v[220:223], v[172:175]
    buffer_store_dwordx2 v[180:181], v182, s[36:39], 0 offen sc1
    v_mfma_f32_16x16x32_bf16 v[180:183], a[224:227], v[212:215], 0
    ds_read_b128 v[212:215], v2 offset:21504
    v_mul_f32 v194, v194, v197
    v_mfma_f32_16x16x32_bf16 v[180:183], a[236:239], v[216:219], v[180:183]
    ds_read_b128 v[216:219], v2 offset:22528
    v_mul_f32 v195, v195, v197
    v_mfma_f32_16x16x32_bf16 v[180:183], a[248:251], v[220:223], v[180:183]
    ds_read_b128 v[220:223], v2 offset:23552
    v_cvt_pk_bf16_f32 v192, v192, v193
    v_sub_f32 v113, v113, v117
    v_cvt_pk_bf16_f32 v104, v104, v105
    v_cvt_pk_bf16_f32 v193, v194, v195
    v_sub_f32 v114, v114, v117
    v_sub_f32 v115, v115, v117
    v_exp_f32 v112, v112
    v_exp_f32 v113, v113
    v_cvt_pk_bf16_f32 v105, v106, v107
    v_sub_f32 v116, v116, v117
    s_waitcnt lgkmcnt(2)
    v_mfma_f32_16x16x32_bf16 v[172:175], a[252:255], v[212:215], v[172:175]
    v_exp_f32 v114, v114
    v_mfma_f32_16x16x32_bf16 v[176:179], v[224:227], v[212:215], v[176:179]
    s_waitcnt lgkmcnt(1)
    v_exp_f32 v115, v115
    v_mfma_f32_16x16x32_bf16 v[180:183], v[228:231], v[212:215], v[180:183]
    v_cvt_pk_bf16_f32 v106, v108, v109
    v_cvt_pk_bf16_f32 v107, v110, v111
    v_mfma_f32_16x16x32_bf16 v[172:175], v[232:235], v[216:219], v[172:175]
    s_waitcnt lgkmcnt(0)
    v_exp_f32 v116, v116
    v_mfma_f32_16x16x32_bf16 v[196:199], v[20:23], v[104:107], 0
    v_cvt_pk_bf16_f32 v112, v112, v113
    v_cvt_pk_bf16_f32 v113, v114, v115
    v_mfma_f32_16x16x32_bf16 v[188:191], v[88:91], v[104:107], 0
    v_cvt_pk_bf16_f32 v114, v116, 0
    v_mov_b32 v115, 0
    v_mfma_f32_16x16x32_bf16 v[176:179], v[236:239], v[216:219], v[176:179]
    ds_read_b32 v116, v7 offset:9456
    ds_read_b128 v[108:111], v6 offset:64
    v_mfma_f32_16x16x32_bf16 v[196:199], v[20:23], v[112:115], v[196:199]
    v_mul_f32 v161, s43, v161
    v_mul_f32 v162, s43, v162
    v_mfma_f32_16x16x32_bf16 v[188:191], v[92:95], v[112:115], v[188:191]
    v_mul_f32 v163, s43, v163
    v_mul_f32 v164, s43, v164
    v_mfma_f32_16x16x32_bf16 v[180:183], v[240:243], v[216:219], v[180:183]
    v_mul_f32 v165, s43, v165
    v_mul_f32 v166, s43, v166
    v_mfma_f32_16x16x32_bf16 v[172:175], v[244:247], v[220:223], v[172:175]
    v_mul_f32 v167, s43, v167
    v_mul_f32 v168, s43, v168
    v_mfma_f32_16x16x32_bf16 v[176:179], v[248:251], v[220:223], v[176:179]
    s_waitcnt lgkmcnt(1)
    v_mul_f32 v169, s43, v169
    v_mul_f32 v170, s43, v170
    v_mfma_f32_16x16x32_bf16 v[116:119], v[48:51], v[72:75], v[116:119]
    s_waitcnt lgkmcnt(0)
    v_cvt_pk_bf16_f32 v172, v172, v173
    v_cvt_pk_bf16_f32 v173, v174, v175
    v_mfma_f32_16x16x32_bf16 v[108:111], v[32:35], v[72:75], v[108:111]
    v_cvt_pk_bf16_f32 v174, v176, v177
    v_cvt_pk_bf16_f32 v175, v178, v179
    v_mfma_f32_16x16x32_bf16 v[116:119], v[52:55], v[76:79], v[116:119]
    v_mul_f32 v171, s43, v171
    v_cvt_pk_bf16_f32 v56, v160, v161
    v_mfma_f32_16x16x32_bf16 v[108:111], v[36:39], v[76:79], v[108:111]
    v_cvt_pk_bf16_f32 v57, v162, v163
    v_cvt_pk_bf16_f32 v58, v164, v165
    v_mfma_f32_16x16x32_bf16 v[180:183], v[252:255], v[220:223], v[180:183]
    v_cvt_pk_bf16_f32 v59, v166, v167
    v_cvt_pk_bf16_f32 v60, v168, v169
    v_mfma_f32_16x16x32_bf16 v[176:179], v[200:203], a[76:79], 0
    v_cvt_pk_bf16_f32 v61, v170, v171
    v_lshrrev_b32 v7, 4, v19
    v_mfma_f32_16x16x32_bf16 v[120:123], v[24:27], v[56:59], v[120:123]
    v_rcp_f32 v197, v196
    v_mfma_f32_16x16x32_bf16 v[132:135], v[48:51], v[56:59], v[132:135]
    v_cvt_pk_bf16_f32 v180, v180, v181
    v_cvt_pk_bf16_f32 v181, v182, v183
    v_mfma_f32_16x16x32_bf16 v[124:127], v[32:35], v[56:59], v[124:127]
    v_add_u32 v182, v14, v10
    v_mul_f32 v188, v188, v197
    v_mfma_f32_16x16x32_bf16 v[128:131], v[40:43], v[56:59], v[128:131]
    v_mul_f32 v189, v189, v197
    v_mul_f32 v190, v190, v197
    v_mfma_f32_16x16x32_bf16 v[120:123], v[28:31], v[60:63], v[120:123]
    v_mul_f32 v191, v191, v197
    v_cmp_eq_u32 vcc, 2, v7
    v_mfma_f32_16x16x32_bf16 v[132:135], v[52:55], v[60:63], v[132:135]
    v_and_b32 v19, 15, v19
    v_mov_b32 v7, 16
    v_mfma_f32_16x16x32_bf16 v[124:127], v[36:39], v[60:63], v[124:127]
    v_cndmask_b32 v19, v7, v19, vcc
    v_lshlrev_b32 v19, 2, v19
    v_mfma_f32_16x16x32_bf16 v[128:131], v[44:47], v[60:63], v[128:131]
    v_add_u32 v7, s49, v19
    v_mov_b32 v62, v15
    v_mfma_f32_16x16x32_bf16 v[160:163], a[0:3], v[200:203], 0
    v_max3_f32 v133, v120, v121, v122
    v_lshrrev_b32 v19, 4, v2
    v_mfma_f32_16x16x32_bf16 v[164:167], a[4:7], v[200:203], 0
    v_max3_f32 v134, v123, v124, v125
    v_max3_f32 v133, v133, v126, v127
    v_mfma_f32_16x16x32_bf16 v[168:171], a[8:11], v[200:203], 0
    v_max3_f32 v134, v134, v128, v129
    v_max3_f32 v133, v133, v130, v131
    v_mfma_f32_16x16x32_bf16 v[176:179], v[204:207], a[88:91], v[176:179]
    v_max3_f32 v133, v133, v134, v132
    v_mov_b32 v134, v133
    v_mfma_f32_16x16x32_bf16 v[160:163], a[12:15], v[204:207], v[160:163]
    v_subrev_u32 v19, 0x1500, v19
    v_mfma_f32_16x16x32_bf16 v[164:167], a[16:19], v[204:207], v[164:167]
    v_permlane32_swap_b32 v134, v133
    v_mfma_f32_16x16x32_bf16 v[168:171], a[20:23], v[204:207], v[168:171]
    v_max_f32 v133, v133, v134
    v_mov_b32 v134, v133
    v_mfma_f32_16x16x32_bf16 v[176:179], v[208:211], a[100:103], v[176:179]
    ds_write_b128 v3, v[184:187] offset:24576
    v_mfma_f32_16x16x32_bf16 v[184:187], v[80:83], v[104:107], 0
    v_permlane16_swap_b32 v134, v133
    v_mfma_f32_16x16x32_bf16 v[184:187], v[84:87], v[112:115], v[184:187]
    v_max_f32 v133, v133, v134
    v_sub_f32 v120, v120, v133
    v_mfma_f32_16x16x32_bf16 v[160:163], a[24:27], v[208:211], v[160:163]
    v_sub_f32 v121, v121, v133
    v_sub_f32 v122, v122, v133
    v_mfma_f32_16x16x32_bf16 v[164:167], a[28:31], v[208:211], v[164:167]
    v_sub_f32 v123, v123, v133
    v_sub_f32 v124, v124, v133
    v_mfma_f32_16x16x32_bf16 v[168:171], a[32:35], v[208:211], v[168:171]
    ds_write_b64 v4, v[192:193] offset:24576
    v_mfma_f32_16x16x32_bf16 v[192:195], v[96:99], v[104:107], 0
    ds_read_b128 v[104:107], v6
    v_sub_f32 v125, v125, v133
    v_mfma_f32_16x16x32_bf16 v[192:195], v[100:103], v[112:115], v[192:195]
    buffer_store_dwordx4 v[172:175], v14, s[36:39], 0 offen sc1
    ds_read_b128 v[112:115], v6 offset:128
    v_exp_f32 v120, v120
    v_mfma_f32_16x16x32_bf16 v[172:175], v[200:203], a[72:75], 0
    v_exp_f32 v121, v121
    v_mfma_f32_16x16x32_bf16 v[172:175], v[204:207], a[84:87], v[172:175]
    v_sub_f32 v126, v126, v133
    v_sub_f32 v127, v127, v133
    v_mfma_f32_16x16x32_bf16 v[172:175], v[208:211], a[96:99], v[172:175]
    s_waitcnt lgkmcnt(1)
    v_exp_f32 v122, v122
    v_mfma_f32_16x16x32_bf16 v[104:107], v[24:27], v[72:75], v[104:107]
    v_exp_f32 v123, v123
    v_mfma_f32_16x16x32_bf16 v[104:107], v[28:31], v[76:79], v[104:107]
    s_waitcnt lgkmcnt(0)
    v_exp_f32 v124, v124
    v_mfma_f32_16x16x32_bf16 v[112:115], v[40:43], v[72:75], v[112:115]
    v_exp_f32 v125, v125
    v_mfma_f32_16x16x32_bf16 v[112:115], v[44:47], v[76:79], v[112:115]
    buffer_store_dwordx2 v[180:181], v182, s[36:39], 0 offen sc1
    v_mfma_f32_16x16x32_bf16 v[180:183], v[200:203], a[80:83], 0
    ds_read_b128 v[200:203], v1 offset:8192
    v_mul_f32 v184, v184, v197
    v_mfma_f32_16x16x32_bf16 v[180:183], v[204:207], a[92:95], v[180:183]
    ds_read_b128 v[204:207], v0 offset:10240
    v_mul_f32 v185, v185, v197
    v_mfma_f32_16x16x32_bf16 v[180:183], v[208:211], a[104:107], v[180:183]
    ds_read_b128 v[208:211], v1 offset:10240
    v_exp_f32 v126, v126
    v_exp_f32 v127, v127
    v_sub_f32 v128, v128, v133
    v_sub_f32 v129, v129, v133
    v_cvt_pk_bf16_f32 v120, v120, v121
    v_mul_f32 v186, v186, v197
    v_mul_f32 v187, v187, v197
    v_sub_f32 v130, v130, v133
    v_sub_f32 v131, v131, v133
    v_cvt_pk_bf16_f32 v184, v184, v185
    s_waitcnt lgkmcnt(2)
    v_mfma_f32_16x16x32_bf16 v[160:163], a[36:39], v[200:203], v[160:163]
    v_exp_f32 v128, v128
    v_mfma_f32_16x16x32_bf16 v[164:167], a[40:43], v[200:203], v[164:167]
    s_waitcnt lgkmcnt(1)
    v_exp_f32 v129, v129
    v_mfma_f32_16x16x32_bf16 v[168:171], a[44:47], v[200:203], v[168:171]
    v_cvt_pk_bf16_f32 v121, v122, v123
    v_sub_f32 v132, v132, v133
    v_mfma_f32_16x16x32_bf16 v[172:175], v[200:203], a[108:111], v[172:175]
    v_max3_f32 v117, v104, v105, v106
    v_cvt_pk_bf16_f32 v185, v186, v187
    v_mfma_f32_16x16x32_bf16 v[176:179], v[200:203], a[112:115], v[176:179]
    v_exp_f32 v130, v130
    v_mfma_f32_16x16x32_bf16 v[180:183], v[200:203], a[116:119], v[180:183]
    ds_read_b128 v[200:203], v0 offset:12288
    v_cvt_pk_bf16_f32 v122, v124, v125
    v_mfma_f32_16x16x32_bf16 v[160:163], a[48:51], v[204:207], v[160:163]
    s_waitcnt lgkmcnt(1)
    v_exp_f32 v131, v131
    v_mfma_f32_16x16x32_bf16 v[164:167], a[52:55], v[204:207], v[164:167]
    v_cvt_pk_bf16_f32 v123, v126, v127
    v_mul_f32 v192, v192, v197
    v_mfma_f32_16x16x32_bf16 v[168:171], a[56:59], v[204:207], v[168:171]
    v_mul_f32 v193, v193, v197
    v_mul_f32 v194, v194, v197
    v_mfma_f32_16x16x32_bf16 v[172:175], v[204:207], a[120:123], v[172:175]
    v_mul_f32 v195, v195, v197
    v_max3_f32 v118, v107, v108, v109
    v_mfma_f32_16x16x32_bf16 v[196:199], v[20:23], v[120:123], 0
    v_exp_f32 v132, v132
    v_mfma_f32_16x16x32_bf16 v[176:179], v[204:207], a[124:127], v[176:179]
    v_max3_f32 v117, v117, v110, v111
    v_cvt_pk_bf16_f32 v186, v188, v189
    v_mfma_f32_16x16x32_bf16 v[180:183], v[204:207], a[128:131], v[180:183]
    v_cvt_pk_bf16_f32 v187, v190, v191
    v_cvt_pk_bf16_f32 v128, v128, v129
    v_mfma_f32_16x16x32_bf16 v[188:191], v[88:91], v[120:123], 0
    v_cvt_pk_bf16_f32 v192, v192, v193
    v_max3_f32 v118, v118, v112, v113
    v_mfma_f32_16x16x32_bf16 v[160:163], a[60:63], v[208:211], v[160:163]
    v_max3_f32 v117, v117, v114, v115
    v_cvt_pk_bf16_f32 v129, v130, v131
    v_mfma_f32_16x16x32_bf16 v[164:167], a[64:67], v[208:211], v[164:167]
    ds_read_b128 v[204:207], v1 offset:12288
    v_cvt_pk_bf16_f32 v193, v194, v195
    v_mfma_f32_16x16x32_bf16 v[168:171], a[68:71], v[208:211], v[168:171]
    v_max3_f32 v117, v117, v118, v116
    v_cvt_pk_bf16_f32 v130, v132, 0
    v_mfma_f32_16x16x32_bf16 v[172:175], v[208:211], a[132:135], v[172:175]
    v_mov_b32 v131, 0
    v_mov_b32 v118, v117
    v_mfma_f32_16x16x32_bf16 v[176:179], v[208:211], a[136:139], v[176:179]
    v_cvt_pk_bf16_f32 v24, v136, v137
    v_cvt_pk_bf16_f32 v25, v138, v139
    v_mfma_f32_16x16x32_bf16 v[196:199], v[20:23], v[128:131], v[196:199]
    s_waitcnt lgkmcnt(1)
    v_permlane32_swap_b32 v118, v117
    v_mfma_f32_16x16x32_bf16 v[188:191], v[92:95], v[128:131], v[188:191]
    v_max_f32 v117, v117, v118
    v_mov_b32 v118, v117
    v_mfma_f32_16x16x32_bf16 v[180:183], v[208:211], a[140:143], v[180:183]
    ds_read_b128 v[208:211], v0 offset:14336
    v_cvt_pk_bf16_f32 v26, v140, v141
    v_mfma_f32_16x16x32_bf16 v[136:139], a[0:3], v[200:203], 0
    s_waitcnt lgkmcnt(1)
    v_permlane16_swap_b32 v118, v117
    v_mfma_f32_16x16x32_bf16 v[136:139], a[12:15], v[204:207], v[136:139]
    ds_write_b128 v3, v[184:187] offset:30720
    v_mfma_f32_16x16x32_bf16 v[184:187], v[80:83], v[120:123], 0
    v_rcp_f32 v197, v196
    v_mfma_f32_16x16x32_bf16 v[184:187], v[84:87], v[128:131], v[184:187]
    v_max_f32 v117, v117, v118
    v_sub_f32 v104, v104, v117
    s_waitcnt lgkmcnt(1)
    v_mfma_f32_16x16x32_bf16 v[136:139], a[24:27], v[208:211], v[136:139]
    ds_write_b64 v4, v[192:193] offset:30720
    v_mfma_f32_16x16x32_bf16 v[192:195], v[96:99], v[120:123], 0
    v_sub_f32 v105, v105, v117
    v_sub_f32 v106, v106, v117
    v_mfma_f32_16x16x32_bf16 v[192:195], v[100:103], v[128:131], v[192:195]
    v_mul_f32 v184, v184, v197
    v_mul_f32 v185, v185, v197
    v_mul_f32 v186, v186, v197
    v_mul_f32 v187, v187, v197
    v_sub_f32 v107, v107, v117
    v_exp_f32 v104, v104
    v_exp_f32 v105, v105
    v_cvt_pk_bf16_f32 v184, v184, v185
    v_mul_f32 v188, v188, v197
    v_mul_f32 v189, v189, v197
    v_mul_f32 v190, v190, v197
    v_mul_f32 v191, v191, v197
    v_sub_f32 v108, v108, v117
    v_sub_f32 v109, v109, v117
    v_sub_f32 v110, v110, v117
    v_sub_f32 v111, v111, v117
    v_exp_f32 v106, v106
    v_mul_f32 v192, v192, v197
    v_mul_f32 v193, v193, v197
    v_exp_f32 v107, v107
    v_cvt_pk_bf16_f32 v185, v186, v187
    v_mul_f32 v194, v194, v197
    v_mul_f32 v195, v195, v197
    v_exp_f32 v108, v108
    v_exp_f32 v109, v109
    v_exp_f32 v110, v110
    v_exp_f32 v111, v111
    v_cvt_pk_bf16_f32 v192, v192, v193
    v_cvt_pk_bf16_f32 v186, v188, v189
    v_cvt_pk_bf16_f32 v187, v190, v191
    v_cvt_pk_bf16_f32 v104, v104, v105
    v_cvt_pk_bf16_f32 v193, v194, v195
    v_cvt_pk_bf16_f32 v105, v106, v107
    ds_write_b128 v3, v[184:187] offset:36864
    v_cvt_pk_bf16_f32 v106, v108, v109
    v_cvt_pk_bf16_f32 v107, v110, v111
    v_cvt_pk_bf16_f32 v27, v142, v143
    v_mfma_f32_16x16x32_bf16 v[140:143], a[4:7], v[200:203], 0
    v_cvt_pk_bf16_f32 v28, v144, v145
    v_cvt_pk_bf16_f32 v29, v146, v147
    v_mfma_f32_16x16x32_bf16 v[184:187], v[80:83], v[104:107], 0
    v_cvt_pk_bf16_f32 v80, v148, v149
    v_cvt_pk_bf16_f32 v81, v150, v151
    v_mfma_f32_16x16x32_bf16 v[188:191], v[88:91], v[104:107], 0
    v_cvt_pk_bf16_f32 v88, v152, v153
    v_cvt_pk_bf16_f32 v89, v154, v155
    v_mfma_f32_16x16x32_bf16 v[144:147], a[8:11], v[200:203], 0
    v_cvt_pk_bf16_f32 v32, v160, v161
    v_cvt_pk_bf16_f32 v33, v162, v163
    v_mfma_f32_16x16x32_bf16 v[148:151], v[200:203], a[72:75], 0
    v_cvt_pk_bf16_f32 v34, v164, v165
    v_cvt_pk_bf16_f32 v35, v166, v167
    v_mfma_f32_16x16x32_bf16 v[152:155], v[200:203], a[76:79], 0
    v_cvt_pk_bf16_f32 v36, v168, v169
    v_cvt_pk_bf16_f32 v37, v170, v171
    v_mfma_f32_16x16x32_bf16 v[140:143], a[16:19], v[204:207], v[140:143]
    v_cvt_pk_bf16_f32 v82, v172, v173
    v_cvt_pk_bf16_f32 v83, v174, v175
    v_mfma_f32_16x16x32_bf16 v[144:147], a[20:23], v[204:207], v[144:147]
    v_cvt_pk_bf16_f32 v90, v176, v177
    v_cvt_pk_bf16_f32 v91, v178, v179
    v_mfma_f32_16x16x32_bf16 v[148:151], v[204:207], a[84:87], v[148:151]
    ds_read_b32 v132, v7 offset:9216
    ds_read_b128 v[120:123], v5
    v_mfma_f32_16x16x32_bf16 v[152:155], v[204:207], a[88:91], v[152:155]
    ds_read_b128 v[124:127], v5 offset:1024
    ds_read_b128 v[128:131], v5 offset:2048
    v_mfma_f32_16x16x32_bf16 v[140:143], a[28:31], v[208:211], v[140:143]
    v_sub_f32 v112, v112, v117
    v_sub_f32 v113, v113, v117
    v_mfma_f32_16x16x32_bf16 v[144:147], a[32:35], v[208:211], v[144:147]
    v_sub_f32 v114, v114, v117
    v_sub_f32 v115, v115, v117
    v_mfma_f32_16x16x32_bf16 v[148:151], v[208:211], a[96:99], v[148:151]
    v_exp_f32 v112, v112
    v_mfma_f32_16x16x32_bf16 v[152:155], v[208:211], a[100:103], v[152:155]
    v_exp_f32 v113, v113
    v_mfma_f32_16x16x32_bf16 v[196:199], v[20:23], v[104:107], 0
    ds_write_b64 v4, v[192:193] offset:36864
    v_mfma_f32_16x16x32_bf16 v[192:195], v[96:99], v[104:107], 0
    v_cvt_pk_bf16_f32 v96, v156, v157
    v_cvt_pk_bf16_f32 v97, v158, v159
    v_mfma_f32_16x16x32_bf16 v[156:159], v[200:203], a[80:83], 0
    ds_read_b128 v[200:203], v1 offset:14336
    v_cvt_pk_bf16_f32 v98, v180, v181
    v_mfma_f32_16x16x32_bf16 v[156:159], v[204:207], a[92:95], v[156:159]
    ds_read_b128 v[204:207], v0 offset:16384
    v_cvt_pk_bf16_f32 v99, v182, v183
    v_mfma_f32_16x16x32_bf16 v[156:159], v[208:211], a[104:107], v[156:159]
    ds_read_b128 v[208:211], v1 offset:16384
    s_waitcnt lgkmcnt(3)
    s_barrier
    s_waitcnt lgkmcnt(2)
    v_mfma_f32_16x16x32_bf16 v[136:139], a[36:39], v[200:203], v[136:139]
    ds_read_b128 v[212:215], v2 offset:24576
    ds_read_b128 v[216:219], v2 offset:25600
    v_mfma_f32_16x16x32_bf16 v[140:143], a[40:43], v[200:203], v[140:143]
    s_waitcnt lgkmcnt(3)
    ds_read_b128 v[220:223], v2 offset:26624
    v_sub_f32 v116, v116, v117
    v_mfma_f32_16x16x32_bf16 v[144:147], a[44:47], v[200:203], v[144:147]
    v_exp_f32 v114, v114
    v_mfma_f32_16x16x32_bf16 v[148:151], v[200:203], a[108:111], v[148:151]
    v_exp_f32 v115, v115
    v_mfma_f32_16x16x32_bf16 v[152:155], v[200:203], a[112:115], v[152:155]
    v_exp_f32 v116, v116
    v_mfma_f32_16x16x32_bf16 v[156:159], v[200:203], a[116:119], v[156:159]
    ds_read_b128 v[200:203], v0
    v_cvt_pk_bf16_f32 v112, v112, v113
    v_mfma_f32_16x16x32_bf16 v[136:139], a[48:51], v[204:207], v[136:139]
    s_waitcnt lgkmcnt(3)
    v_cvt_pk_bf16_f32 v113, v114, v115
    v_cvt_pk_bf16_f32 v114, v116, 0
    v_mfma_f32_16x16x32_bf16 v[140:143], a[52:55], v[204:207], v[140:143]
    v_mov_b32 v115, 0
    v_mfma_f32_16x16x32_bf16 v[144:147], a[56:59], v[204:207], v[144:147]
    ds_read_b128 v[104:107], v5 offset:3072
    ds_read_b32 v116, v7 offset:9296
    v_mfma_f32_16x16x32_bf16 v[148:151], v[204:207], a[120:123], v[148:151]
    ds_read_b128 v[108:111], v5 offset:4096
    v_mfma_f32_16x16x32_bf16 v[152:155], v[204:207], a[124:127], v[152:155]
    v_mfma_f32_16x16x32_bf16 v[156:159], v[204:207], a[128:131], v[156:159]
    s_waitcnt lgkmcnt(3)
    ds_read_b128 v[204:207], v1
    v_mfma_f32_16x16x32_bf16 v[136:139], a[60:63], v[208:211], v[136:139]
    v_mfma_f32_16x16x32_bf16 v[140:143], a[64:67], v[208:211], v[140:143]
    v_mfma_f32_16x16x32_bf16 v[144:147], a[68:71], v[208:211], v[144:147]
    v_mfma_f32_16x16x32_bf16 v[148:151], v[208:211], a[132:135], v[148:151]
    v_mfma_f32_16x16x32_bf16 v[152:155], v[208:211], a[136:139], v[152:155]
    v_mfma_f32_16x16x32_bf16 v[156:159], v[208:211], a[140:143], v[156:159]
    ds_read_b128 v[208:211], v0 offset:2048
    v_mfma_f32_16x16x32_bf16 v[160:163], a[144:147], v[200:203], 0
    s_waitcnt lgkmcnt(1)
    v_cvt_pk_bf16_f32 v40, v136, v137
    v_cvt_pk_bf16_f32 v41, v138, v139
    v_mfma_f32_16x16x32_bf16 v[164:167], a[148:151], v[200:203], 0
    v_cvt_pk_bf16_f32 v42, v140, v141
    v_cvt_pk_bf16_f32 v43, v142, v143
    v_mfma_f32_16x16x32_bf16 v[168:171], a[152:155], v[200:203], 0
    ds_read_b128 v[200:203], v1 offset:2048
    v_cvt_pk_bf16_f32 v44, v144, v145
    v_mfma_f32_16x16x32_bf16 v[160:163], a[156:159], v[204:207], v[160:163]
    v_cvt_pk_bf16_f32 v45, v146, v147
    v_mfma_f32_16x16x32_bf16 v[164:167], a[160:163], v[204:207], v[164:167]
    v_mfma_f32_16x16x32_bf16 v[168:171], a[164:167], v[204:207], v[168:171]
    s_waitcnt lgkmcnt(1)
    ds_read_b128 v[204:207], v0 offset:4096
    v_mfma_f32_16x16x32_bf16 v[160:163], a[168:171], v[208:211], v[160:163]
    v_mfma_f32_16x16x32_bf16 v[164:167], a[172:175], v[208:211], v[164:167]
    v_mfma_f32_16x16x32_bf16 v[168:171], a[176:179], v[208:211], v[168:171]
    s_waitcnt lgkmcnt(1)
    ds_read_b128 v[208:211], v1 offset:4096
    v_mfma_f32_16x16x32_bf16 v[160:163], a[180:183], v[200:203], v[160:163]
    v_mfma_f32_16x16x32_bf16 v[164:167], a[184:187], v[200:203], v[164:167]
    v_mfma_f32_16x16x32_bf16 v[168:171], a[188:191], v[200:203], v[168:171]
    s_waitcnt lgkmcnt(1)
    ds_read_b128 v[200:203], v0 offset:6144
    v_mfma_f32_16x16x32_bf16 v[160:163], a[192:195], v[204:207], v[160:163]
    v_mfma_f32_16x16x32_bf16 v[164:167], a[196:199], v[204:207], v[164:167]
    v_mfma_f32_16x16x32_bf16 v[168:171], a[200:203], v[204:207], v[168:171]
    s_waitcnt lgkmcnt(1)
    ds_read_b128 v[204:207], v1 offset:6144
    v_mfma_f32_16x16x32_bf16 v[160:163], a[204:207], v[208:211], v[160:163]
    v_mfma_f32_16x16x32_bf16 v[164:167], a[208:211], v[208:211], v[164:167]
    v_mfma_f32_16x16x32_bf16 v[168:171], a[212:215], v[208:211], v[168:171]
    ds_read_b128 v[208:211], v0 offset:8192
    v_mfma_f32_16x16x32_bf16 v[172:175], a[216:219], v[212:215], 0
    v_mfma_f32_16x16x32_bf16 v[176:179], a[220:223], v[212:215], 0
    v_mfma_f32_16x16x32_bf16 v[180:183], a[224:227], v[212:215], 0
    ds_read_b128 v[212:215], v2 offset:27648
    v_mfma_f32_16x16x32_bf16 v[172:175], a[228:231], v[216:219], v[172:175]
    v_mul_f32 v160, s43, v160
    v_mul_f32 v161, s43, v161
    v_mfma_f32_16x16x32_bf16 v[176:179], a[232:235], v[216:219], v[176:179]
    v_mul_f32 v162, s43, v162
    v_mul_f32 v163, s43, v163
    v_mfma_f32_16x16x32_bf16 v[180:183], a[236:239], v[216:219], v[180:183]
    v_mul_f32 v164, s43, v164
    v_mul_f32 v165, s43, v165
    v_mfma_f32_16x16x32_bf16 v[172:175], a[240:243], v[220:223], v[172:175]
    v_mul_f32 v166, s43, v166
    v_mul_f32 v167, s43, v167
    v_mfma_f32_16x16x32_bf16 v[176:179], a[244:247], v[220:223], v[176:179]
    v_mul_f32 v168, s43, v168
    v_mul_f32 v169, s43, v169
    v_mfma_f32_16x16x32_bf16 v[180:183], a[248:251], v[220:223], v[180:183]
    s_waitcnt lgkmcnt(0)
    v_mul_f32 v170, s43, v170
    v_mul_f32 v171, s43, v171
    v_mfma_f32_16x16x32_bf16 v[172:175], a[252:255], v[212:215], v[172:175]
    v_cvt_pk_bf16_f32 v56, v160, v161
    v_cvt_pk_bf16_f32 v57, v162, v163
    v_mfma_f32_16x16x32_bf16 v[160:163], a[144:147], v[200:203], 0
    v_cvt_pk_bf16_f32 v58, v164, v165
    v_cvt_pk_bf16_f32 v59, v166, v167
    v_mfma_f32_16x16x32_bf16 v[164:167], a[148:151], v[200:203], 0
    v_cvt_pk_bf16_f32 v60, v168, v169
    v_cvt_pk_bf16_f32 v61, v170, v171
    v_mfma_f32_16x16x32_bf16 v[168:171], a[152:155], v[200:203], 0
    ds_read_b128 v[200:203], v1 offset:8192
    ds_read_b128 v[216:219], v2 offset:28672
    v_mfma_f32_16x16x32_bf16 v[160:163], a[156:159], v[204:207], v[160:163]
    ds_read_b128 v[220:223], v2 offset:29696
    v_mfma_f32_16x16x32_bf16 v[164:167], a[160:163], v[204:207], v[164:167]
    v_mfma_f32_16x16x32_bf16 v[168:171], a[164:167], v[204:207], v[168:171]
    ds_read_b128 v[204:207], v0 offset:10240
    v_mfma_f32_16x16x32_bf16 v[160:163], a[168:171], v[208:211], v[160:163]
    v_mfma_f32_16x16x32_bf16 v[164:167], a[172:175], v[208:211], v[164:167]
    v_mfma_f32_16x16x32_bf16 v[168:171], a[176:179], v[208:211], v[168:171]
    s_waitcnt lgkmcnt(3)
    ds_read_b128 v[208:211], v1 offset:10240
    v_mfma_f32_16x16x32_bf16 v[160:163], a[180:183], v[200:203], v[160:163]
    s_waitcnt lgkmcnt(3)
    v_mfma_f32_16x16x32_bf16 v[164:167], a[184:187], v[200:203], v[164:167]
    v_mfma_f32_16x16x32_bf16 v[168:171], a[188:191], v[200:203], v[168:171]
    s_waitcnt lgkmcnt(1)
    ds_read_b128 v[200:203], v0 offset:12288
    v_mfma_f32_16x16x32_bf16 v[160:163], a[192:195], v[204:207], v[160:163]
    v_mfma_f32_16x16x32_bf16 v[164:167], a[196:199], v[204:207], v[164:167]
    v_mfma_f32_16x16x32_bf16 v[168:171], a[200:203], v[204:207], v[168:171]
    s_waitcnt lgkmcnt(1)
    ds_read_b128 v[204:207], v1 offset:12288
    v_mfma_f32_16x16x32_bf16 v[160:163], a[204:207], v[208:211], v[160:163]
    v_mfma_f32_16x16x32_bf16 v[164:167], a[208:211], v[208:211], v[164:167]
    v_mfma_f32_16x16x32_bf16 v[168:171], a[212:215], v[208:211], v[168:171]
    ds_read_b128 v[208:211], v0 offset:14336
    v_mfma_f32_16x16x32_bf16 v[176:179], v[224:227], v[212:215], v[176:179]
    v_mfma_f32_16x16x32_bf16 v[180:183], v[228:231], v[212:215], v[180:183]
    ds_read_b128 v[212:215], v2 offset:30720
    v_mfma_f32_16x16x32_bf16 v[172:175], v[232:235], v[216:219], v[172:175]
    v_mfma_f32_16x16x32_bf16 v[176:179], v[236:239], v[216:219], v[176:179]
    v_mul_f32 v160, s43, v160
    v_mul_f32 v161, s43, v161
    v_mfma_f32_16x16x32_bf16 v[180:183], v[240:243], v[216:219], v[180:183]
    ds_read_b128 v[216:219], v2 offset:31744
    v_mul_f32 v162, s43, v162
    v_mfma_f32_16x16x32_bf16 v[172:175], v[244:247], v[220:223], v[172:175]
    v_mul_f32 v163, s43, v163
    v_mul_f32 v164, s43, v164
    v_mfma_f32_16x16x32_bf16 v[176:179], v[248:251], v[220:223], v[176:179]
    v_mul_f32 v165, s43, v165
    v_mul_f32 v166, s43, v166
    v_mfma_f32_16x16x32_bf16 v[180:183], v[252:255], v[220:223], v[180:183]
    ds_read_b128 v[220:223], v2 offset:32768
    v_mul_f32 v167, s43, v167
    v_mfma_f32_16x16x32_bf16 v[120:123], v[24:27], v[56:59], v[120:123]
    v_mul_f32 v168, s43, v168
    v_mul_f32 v169, s43, v169
    v_mfma_f32_16x16x32_bf16 v[132:135], v[48:51], v[56:59], v[132:135]
    v_mul_f32 v170, s43, v170
    v_mul_f32 v171, s43, v171
    v_mfma_f32_16x16x32_bf16 v[124:127], v[32:35], v[56:59], v[124:127]
    v_cvt_pk_bf16_f32 v64, v160, v161
    v_cvt_pk_bf16_f32 v65, v162, v163
    v_mfma_f32_16x16x32_bf16 v[128:131], v[40:43], v[56:59], v[128:131]
    s_waitcnt lgkmcnt(1)
    v_cvt_pk_bf16_f32 v66, v164, v165
    v_cvt_pk_bf16_f32 v67, v166, v167
    v_mfma_f32_16x16x32_bf16 v[120:123], v[28:31], v[60:63], v[120:123]
    v_cvt_pk_bf16_f32 v68, v168, v169
    v_cvt_pk_bf16_f32 v69, v170, v171
    v_mfma_f32_16x16x32_bf16 v[132:135], v[52:55], v[60:63], v[132:135]
    v_cvt_pk_bf16_f32 v172, v172, v173
    v_cvt_pk_bf16_f32 v173, v174, v175
    v_mfma_f32_16x16x32_bf16 v[160:163], a[144:147], v[200:203], 0
    v_cvt_pk_bf16_f32 v180, v180, v181
    v_cvt_pk_bf16_f32 v174, v176, v177
    v_mfma_f32_16x16x32_bf16 v[164:167], a[148:151], v[200:203], 0
    v_cvt_pk_bf16_f32 v175, v178, v179
    v_cvt_pk_bf16_f32 v181, v182, v183
    v_mfma_f32_16x16x32_bf16 v[168:171], a[152:155], v[200:203], 0
    ds_read_b128 v[200:203], v1 offset:14336
    v_add_u32 v182, v12, v10
    v_mfma_f32_16x16x32_bf16 v[124:127], v[36:39], v[60:63], v[124:127]
    v_max3_f32 v133, v120, v121, v122
    v_mfma_f32_16x16x32_bf16 v[128:131], v[44:47], v[60:63], v[128:131]
    v_mov_b32 v62, v16
    v_mfma_f32_16x16x32_bf16 v[160:163], a[156:159], v[204:207], v[160:163]
    buffer_store_dwordx4 v[172:175], v12, s[36:39], s53 offen sc1
    v_mfma_f32_16x16x32_bf16 v[164:167], a[160:163], v[204:207], v[164:167]
    v_mfma_f32_16x16x32_bf16 v[168:171], a[164:167], v[204:207], v[168:171]
    ds_read_b128 v[204:207], v0 offset:16384
    v_max3_f32 v134, v123, v124, v125
    v_mfma_f32_16x16x32_bf16 v[160:163], a[168:171], v[208:211], v[160:163]
    s_waitcnt lgkmcnt(1)
    v_max3_f32 v133, v133, v126, v127
    v_max3_f32 v134, v134, v128, v129
    v_mfma_f32_16x16x32_bf16 v[164:167], a[172:175], v[208:211], v[164:167]
    v_max3_f32 v133, v133, v130, v131
    v_max3_f32 v133, v133, v134, v132
    v_mfma_f32_16x16x32_bf16 v[168:171], a[176:179], v[208:211], v[168:171]
    ds_read_b128 v[208:211], v1 offset:16384
    v_mov_b32 v134, v133
    v_mfma_f32_16x16x32_bf16 v[196:199], v[20:23], v[112:115], v[196:199]
    buffer_store_dwordx2 v[180:181], v182, s[36:39], s53 offen sc1
    v_mfma_f32_16x16x32_bf16 v[184:187], v[84:87], v[112:115], v[184:187]
    v_cvt_pk_bf16_f32 v84, v148, v149
    v_cvt_pk_bf16_f32 v85, v150, v151
    v_mfma_f32_16x16x32_bf16 v[188:191], v[92:95], v[112:115], v[188:191]
    v_cvt_pk_bf16_f32 v92, v152, v153
    v_cvt_pk_bf16_f32 v93, v154, v155
    v_mfma_f32_16x16x32_bf16 v[192:195], v[100:103], v[112:115], v[192:195]
    ds_read_b128 v[112:115], v5 offset:5120
    v_cvt_pk_bf16_f32 v100, v156, v157
    v_mfma_f32_16x16x32_bf16 v[176:179], a[220:223], v[212:215], 0
    s_waitcnt lgkmcnt(1)
    s_waitcnt vmcnt(7)
    s_barrier
    v_mfma_f32_16x16x32_bf16 v[172:175], a[216:219], v[212:215], 0
    v_cvt_pk_bf16_f32 v101, v158, v159
    v_mfma_f32_16x16x32_bf16 v[180:183], a[224:227], v[212:215], 0
    ds_read_b128 v[212:215], v2 offset:33792
    v_mfma_f32_16x16x32_bf16 v[176:179], a[232:235], v[216:219], v[176:179]
    s_waitcnt lgkmcnt(1)
    v_permlane32_swap_b32 v134, v133
    v_mfma_f32_16x16x32_bf16 v[172:175], a[228:231], v[216:219], v[172:175]
    v_max_f32 v133, v133, v134
    v_mov_b32 v134, v133
    v_mfma_f32_16x16x32_bf16 v[180:183], a[236:239], v[216:219], v[180:183]
    ds_read_b128 v[216:219], v2 offset:34816
    v_mfma_f32_16x16x32_bf16 v[176:179], a[244:247], v[220:223], v[176:179]
    v_permlane16_swap_b32 v134, v133
    v_mfma_f32_16x16x32_bf16 v[172:175], a[240:243], v[220:223], v[172:175]
    v_rcp_f32 v197, v196
    v_mfma_f32_16x16x32_bf16 v[180:183], a[248:251], v[220:223], v[180:183]
    s_waitcnt lgkmcnt(1)
    ds_read_b128 v[220:223], v2 offset:35840
    v_max_f32 v133, v133, v134
    v_mfma_f32_16x16x32_bf16 v[104:107], v[24:27], v[64:67], v[104:107]
    v_mul_f32 v184, v184, v197
    v_mul_f32 v185, v185, v197
    v_mfma_f32_16x16x32_bf16 v[116:119], v[48:51], v[64:67], v[116:119]
    v_sub_f32 v120, v120, v133
    v_sub_f32 v121, v121, v133
    v_mfma_f32_16x16x32_bf16 v[108:111], v[32:35], v[64:67], v[108:111]
    v_mul_f32 v186, v186, v197
    v_mul_f32 v187, v187, v197
    v_mfma_f32_16x16x32_bf16 v[112:115], v[40:43], v[64:67], v[112:115]
    v_sub_f32 v122, v122, v133
    v_sub_f32 v123, v123, v133
    v_mfma_f32_16x16x32_bf16 v[104:107], v[28:31], v[68:71], v[104:107]
    v_cvt_pk_bf16_f32 v184, v184, v185
    v_mul_f32 v188, v188, v197
    v_mfma_f32_16x16x32_bf16 v[116:119], v[52:55], v[68:71], v[116:119]
    v_exp_f32 v120, v120
    v_mfma_f32_16x16x32_bf16 v[108:111], v[36:39], v[68:71], v[108:111]
    v_exp_f32 v121, v121
    v_mfma_f32_16x16x32_bf16 v[112:115], v[44:47], v[68:71], v[112:115]
    v_mul_f32 v189, v189, v197
    v_mul_f32 v190, v190, v197
    v_mfma_f32_16x16x32_bf16 v[160:163], a[180:183], v[200:203], v[160:163]
    v_mul_f32 v191, v191, v197
    v_mul_f32 v192, v192, v197
    v_mfma_f32_16x16x32_bf16 v[164:167], a[184:187], v[200:203], v[164:167]
    v_mul_f32 v193, v193, v197
    v_sub_f32 v124, v124, v133
    v_mfma_f32_16x16x32_bf16 v[168:171], a[188:191], v[200:203], v[168:171]
    ds_read_b128 v[200:203], v0 offset:18432
    v_sub_f32 v125, v125, v133
    v_mfma_f32_16x16x32_bf16 v[160:163], a[192:195], v[204:207], v[160:163]
    v_sub_f32 v126, v126, v133
    v_sub_f32 v127, v127, v133
    v_mfma_f32_16x16x32_bf16 v[164:167], a[196:199], v[204:207], v[164:167]
    v_exp_f32 v122, v122
    v_mfma_f32_16x16x32_bf16 v[168:171], a[200:203], v[204:207], v[168:171]
    ds_read_b128 v[204:207], v1 offset:18432
    v_cvt_pk_bf16_f32 v185, v186, v187
    v_mfma_f32_16x16x32_bf16 v[160:163], a[204:207], v[208:211], v[160:163]
    v_exp_f32 v123, v123
    v_mfma_f32_16x16x32_bf16 v[164:167], a[208:211], v[208:211], v[164:167]
    v_mul_f32 v194, v194, v197
    v_mul_f32 v195, v195, v197
    v_mfma_f32_16x16x32_bf16 v[168:171], a[212:215], v[208:211], v[168:171]
    s_waitcnt lgkmcnt(1)
    ds_read_b128 v[208:211], v0 offset:20480
    v_cvt_pk_bf16_f32 v192, v192, v193
    v_mfma_f32_16x16x32_bf16 v[176:179], v[224:227], v[212:215], v[176:179]
    v_exp_f32 v124, v124
    v_mfma_f32_16x16x32_bf16 v[172:175], a[252:255], v[212:215], v[172:175]
    v_exp_f32 v125, v125
    v_mfma_f32_16x16x32_bf16 v[180:183], v[228:231], v[212:215], v[180:183]
    ds_read_b128 v[212:215], v2 offset:36864
    v_cvt_pk_bf16_f32 v186, v188, v189
    v_mfma_f32_16x16x32_bf16 v[176:179], v[236:239], v[216:219], v[176:179]
    v_exp_f32 v126, v126
    v_mfma_f32_16x16x32_bf16 v[172:175], v[232:235], v[216:219], v[172:175]
    v_exp_f32 v127, v127
    v_mfma_f32_16x16x32_bf16 v[180:183], v[240:243], v[216:219], v[180:183]
    ds_read_b128 v[216:219], v2 offset:37888
    v_cvt_pk_bf16_f32 v187, v190, v191
    v_mfma_f32_16x16x32_bf16 v[176:179], v[248:251], v[220:223], v[176:179]
    v_sub_f32 v128, v128, v133
    v_sub_f32 v129, v129, v133
    v_mfma_f32_16x16x32_bf16 v[172:175], v[244:247], v[220:223], v[172:175]
    v_cvt_pk_bf16_f32 v120, v120, v121
    v_cvt_pk_bf16_f32 v193, v194, v195
    v_mfma_f32_16x16x32_bf16 v[180:183], v[252:255], v[220:223], v[180:183]
    ds_read_b128 v[220:223], v2 offset:38912
    v_sub_f32 v130, v130, v133
    v_mfma_f32_16x16x32_bf16 v[136:139], a[0:3], v[200:203], 0
    s_waitcnt lgkmcnt(2)
    v_sub_f32 v131, v131, v133
    v_cvt_pk_bf16_f32 v172, v172, v173
    v_mfma_f32_16x16x32_bf16 v[140:143], a[4:7], v[200:203], 0
    v_cvt_pk_bf16_f32 v173, v174, v175
    v_cvt_pk_bf16_f32 v180, v180, v181
    v_mfma_f32_16x16x32_bf16 v[144:147], a[8:11], v[200:203], 0
    v_cvt_pk_bf16_f32 v174, v176, v177
    v_cvt_pk_bf16_f32 v175, v178, v179
    v_mfma_f32_16x16x32_bf16 v[148:151], v[200:203], a[72:75], 0
    v_cvt_pk_bf16_f32 v181, v182, v183
    v_add_u32 v182, v13, v10
    v_mfma_f32_16x16x32_bf16 v[152:155], v[200:203], a[76:79], 0
    v_exp_f32 v128, v128
    v_mfma_f32_16x16x32_bf16 v[156:159], v[200:203], a[80:83], 0
    ds_read_b128 v[200:203], v1 offset:20480
    v_cvt_pk_bf16_f32 v121, v122, v123
    v_mfma_f32_16x16x32_bf16 v[136:139], a[12:15], v[204:207], v[136:139]
    v_exp_f32 v129, v129
    v_mfma_f32_16x16x32_bf16 v[140:143], a[16:19], v[204:207], v[140:143]
    v_sub_f32 v132, v132, v133
    v_max3_f32 v117, v104, v105, v106
    v_mfma_f32_16x16x32_bf16 v[144:147], a[20:23], v[204:207], v[144:147]
    v_exp_f32 v130, v130
    v_mfma_f32_16x16x32_bf16 v[148:151], v[204:207], a[84:87], v[148:151]
    v_exp_f32 v131, v131
    v_mfma_f32_16x16x32_bf16 v[152:155], v[204:207], a[88:91], v[152:155]
    v_cvt_pk_bf16_f32 v122, v124, v125
    v_cvt_pk_bf16_f32 v123, v126, v127
    v_mfma_f32_16x16x32_bf16 v[156:159], v[204:207], a[92:95], v[156:159]
    ds_read_b128 v[204:207], v0 offset:22528
    v_max3_f32 v118, v107, v108, v109
    v_mfma_f32_16x16x32_bf16 v[196:199], v[20:23], v[120:123], 0
    v_exp_f32 v132, v132
    v_mfma_f32_16x16x32_bf16 v[188:191], v[88:91], v[120:123], 0
    v_max3_f32 v117, v117, v110, v111
    v_cvt_pk_bf16_f32 v128, v128, v129
    v_mfma_f32_16x16x32_bf16 v[136:139], a[24:27], v[208:211], v[136:139]
    s_waitcnt lgkmcnt(1)
    v_max3_f32 v118, v118, v112, v113
    v_max3_f32 v117, v117, v114, v115
    v_mfma_f32_16x16x32_bf16 v[140:143], a[28:31], v[208:211], v[140:143]
    v_cvt_pk_bf16_f32 v129, v130, v131
    v_max3_f32 v117, v117, v118, v116
    v_mfma_f32_16x16x32_bf16 v[144:147], a[32:35], v[208:211], v[144:147]
    v_cvt_pk_bf16_f32 v130, v132, 0
    v_mov_b32 v131, 0
    v_mfma_f32_16x16x32_bf16 v[148:151], v[208:211], a[96:99], v[148:151]
    v_mov_b32 v118, v117
    v_mul_f32 v160, s43, v160
    v_mfma_f32_16x16x32_bf16 v[196:199], v[20:23], v[128:131], v[196:199]
    v_permlane32_swap_b32 v118, v117
    v_mfma_f32_16x16x32_bf16 v[188:191], v[92:95], v[128:131], v[188:191]
    ds_read_b32 v132, v7 offset:9376
    ds_read_b128 v[124:127], v5 offset:7168
    v_mfma_f32_16x16x32_bf16 v[152:155], v[208:211], a[100:103], v[152:155]
    v_max_f32 v117, v117, v118
    v_mov_b32 v118, v117
    v_mfma_f32_16x16x32_bf16 v[156:159], v[208:211], a[104:107], v[156:159]
    ds_read_b128 v[208:211], v1 offset:22528
    v_mul_f32 v161, s43, v161
    v_mfma_f32_16x16x32_bf16 v[176:179], a[220:223], v[212:215], 0
    v_permlane16_swap_b32 v118, v117
    v_mfma_f32_16x16x32_bf16 v[176:179], a[232:235], v[216:219], v[176:179]
    v_rcp_f32 v197, v196
    v_mfma_f32_16x16x32_bf16 v[176:179], a[244:247], v[220:223], v[176:179]
    v_max_f32 v117, v117, v118
    v_sub_f32 v104, v104, v117
    v_mfma_f32_16x16x32_bf16 v[136:139], a[36:39], v[200:203], v[136:139]
    s_waitcnt lgkmcnt(1)
    v_sub_f32 v105, v105, v117
    v_sub_f32 v106, v106, v117
    v_mfma_f32_16x16x32_bf16 v[140:143], a[40:43], v[200:203], v[140:143]
    v_sub_f32 v107, v107, v117
    v_mul_f32 v188, v188, v197
    v_mfma_f32_16x16x32_bf16 v[144:147], a[44:47], v[200:203], v[144:147]
    v_exp_f32 v104, v104
    v_mfma_f32_16x16x32_bf16 v[148:151], v[200:203], a[108:111], v[148:151]
    v_exp_f32 v105, v105
    v_mfma_f32_16x16x32_bf16 v[152:155], v[200:203], a[112:115], v[152:155]
    v_mul_f32 v189, v189, v197
    v_mul_f32 v190, v190, v197
    v_mfma_f32_16x16x32_bf16 v[156:159], v[200:203], a[116:119], v[156:159]
    ds_read_b128 v[200:203], v0 offset:24576
    v_mul_f32 v191, v191, v197
    v_mfma_f32_16x16x32_bf16 v[136:139], a[48:51], v[204:207], v[136:139]
    s_waitcnt lgkmcnt(1)
    v_sub_f32 v108, v108, v117
    v_sub_f32 v109, v109, v117
    v_mfma_f32_16x16x32_bf16 v[140:143], a[52:55], v[204:207], v[140:143]
    v_sub_f32 v110, v110, v117
    v_sub_f32 v111, v111, v117
    v_mfma_f32_16x16x32_bf16 v[144:147], a[56:59], v[204:207], v[144:147]
    v_exp_f32 v106, v106
    v_mfma_f32_16x16x32_bf16 v[148:151], v[204:207], a[120:123], v[148:151]
    v_exp_f32 v107, v107
    v_mfma_f32_16x16x32_bf16 v[152:155], v[204:207], a[124:127], v[152:155]
    v_exp_f32 v108, v108
    v_mfma_f32_16x16x32_bf16 v[156:159], v[204:207], a[128:131], v[156:159]
    ds_read_b128 v[204:207], v1 offset:24576
    v_sub_f32 v112, v112, v117
    v_mfma_f32_16x16x32_bf16 v[136:139], a[60:63], v[208:211], v[136:139]
    v_exp_f32 v109, v109
    v_mfma_f32_16x16x32_bf16 v[140:143], a[64:67], v[208:211], v[140:143]
    v_exp_f32 v110, v110
    v_mfma_f32_16x16x32_bf16 v[144:147], a[68:71], v[208:211], v[144:147]
    v_exp_f32 v111, v111
    v_mfma_f32_16x16x32_bf16 v[148:151], v[208:211], a[132:135], v[148:151]
    v_sub_f32 v113, v113, v117
    v_cvt_pk_bf16_f32 v104, v104, v105
    v_mfma_f32_16x16x32_bf16 v[152:155], v[208:211], a[136:139], v[152:155]
    v_sub_f32 v114, v114, v117
    v_sub_f32 v115, v115, v117
    v_mfma_f32_16x16x32_bf16 v[156:159], v[208:211], a[140:143], v[156:159]
    buffer_store_dwordx4 v[172:175], v13, s[36:39], s53 offen sc1
    s_mov_b32 exec_lo, 0x100010
    s_mov_b32 exec_hi, 0x100010
    ds_write_b128 v3, v[184:187]
    s_mov_b64 exec, -1
    v_mfma_f32_16x16x32_bf16 v[184:187], v[80:83], v[120:123], 0
    ds_read_b128 v[208:211], v0 offset:26624
    v_cvt_pk_bf16_f32 v105, v106, v107
    v_mfma_f32_16x16x32_bf16 v[184:187], v[84:87], v[128:131], v[184:187]
    v_exp_f32 v112, v112
    v_mfma_f32_16x16x32_bf16 v[172:175], a[216:219], v[212:215], 0
    v_exp_f32 v113, v113
    v_mfma_f32_16x16x32_bf16 v[172:175], a[228:231], v[216:219], v[172:175]
    v_sub_f32 v116, v116, v117
    v_cvt_pk_bf16_f32 v106, v108, v109
    v_mfma_f32_16x16x32_bf16 v[172:175], a[240:243], v[220:223], v[172:175]
    buffer_store_dwordx2 v[180:181], v182, s[36:39], s53 offen sc1
    v_mfma_f32_16x16x32_bf16 v[180:183], a[224:227], v[212:215], 0
    ds_read_b128 v[212:215], v2 offset:39936
    v_mul_f32 v184, v184, v197
    v_mfma_f32_16x16x32_bf16 v[180:183], a[236:239], v[216:219], v[180:183]
    ds_read_b128 v[216:219], v2 offset:40960
    v_mul_f32 v185, v185, v197
    v_mfma_f32_16x16x32_bf16 v[180:183], a[248:251], v[220:223], v[180:183]
    ds_read_b128 v[220:223], v2 offset:41984
    s_mov_b32 exec_lo, 0x100010
    s_mov_b32 exec_hi, 0x100010
    ds_write_b64 v4, v[192:193]
    s_mov_b64 exec, -1
    v_mfma_f32_16x16x32_bf16 v[192:195], v[96:99], v[120:123], 0
    ds_read_b128 v[120:123], v5 offset:6144
    v_mul_f32 v186, v186, v197
    v_mfma_f32_16x16x32_bf16 v[192:195], v[100:103], v[128:131], v[192:195]
    s_waitcnt lgkmcnt(4)
    ds_read_b128 v[128:131], v5 offset:8192
    v_mul_f32 v187, v187, v197
    v_mfma_f32_16x16x32_bf16 v[172:175], a[252:255], v[212:215], v[172:175]
    s_waitcnt lgkmcnt(4)
    v_cvt_pk_bf16_f32 v184, v184, v185
    v_cvt_pk_bf16_f32 v185, v186, v187
    v_mfma_f32_16x16x32_bf16 v[176:179], v[224:227], v[212:215], v[176:179]
    v_mul_f32 v192, v192, v197
    v_mul_f32 v193, v193, v197
    v_mfma_f32_16x16x32_bf16 v[180:183], v[228:231], v[212:215], v[180:183]
    v_mul_f32 v194, v194, v197
    v_mul_f32 v195, v195, v197
    v_mfma_f32_16x16x32_bf16 v[172:175], v[232:235], v[216:219], v[172:175]
    s_waitcnt lgkmcnt(2)
    v_cvt_pk_bf16_f32 v186, v188, v189
    v_cvt_pk_bf16_f32 v187, v190, v191
    v_mfma_f32_16x16x32_bf16 v[176:179], v[236:239], v[216:219], v[176:179]
    v_cvt_pk_bf16_f32 v192, v192, v193
    v_cvt_pk_bf16_f32 v193, v194, v195
    v_mfma_f32_16x16x32_bf16 v[180:183], v[240:243], v[216:219], v[180:183]
    v_exp_f32 v114, v114
    v_mfma_f32_16x16x32_bf16 v[172:175], v[244:247], v[220:223], v[172:175]
    v_exp_f32 v115, v115
    v_mfma_f32_16x16x32_bf16 v[176:179], v[248:251], v[220:223], v[176:179]
    v_cvt_pk_bf16_f32 v107, v110, v111
    v_cvt_pk_bf16_f32 v112, v112, v113
    v_mfma_f32_16x16x32_bf16 v[180:183], v[252:255], v[220:223], v[180:183]
    v_exp_f32 v116, v116
    v_mfma_f32_16x16x32_bf16 v[196:199], v[20:23], v[104:107], 0
    v_cvt_pk_bf16_f32 v113, v114, v115
    v_cvt_pk_bf16_f32 v172, v172, v173
    v_mfma_f32_16x16x32_bf16 v[188:191], v[88:91], v[104:107], 0
    ds_write_b128 v3, v[184:187] offset:6144
    v_mfma_f32_16x16x32_bf16 v[184:187], v[80:83], v[104:107], 0
    v_cvt_pk_bf16_f32 v114, v116, 0
    ds_write_b64 v4, v[192:193] offset:6144
    v_mfma_f32_16x16x32_bf16 v[192:195], v[96:99], v[104:107], 0
    v_mov_b32 v115, 0
    v_cvt_pk_bf16_f32 v173, v174, v175
    v_cvt_pk_bf16_f32 v180, v180, v181
    v_mfma_f32_16x16x32_bf16 v[196:199], v[20:23], v[112:115], v[196:199]
    v_cvt_pk_bf16_f32 v174, v176, v177
    v_cvt_pk_bf16_f32 v175, v178, v179
    v_mfma_f32_16x16x32_bf16 v[184:187], v[84:87], v[112:115], v[184:187]
    v_cvt_pk_bf16_f32 v181, v182, v183
    v_add_u32 v182, v14, v10
    v_mfma_f32_16x16x32_bf16 v[188:191], v[92:95], v[112:115], v[188:191]
    ds_read_b32 v116, v7 offset:9456
    ds_read_b128 v[104:107], v6
    v_mfma_f32_16x16x32_bf16 v[192:195], v[100:103], v[112:115], v[192:195]
    ds_read_b128 v[108:111], v6 offset:64
    v_mul_f32 v162, s43, v162
    v_mfma_f32_16x16x32_bf16 v[176:179], v[200:203], a[76:79], 0
    v_mul_f32 v163, s43, v163
    v_mul_f32 v164, s43, v164
    v_mfma_f32_16x16x32_bf16 v[176:179], v[204:207], a[88:91], v[176:179]
    v_mul_f32 v165, s43, v165
    v_mul_f32 v166, s43, v166
    v_mfma_f32_16x16x32_bf16 v[176:179], v[208:211], a[100:103], v[176:179]
    v_mul_f32 v167, s43, v167
    v_mul_f32 v168, s43, v168
    v_mul_f32 v169, s43, v169
    v_mul_f32 v170, s43, v170
    s_waitcnt lgkmcnt(2)
    v_mfma_f32_16x16x32_bf16 v[116:119], v[48:51], v[72:75], v[116:119]
    v_mul_f32 v171, s43, v171
    v_cvt_pk_bf16_f32 v56, v160, v161
    s_waitcnt lgkmcnt(1)
    v_mfma_f32_16x16x32_bf16 v[104:107], v[24:27], v[72:75], v[104:107]
    s_waitcnt lgkmcnt(0)
    ds_read_b128 v[112:115], v6 offset:128
    v_cvt_pk_bf16_f32 v57, v162, v163
    v_mfma_f32_16x16x32_bf16 v[108:111], v[32:35], v[72:75], v[108:111]
    v_cvt_pk_bf16_f32 v58, v164, v165
    v_cvt_pk_bf16_f32 v59, v166, v167
    v_mfma_f32_16x16x32_bf16 v[116:119], v[52:55], v[76:79], v[116:119]
    v_cvt_pk_bf16_f32 v60, v168, v169
    v_cvt_pk_bf16_f32 v61, v170, v171
    v_mfma_f32_16x16x32_bf16 v[120:123], v[24:27], v[56:59], v[120:123]
    v_rcp_f32 v197, v196
    v_mfma_f32_16x16x32_bf16 v[132:135], v[48:51], v[56:59], v[132:135]
    v_mul_f32 v184, v184, v197
    v_mul_f32 v185, v185, v197
    v_mfma_f32_16x16x32_bf16 v[124:127], v[32:35], v[56:59], v[124:127]
    v_mul_f32 v186, v186, v197
    v_mul_f32 v187, v187, v197
    v_mfma_f32_16x16x32_bf16 v[128:131], v[40:43], v[56:59], v[128:131]
    s_waitcnt lgkmcnt(0)
    v_cvt_pk_bf16_f32 v184, v184, v185
    v_mul_f32 v188, v188, v197
    v_mfma_f32_16x16x32_bf16 v[120:123], v[28:31], v[60:63], v[120:123]
    v_mul_f32 v189, v189, v197
    v_mul_f32 v190, v190, v197
    v_mfma_f32_16x16x32_bf16 v[132:135], v[52:55], v[60:63], v[132:135]
    v_mul_f32 v191, v191, v197
    v_cvt_pk_bf16_f32 v185, v186, v187
    v_mfma_f32_16x16x32_bf16 v[124:127], v[36:39], v[60:63], v[124:127]
    v_mul_f32 v192, v192, v197
    v_mul_f32 v193, v193, v197
    v_mfma_f32_16x16x32_bf16 v[128:131], v[44:47], v[60:63], v[128:131]
    v_mul_f32 v194, v194, v197
    v_mul_f32 v195, v195, v197
    v_mfma_f32_16x16x32_bf16 v[112:115], v[40:43], v[72:75], v[112:115]
    v_max3_f32 v133, v120, v121, v122
    v_cvt_pk_bf16_f32 v186, v188, v189
    v_mfma_f32_16x16x32_bf16 v[104:107], v[28:31], v[76:79], v[104:107]
    v_max3_f32 v134, v123, v124, v125
    v_max3_f32 v133, v133, v126, v127
    v_mfma_f32_16x16x32_bf16 v[108:111], v[36:39], v[76:79], v[108:111]
    v_max3_f32 v134, v134, v128, v129
    v_max3_f32 v133, v133, v130, v131
    v_mfma_f32_16x16x32_bf16 v[112:115], v[44:47], v[76:79], v[112:115]
    v_max3_f32 v133, v133, v134, v132
    v_mov_b32 v134, v133
    v_mfma_f32_16x16x32_bf16 v[160:163], a[0:3], v[200:203], 0
    v_max3_f32 v117, v104, v105, v106
    v_cvt_pk_bf16_f32 v187, v190, v191
    v_mfma_f32_16x16x32_bf16 v[164:167], a[4:7], v[200:203], 0
    v_permlane32_swap_b32 v134, v133
    v_mfma_f32_16x16x32_bf16 v[168:171], a[8:11], v[200:203], 0
    v_max_f32 v133, v133, v134
    v_mov_b32 v134, v133
    v_mfma_f32_16x16x32_bf16 v[160:163], a[12:15], v[204:207], v[160:163]
    v_max3_f32 v118, v107, v108, v109
    v_max3_f32 v117, v117, v110, v111
    v_mfma_f32_16x16x32_bf16 v[164:167], a[16:19], v[204:207], v[164:167]
    v_permlane16_swap_b32 v134, v133
    v_mfma_f32_16x16x32_bf16 v[168:171], a[20:23], v[204:207], v[168:171]
    v_max_f32 v133, v133, v134
    v_sub_f32 v120, v120, v133
    v_mfma_f32_16x16x32_bf16 v[160:163], a[24:27], v[208:211], v[160:163]
    v_sub_f32 v121, v121, v133
    v_sub_f32 v122, v122, v133
    v_mfma_f32_16x16x32_bf16 v[164:167], a[28:31], v[208:211], v[164:167]
    v_sub_f32 v123, v123, v133
    v_sub_f32 v124, v124, v133
    v_mfma_f32_16x16x32_bf16 v[168:171], a[32:35], v[208:211], v[168:171]
    buffer_store_dwordx4 v[172:175], v14, s[36:39], s53 offen sc1
    v_exp_f32 v120, v120
    v_exp_f32 v121, v121
    v_mfma_f32_16x16x32_bf16 v[172:175], v[200:203], a[72:75], 0
    v_sub_f32 v125, v125, v133
    v_sub_f32 v126, v126, v133
    v_mfma_f32_16x16x32_bf16 v[172:175], v[204:207], a[84:87], v[172:175]
    v_sub_f32 v127, v127, v133
    v_sub_f32 v128, v128, v133
    v_mfma_f32_16x16x32_bf16 v[172:175], v[208:211], a[96:99], v[172:175]
    buffer_store_dwordx2 v[180:181], v182, s[36:39], s53 offen sc1
    v_mfma_f32_16x16x32_bf16 v[180:183], v[200:203], a[80:83], 0
    ds_read_b128 v[200:203], v1 offset:26624
    v_sub_f32 v129, v129, v133
    v_mfma_f32_16x16x32_bf16 v[180:183], v[204:207], a[92:95], v[180:183]
    ds_read_b128 v[204:207], v0 offset:28672
    v_cvt_pk_bf16_f32 v120, v120, v121
    v_mfma_f32_16x16x32_bf16 v[180:183], v[208:211], a[104:107], v[180:183]
    ds_read_b128 v[208:211], v1 offset:28672
    v_exp_f32 v122, v122
    v_exp_f32 v123, v123
    v_exp_f32 v124, v124
    v_exp_f32 v125, v125
    v_exp_f32 v126, v126
    v_exp_f32 v127, v127
    s_waitcnt lgkmcnt(2)
    v_mfma_f32_16x16x32_bf16 v[160:163], a[36:39], v[200:203], v[160:163]
    v_sub_f32 v130, v130, v133
    v_sub_f32 v131, v131, v133
    v_mfma_f32_16x16x32_bf16 v[164:167], a[40:43], v[200:203], v[164:167]
    s_waitcnt lgkmcnt(1)
    v_exp_f32 v128, v128
    v_mfma_f32_16x16x32_bf16 v[168:171], a[44:47], v[200:203], v[168:171]
    v_exp_f32 v129, v129
    v_mfma_f32_16x16x32_bf16 v[172:175], v[200:203], a[108:111], v[172:175]
    v_cvt_pk_bf16_f32 v121, v122, v123
    v_sub_f32 v132, v132, v133
    v_mfma_f32_16x16x32_bf16 v[176:179], v[200:203], a[112:115], v[176:179]
    v_exp_f32 v130, v130
    v_mfma_f32_16x16x32_bf16 v[180:183], v[200:203], a[116:119], v[180:183]
    ds_read_b128 v[200:203], v0 offset:30720
    v_cvt_pk_bf16_f32 v122, v124, v125
    v_mfma_f32_16x16x32_bf16 v[160:163], a[48:51], v[204:207], v[160:163]
    s_waitcnt lgkmcnt(1)
    v_exp_f32 v131, v131
    v_mfma_f32_16x16x32_bf16 v[164:167], a[52:55], v[204:207], v[164:167]
    v_cvt_pk_bf16_f32 v123, v126, v127
    v_cvt_pk_bf16_f32 v192, v192, v193
    v_mfma_f32_16x16x32_bf16 v[168:171], a[56:59], v[204:207], v[168:171]
    v_exp_f32 v132, v132
    v_mfma_f32_16x16x32_bf16 v[196:199], v[20:23], v[120:123], 0
    v_max3_f32 v118, v118, v112, v113
    v_max3_f32 v117, v117, v114, v115
    v_mfma_f32_16x16x32_bf16 v[188:191], v[88:91], v[120:123], 0
    v_cvt_pk_bf16_f32 v128, v128, v129
    v_cvt_pk_bf16_f32 v193, v194, v195
    v_mfma_f32_16x16x32_bf16 v[172:175], v[204:207], a[120:123], v[172:175]
    v_max3_f32 v117, v117, v118, v116
    v_cvt_pk_bf16_f32 v129, v130, v131
    v_mfma_f32_16x16x32_bf16 v[176:179], v[204:207], a[124:127], v[176:179]
    v_mov_b32 v118, v117
    v_cvt_pk_bf16_f32 v130, v132, 0
    v_mfma_f32_16x16x32_bf16 v[180:183], v[204:207], a[128:131], v[180:183]
    ds_read_b128 v[204:207], v1 offset:30720
    v_mov_b32 v131, 0
    v_mfma_f32_16x16x32_bf16 v[160:163], a[60:63], v[208:211], v[160:163]
    v_permlane32_swap_b32 v118, v117
    v_mfma_f32_16x16x32_bf16 v[196:199], v[20:23], v[128:131], v[196:199]
    v_max_f32 v117, v117, v118
    v_mov_b32 v118, v117
    v_mfma_f32_16x16x32_bf16 v[188:191], v[92:95], v[128:131], v[188:191]
    v_cvt_pk_bf16_f32 v24, v136, v137
    v_cvt_pk_bf16_f32 v25, v138, v139
    v_mfma_f32_16x16x32_bf16 v[164:167], a[64:67], v[208:211], v[164:167]
    s_waitcnt lgkmcnt(1)
    v_permlane16_swap_b32 v118, v117
    v_mfma_f32_16x16x32_bf16 v[168:171], a[68:71], v[208:211], v[168:171]
    v_rcp_f32 v197, v196
    v_mfma_f32_16x16x32_bf16 v[172:175], v[208:211], a[132:135], v[172:175]
    v_max_f32 v117, v117, v118
    v_sub_f32 v104, v104, v117
    v_mfma_f32_16x16x32_bf16 v[176:179], v[208:211], a[136:139], v[176:179]
    v_sub_f32 v105, v105, v117
    v_sub_f32 v106, v106, v117
    v_mfma_f32_16x16x32_bf16 v[180:183], v[208:211], a[140:143], v[180:183]
    ds_read_b128 v[208:211], v0 offset:32768
    v_sub_f32 v107, v107, v117
    v_mfma_f32_16x16x32_bf16 v[136:139], a[0:3], v[200:203], 0
    s_waitcnt lgkmcnt(1)
    v_exp_f32 v104, v104
    v_mfma_f32_16x16x32_bf16 v[136:139], a[12:15], v[204:207], v[136:139]
    ds_write_b128 v3, v[184:187] offset:12288
    v_mfma_f32_16x16x32_bf16 v[184:187], v[80:83], v[120:123], 0
    v_exp_f32 v105, v105
    v_mfma_f32_16x16x32_bf16 v[184:187], v[84:87], v[128:131], v[184:187]
    v_mul_f32 v188, v188, v197
    v_mul_f32 v189, v189, v197
    s_waitcnt lgkmcnt(1)
    v_mfma_f32_16x16x32_bf16 v[136:139], a[24:27], v[208:211], v[136:139]
    ds_write_b64 v4, v[192:193] offset:12288
    v_mfma_f32_16x16x32_bf16 v[192:195], v[96:99], v[120:123], 0
    v_mul_f32 v190, v190, v197
    v_mul_f32 v191, v191, v197
    v_mfma_f32_16x16x32_bf16 v[192:195], v[100:103], v[128:131], v[192:195]
    v_mul_f32 v184, v184, v197
    v_mul_f32 v185, v185, v197
    v_mul_f32 v186, v186, v197
    v_mul_f32 v187, v187, v197
    v_cvt_pk_bf16_f32 v184, v184, v185
    v_sub_f32 v108, v108, v117
    v_sub_f32 v109, v109, v117
    v_sub_f32 v110, v110, v117
    v_sub_f32 v111, v111, v117
    v_exp_f32 v106, v106
    v_exp_f32 v107, v107
    v_mul_f32 v192, v192, v197
    v_mul_f32 v193, v193, v197
    v_cvt_pk_bf16_f32 v185, v186, v187
    v_mul_f32 v194, v194, v197
    v_mul_f32 v195, v195, v197
    v_exp_f32 v108, v108
    v_exp_f32 v109, v109
    v_exp_f32 v110, v110
    v_exp_f32 v111, v111
    v_cvt_pk_bf16_f32 v192, v192, v193
    v_cvt_pk_bf16_f32 v186, v188, v189
    v_cvt_pk_bf16_f32 v187, v190, v191
    v_cvt_pk_bf16_f32 v104, v104, v105
    v_cvt_pk_bf16_f32 v193, v194, v195
    v_cvt_pk_bf16_f32 v105, v106, v107
    ds_write_b128 v3, v[184:187] offset:18432
    v_cvt_pk_bf16_f32 v106, v108, v109
    v_cvt_pk_bf16_f32 v107, v110, v111
    v_cvt_pk_bf16_f32 v26, v140, v141
    ds_write_b64 v4, v[192:193] offset:18432
    v_mfma_f32_16x16x32_bf16 v[184:187], v[80:83], v[104:107], 0
    v_cvt_pk_bf16_f32 v27, v142, v143
    v_cvt_pk_bf16_f32 v28, v144, v145
    v_mfma_f32_16x16x32_bf16 v[188:191], v[88:91], v[104:107], 0
    v_cvt_pk_bf16_f32 v29, v146, v147
    v_cvt_pk_bf16_f32 v80, v148, v149
    v_mfma_f32_16x16x32_bf16 v[192:195], v[96:99], v[104:107], 0
    v_cvt_pk_bf16_f32 v81, v150, v151
    v_cvt_pk_bf16_f32 v88, v152, v153
    v_mfma_f32_16x16x32_bf16 v[140:143], a[4:7], v[200:203], 0
    v_cvt_pk_bf16_f32 v89, v154, v155
    v_cvt_pk_bf16_f32 v96, v156, v157
    v_mfma_f32_16x16x32_bf16 v[144:147], a[8:11], v[200:203], 0
    v_cvt_pk_bf16_f32 v97, v158, v159
    v_cvt_pk_bf16_f32 v32, v160, v161
    v_mfma_f32_16x16x32_bf16 v[148:151], v[200:203], a[72:75], 0
    v_cvt_pk_bf16_f32 v33, v162, v163
    v_cvt_pk_bf16_f32 v34, v164, v165
    v_mfma_f32_16x16x32_bf16 v[152:155], v[200:203], a[76:79], 0
    s_waitcnt lgkmcnt(0)
    s_barrier
    v_mfma_f32_16x16x32_bf16 v[156:159], v[200:203], a[80:83], 0
    ds_read_b128 v[200:203], v1 offset:32768
    ds_read_b128 v[212:215], v2 offset:6144
    v_mfma_f32_16x16x32_bf16 v[140:143], a[16:19], v[204:207], v[140:143]
    ds_read_b128 v[216:219], v2 offset:7168
    v_cvt_pk_bf16_f32 v35, v166, v167
    v_mfma_f32_16x16x32_bf16 v[144:147], a[20:23], v[204:207], v[144:147]
    ds_read_b128 v[220:223], v2 offset:8192
    v_cvt_pk_bf16_f32 v36, v168, v169
    v_mfma_f32_16x16x32_bf16 v[148:151], v[204:207], a[84:87], v[148:151]
    v_cvt_pk_bf16_f32 v37, v170, v171
    v_cvt_pk_bf16_f32 v82, v172, v173
    v_mfma_f32_16x16x32_bf16 v[152:155], v[204:207], a[88:91], v[152:155]
    v_cvt_pk_bf16_f32 v83, v174, v175
    v_cvt_pk_bf16_f32 v90, v176, v177
    v_mfma_f32_16x16x32_bf16 v[156:159], v[204:207], a[92:95], v[156:159]
    ds_read_b128 v[204:207], v0 offset:34816
    v_cvt_pk_bf16_f32 v91, v178, v179
    v_mfma_f32_16x16x32_bf16 v[140:143], a[28:31], v[208:211], v[140:143]
    s_waitcnt lgkmcnt(4)
    v_cvt_pk_bf16_f32 v98, v180, v181
    v_cvt_pk_bf16_f32 v99, v182, v183
    v_mfma_f32_16x16x32_bf16 v[144:147], a[32:35], v[208:211], v[144:147]
    s_waitcnt lgkmcnt(3)
    v_lshrrev_b32 v7, 4, v19
    v_cmp_eq_u32 vcc, 3, v7
    v_mfma_f32_16x16x32_bf16 v[148:151], v[208:211], a[96:99], v[148:151]
    v_and_b32 v19, 15, v19
    v_mov_b32 v7, 16
    v_mfma_f32_16x16x32_bf16 v[152:155], v[208:211], a[100:103], v[152:155]
    v_cndmask_b32 v19, v7, v19, vcc
    v_lshlrev_b32 v19, 2, v19
    v_mfma_f32_16x16x32_bf16 v[156:159], v[208:211], a[104:107], v[156:159]
    ds_read_b128 v[208:211], v1 offset:34816
    v_add_u32 v7, s49, v19
    v_mfma_f32_16x16x32_bf16 v[136:139], a[36:39], v[200:203], v[136:139]
    s_waitcnt lgkmcnt(1)
    ds_read_b128 v[120:123], v5
    ds_read_b32 v132, v7 offset:9216
    v_mfma_f32_16x16x32_bf16 v[140:143], a[40:43], v[200:203], v[140:143]
    ds_read_b128 v[124:127], v5 offset:1024
    ds_read_b128 v[128:131], v5 offset:2048
    v_mfma_f32_16x16x32_bf16 v[144:147], a[44:47], v[200:203], v[144:147]
    v_sub_f32 v112, v112, v117
    v_sub_f32 v113, v113, v117
    v_mfma_f32_16x16x32_bf16 v[148:151], v[200:203], a[108:111], v[148:151]
    v_sub_f32 v114, v114, v117
    v_sub_f32 v115, v115, v117
    v_mfma_f32_16x16x32_bf16 v[152:155], v[200:203], a[112:115], v[152:155]
    v_exp_f32 v112, v112
    v_mfma_f32_16x16x32_bf16 v[156:159], v[200:203], a[116:119], v[156:159]
    ds_read_b128 v[200:203], v0 offset:18432
    v_sub_f32 v116, v116, v117
    v_mfma_f32_16x16x32_bf16 v[136:139], a[48:51], v[204:207], v[136:139]
    s_waitcnt lgkmcnt(3)
    v_exp_f32 v113, v113
    v_mfma_f32_16x16x32_bf16 v[140:143], a[52:55], v[204:207], v[140:143]
    v_exp_f32 v114, v114
    v_mfma_f32_16x16x32_bf16 v[144:147], a[56:59], v[204:207], v[144:147]
    v_exp_f32 v115, v115
    v_mfma_f32_16x16x32_bf16 v[148:151], v[204:207], a[120:123], v[148:151]
    v_exp_f32 v116, v116
    v_mfma_f32_16x16x32_bf16 v[152:155], v[204:207], a[124:127], v[152:155]
    v_cvt_pk_bf16_f32 v112, v112, v113
    v_cvt_pk_bf16_f32 v113, v114, v115
    v_mfma_f32_16x16x32_bf16 v[156:159], v[204:207], a[128:131], v[156:159]
    s_waitcnt lgkmcnt(0)
    ds_read_b128 v[204:207], v1 offset:18432
    v_cvt_pk_bf16_f32 v114, v116, 0
    v_mfma_f32_16x16x32_bf16 v[136:139], a[60:63], v[208:211], v[136:139]
    v_mov_b32 v115, 0
    v_bfe_i32 v19, v11, 5, 1
    v_mfma_f32_16x16x32_bf16 v[140:143], a[64:67], v[208:211], v[140:143]
    ds_read_b32 v116, v7 offset:9296
    ds_read_b128 v[108:111], v5 offset:4096
    v_mfma_f32_16x16x32_bf16 v[144:147], a[68:71], v[208:211], v[144:147]
    v_and_b32 v30, 0xbe8ac310, v19
    v_bfe_i32 v19, v11, 6, 1
    v_mfma_f32_16x16x32_bf16 v[148:151], v[208:211], a[132:135], v[148:151]
    v_and_b32 v38, 0xbe8ac310, v19
    v_bfe_i32 v19, v11, 7, 1
    v_mfma_f32_16x16x32_bf16 v[152:155], v[208:211], a[136:139], v[152:155]
    v_cvt_pk_bf16_f32 v40, v136, v137
    v_cvt_pk_bf16_f32 v41, v138, v139
    v_mfma_f32_16x16x32_bf16 v[156:159], v[208:211], a[140:143], v[156:159]
    ds_read_b128 v[208:211], v0 offset:20480
    v_cvt_pk_bf16_f32 v42, v140, v141
    v_mfma_f32_16x16x32_bf16 v[160:163], a[144:147], v[200:203], 0
    s_waitcnt lgkmcnt(2)
    v_cvt_pk_bf16_f32 v43, v142, v143
    v_and_b32 v46, 0xbe8ac310, v19
    v_mfma_f32_16x16x32_bf16 v[164:167], a[148:151], v[200:203], 0
    v_bfe_i32 v19, v11, 8, 1
    v_mov_b32 v62, v15
    v_mfma_f32_16x16x32_bf16 v[168:171], a[152:155], v[200:203], 0
    ds_read_b128 v[200:203], v1 offset:20480
    v_and_b32 v54, 0xbe8ac310, v19
    v_mfma_f32_16x16x32_bf16 v[160:163], a[156:159], v[204:207], v[160:163]
    v_cvt_pk_bf16_f32 v44, v144, v145
    v_cvt_pk_bf16_f32 v45, v146, v147
    v_mfma_f32_16x16x32_bf16 v[164:167], a[160:163], v[204:207], v[164:167]
    v_bfe_i32 v19, v11, 2, 1
    v_and_b32 v19, 0x15000, v19
    v_mfma_f32_16x16x32_bf16 v[168:171], a[164:167], v[204:207], v[168:171]
    s_waitcnt lgkmcnt(1)
    ds_read_b128 v[204:207], v0 offset:22528
    v_mfma_f32_16x16x32_bf16 v[172:175], a[216:219], v[212:215], 0
    v_mfma_f32_16x16x32_bf16 v[176:179], a[220:223], v[212:215], 0
    v_mfma_f32_16x16x32_bf16 v[180:183], a[224:227], v[212:215], 0
    ds_read_b128 v[212:215], v2 offset:9216
    v_mfma_f32_16x16x32_bf16 v[160:163], a[168:171], v[208:211], v[160:163]
    s_waitcnt lgkmcnt(2)
    v_mfma_f32_16x16x32_bf16 v[164:167], a[172:175], v[208:211], v[164:167]
    v_mfma_f32_16x16x32_bf16 v[168:171], a[176:179], v[208:211], v[168:171]
    ds_read_b128 v[208:211], v1 offset:22528
    v_mfma_f32_16x16x32_bf16 v[172:175], a[228:231], v[216:219], v[172:175]
    v_mfma_f32_16x16x32_bf16 v[176:179], a[232:235], v[216:219], v[176:179]
    v_mfma_f32_16x16x32_bf16 v[180:183], a[236:239], v[216:219], v[180:183]
    ds_read_b128 v[216:219], v2 offset:10240
    v_mfma_f32_16x16x32_bf16 v[172:175], a[240:243], v[220:223], v[172:175]
    s_waitcnt lgkmcnt(2)
    v_mfma_f32_16x16x32_bf16 v[176:179], a[244:247], v[220:223], v[176:179]
    v_mfma_f32_16x16x32_bf16 v[180:183], a[248:251], v[220:223], v[180:183]
    ds_read_b128 v[220:223], v2 offset:11264
    v_mfma_f32_16x16x32_bf16 v[160:163], a[180:183], v[200:203], v[160:163]
    v_mfma_f32_16x16x32_bf16 v[164:167], a[184:187], v[200:203], v[164:167]
    v_mfma_f32_16x16x32_bf16 v[168:171], a[188:191], v[200:203], v[168:171]
    ds_read_b128 v[200:203], v0 offset:24576
    v_mfma_f32_16x16x32_bf16 v[196:199], v[20:23], v[104:107], 0
    ds_read_b128 v[104:107], v5 offset:3072
    v_mfma_f32_16x16x32_bf16 v[160:163], a[192:195], v[204:207], v[160:163]
    s_waitcnt lgkmcnt(3)
    v_mfma_f32_16x16x32_bf16 v[164:167], a[196:199], v[204:207], v[164:167]
    v_mfma_f32_16x16x32_bf16 v[168:171], a[200:203], v[204:207], v[168:171]
    ds_read_b128 v[204:207], v1 offset:24576
    v_mfma_f32_16x16x32_bf16 v[184:187], v[84:87], v[112:115], v[184:187]
    v_cvt_pk_bf16_f32 v84, v148, v149
    v_cvt_pk_bf16_f32 v85, v150, v151
    v_mfma_f32_16x16x32_bf16 v[188:191], v[92:95], v[112:115], v[188:191]
    v_cvt_pk_bf16_f32 v92, v152, v153
    v_cvt_pk_bf16_f32 v93, v154, v155
    v_mfma_f32_16x16x32_bf16 v[192:195], v[100:103], v[112:115], v[192:195]
    v_cvt_pk_bf16_f32 v100, v156, v157
    v_cvt_pk_bf16_f32 v101, v158, v159
    v_mfma_f32_16x16x32_bf16 v[172:175], a[252:255], v[212:215], v[172:175]
    v_mfma_f32_16x16x32_bf16 v[176:179], v[224:227], v[212:215], v[176:179]
    v_mfma_f32_16x16x32_bf16 v[180:183], v[228:231], v[212:215], v[180:183]
    ds_read_b128 v[212:215], v2 offset:12288
    v_mfma_f32_16x16x32_bf16 v[196:199], v[20:23], v[112:115], v[196:199]
    ds_read_b128 v[112:115], v5 offset:5120
    v_mfma_f32_16x16x32_bf16 v[160:163], a[204:207], v[208:211], v[160:163]
    v_mfma_f32_16x16x32_bf16 v[164:167], a[208:211], v[208:211], v[164:167]
    v_mfma_f32_16x16x32_bf16 v[168:171], a[212:215], v[208:211], v[168:171]
    ds_read_b128 v[208:211], v0 offset:26624
    v_mfma_f32_16x16x32_bf16 v[172:175], v[232:235], v[216:219], v[172:175]
    s_waitcnt lgkmcnt(3)
    v_mfma_f32_16x16x32_bf16 v[176:179], v[236:239], v[216:219], v[176:179]
    v_rcp_f32 v197, v196
    v_mfma_f32_16x16x32_bf16 v[180:183], v[240:243], v[216:219], v[180:183]
    ds_read_b128 v[216:219], v2 offset:13312
    v_mul_f32 v160, s43, v160
    v_mfma_f32_16x16x32_bf16 v[172:175], v[244:247], v[220:223], v[172:175]
    v_mul_f32 v161, s43, v161
    v_mul_f32 v162, s43, v162
    v_mfma_f32_16x16x32_bf16 v[176:179], v[248:251], v[220:223], v[176:179]
    v_mul_f32 v163, s43, v163
    v_mul_f32 v164, s43, v164
    v_mfma_f32_16x16x32_bf16 v[180:183], v[252:255], v[220:223], v[180:183]
    ds_read_b128 v[220:223], v2 offset:14336
    v_mul_f32 v165, s43, v165
    v_mul_f32 v166, s43, v166
    v_mul_f32 v167, s43, v167
    v_mul_f32 v168, s43, v168
    v_mul_f32 v169, s43, v169
    v_mul_f32 v170, s43, v170
    v_mul_f32 v171, s43, v171
    v_cvt_pk_bf16_f32 v56, v160, v161
    v_cvt_pk_bf16_f32 v57, v162, v163
    v_mfma_f32_16x16x32_bf16 v[160:163], a[144:147], v[200:203], 0
    v_cvt_pk_bf16_f32 v58, v164, v165
    v_cvt_pk_bf16_f32 v59, v166, v167
    v_mfma_f32_16x16x32_bf16 v[164:167], a[148:151], v[200:203], 0
    v_cvt_pk_bf16_f32 v60, v168, v169
    v_cvt_pk_bf16_f32 v61, v170, v171
    v_mfma_f32_16x16x32_bf16 v[120:123], v[24:27], v[56:59], v[120:123]
    v_cvt_pk_bf16_f32 v172, v172, v173
    v_cvt_pk_bf16_f32 v173, v174, v175
    v_mfma_f32_16x16x32_bf16 v[132:135], v[48:51], v[56:59], v[132:135]
    v_cvt_pk_bf16_f32 v180, v180, v181
    v_cvt_pk_bf16_f32 v174, v176, v177
    v_mfma_f32_16x16x32_bf16 v[124:127], v[32:35], v[56:59], v[124:127]
    v_cvt_pk_bf16_f32 v175, v178, v179
    v_cvt_pk_bf16_f32 v181, v182, v183
    v_mfma_f32_16x16x32_bf16 v[128:131], v[40:43], v[56:59], v[128:131]
    s_waitcnt lgkmcnt(0)
    v_add_u32 v182, v12, v10
    v_mul_f32 v184, v184, v197
    v_mfma_f32_16x16x32_bf16 v[120:123], v[28:31], v[60:63], v[120:123]
    v_mul_f32 v185, v185, v197
    v_mul_f32 v186, v186, v197
    v_mfma_f32_16x16x32_bf16 v[132:135], v[52:55], v[60:63], v[132:135]
    v_mul_f32 v187, v187, v197
    v_cvt_pk_bf16_f32 v184, v184, v185
    v_mfma_f32_16x16x32_bf16 v[124:127], v[36:39], v[60:63], v[124:127]
    v_mul_f32 v188, v188, v197
    v_mul_f32 v189, v189, v197
    v_mfma_f32_16x16x32_bf16 v[128:131], v[44:47], v[60:63], v[128:131]
    v_mul_f32 v190, v190, v197
    v_mul_f32 v191, v191, v197
    v_mfma_f32_16x16x32_bf16 v[168:171], a[152:155], v[200:203], 0
    ds_read_b128 v[200:203], v1 offset:26624
    v_max3_f32 v133, v120, v121, v122
    v_mfma_f32_16x16x32_bf16 v[160:163], a[156:159], v[204:207], v[160:163]
    v_max3_f32 v134, v123, v124, v125
    v_max3_f32 v133, v133, v126, v127
    v_mfma_f32_16x16x32_bf16 v[164:167], a[160:163], v[204:207], v[164:167]
    v_max3_f32 v134, v134, v128, v129
    v_max3_f32 v133, v133, v130, v131
    v_mfma_f32_16x16x32_bf16 v[168:171], a[164:167], v[204:207], v[168:171]
    ds_read_b128 v[204:207], v0 offset:28672
    v_max3_f32 v133, v133, v134, v132
    v_mfma_f32_16x16x32_bf16 v[176:179], a[220:223], v[212:215], 0
    v_mov_b32 v134, v133
    v_cvt_pk_bf16_f32 v185, v186, v187
    v_mfma_f32_16x16x32_bf16 v[160:163], a[168:171], v[208:211], v[160:163]
    v_permlane32_swap_b32 v134, v133
    v_mfma_f32_16x16x32_bf16 v[164:167], a[172:175], v[208:211], v[164:167]
    s_waitcnt lgkmcnt(1)
    v_max_f32 v133, v133, v134
    v_mov_b32 v134, v133
    v_mfma_f32_16x16x32_bf16 v[168:171], a[176:179], v[208:211], v[168:171]
    ds_read_b128 v[208:211], v1 offset:28672
    v_mul_f32 v192, v192, v197
    v_mfma_f32_16x16x32_bf16 v[176:179], a[232:235], v[216:219], v[176:179]
    v_permlane16_swap_b32 v134, v133
    v_mfma_f32_16x16x32_bf16 v[176:179], a[244:247], v[220:223], v[176:179]
    v_max_f32 v133, v133, v134
    v_sub_f32 v120, v120, v133
    v_mfma_f32_16x16x32_bf16 v[160:163], a[180:183], v[200:203], v[160:163]
    s_waitcnt lgkmcnt(1)
    v_sub_f32 v121, v121, v133
    v_sub_f32 v122, v122, v133
    v_mfma_f32_16x16x32_bf16 v[164:167], a[184:187], v[200:203], v[164:167]
    v_sub_f32 v123, v123, v133
    v_sub_f32 v124, v124, v133
    v_mfma_f32_16x16x32_bf16 v[168:171], a[188:191], v[200:203], v[168:171]
    v_exp_f32 v120, v120
    v_mfma_f32_16x16x32_bf16 v[160:163], a[192:195], v[204:207], v[160:163]
    s_waitcnt lgkmcnt(0)
    v_exp_f32 v121, v121
    v_mfma_f32_16x16x32_bf16 v[164:167], a[196:199], v[204:207], v[164:167]
    v_sub_f32 v125, v125, v133
    v_sub_f32 v126, v126, v133
    v_mfma_f32_16x16x32_bf16 v[168:171], a[200:203], v[204:207], v[168:171]
    v_sub_f32 v127, v127, v133
    v_sub_f32 v128, v128, v133
    v_mfma_f32_16x16x32_bf16 v[160:163], a[204:207], v[208:211], v[160:163]
    v_exp_f32 v122, v122
    v_mfma_f32_16x16x32_bf16 v[164:167], a[208:211], v[208:211], v[164:167]
    v_exp_f32 v123, v123
    v_mfma_f32_16x16x32_bf16 v[168:171], a[212:215], v[208:211], v[168:171]
    buffer_store_dwordx4 v[172:175], v12, s[36:39], s54 offen sc1
    v_exp_f32 v124, v124
    v_exp_f32 v125, v125
    v_mfma_f32_16x16x32_bf16 v[172:175], a[216:219], v[212:215], 0
    v_mul_f32 v160, s43, v160
    v_mul_f32 v161, s43, v161
    v_mfma_f32_16x16x32_bf16 v[172:175], a[228:231], v[216:219], v[172:175]
    v_mul_f32 v162, s43, v162
    v_mul_f32 v163, s43, v163
    v_mfma_f32_16x16x32_bf16 v[172:175], a[240:243], v[220:223], v[172:175]
    buffer_store_dwordx2 v[180:181], v182, s[36:39], s54 offen sc1
    v_mfma_f32_16x16x32_bf16 v[180:183], a[224:227], v[212:215], 0
    ds_read_b128 v[212:215], v2 offset:15360
    v_mul_f32 v164, s43, v164
    v_mfma_f32_16x16x32_bf16 v[180:183], a[236:239], v[216:219], v[180:183]
    ds_read_b128 v[216:219], v2 offset:16384
    v_mul_f32 v165, s43, v165
    v_mfma_f32_16x16x32_bf16 v[180:183], a[248:251], v[220:223], v[180:183]
    ds_read_b128 v[220:223], v2 offset:17408
    v_mul_f32 v166, s43, v166
    v_mul_f32 v167, s43, v167
    v_cvt_pk_bf16_f32 v64, v160, v161
    v_cvt_pk_bf16_f32 v65, v162, v163
    v_cvt_pk_bf16_f32 v66, v164, v165
    v_cvt_pk_bf16_f32 v67, v166, v167
    v_mul_f32 v168, s43, v168
    v_mul_f32 v169, s43, v169
    v_mfma_f32_16x16x32_bf16 v[104:107], v[24:27], v[64:67], v[104:107]
    v_mul_f32 v170, s43, v170
    v_mul_f32 v171, s43, v171
    v_mfma_f32_16x16x32_bf16 v[116:119], v[48:51], v[64:67], v[116:119]
    s_waitcnt lgkmcnt(2)
    v_cvt_pk_bf16_f32 v68, v168, v169
    v_cvt_pk_bf16_f32 v69, v170, v171
    v_mfma_f32_16x16x32_bf16 v[108:111], v[32:35], v[64:67], v[108:111]
    v_exp_f32 v126, v126
    v_mfma_f32_16x16x32_bf16 v[112:115], v[40:43], v[64:67], v[112:115]
    v_exp_f32 v127, v127
    v_mfma_f32_16x16x32_bf16 v[104:107], v[28:31], v[68:71], v[104:107]
    v_sub_f32 v129, v129, v133
    v_cvt_pk_bf16_f32 v120, v120, v121
    v_mfma_f32_16x16x32_bf16 v[116:119], v[52:55], v[68:71], v[116:119]
    v_sub_f32 v130, v130, v133
    v_sub_f32 v131, v131, v133
    v_mfma_f32_16x16x32_bf16 v[108:111], v[36:39], v[68:71], v[108:111]
    v_exp_f32 v128, v128
    v_mfma_f32_16x16x32_bf16 v[112:115], v[44:47], v[68:71], v[112:115]
    v_exp_f32 v129, v129
    v_mfma_f32_16x16x32_bf16 v[172:175], a[252:255], v[212:215], v[172:175]
    s_waitcnt lgkmcnt(0)
    v_max3_f32 v117, v104, v105, v106
    v_cvt_pk_bf16_f32 v121, v122, v123
    v_mfma_f32_16x16x32_bf16 v[176:179], v[224:227], v[212:215], v[176:179]
    v_max3_f32 v118, v107, v108, v109
    v_max3_f32 v117, v117, v110, v111
    v_mfma_f32_16x16x32_bf16 v[180:183], v[228:231], v[212:215], v[180:183]
    ds_read_b128 v[212:215], v2 offset:18432
    v_max3_f32 v118, v118, v112, v113
    v_mfma_f32_16x16x32_bf16 v[172:175], v[232:235], v[216:219], v[172:175]
    v_max3_f32 v117, v117, v114, v115
    v_max3_f32 v117, v117, v118, v116
    v_mfma_f32_16x16x32_bf16 v[176:179], v[236:239], v[216:219], v[176:179]
    v_sub_f32 v132, v132, v133
    v_cvt_pk_bf16_f32 v122, v124, v125
    v_mfma_f32_16x16x32_bf16 v[180:183], v[240:243], v[216:219], v[180:183]
    ds_read_b128 v[216:219], v2 offset:19456
    v_cvt_pk_bf16_f32 v123, v126, v127
    v_mfma_f32_16x16x32_bf16 v[172:175], v[244:247], v[220:223], v[172:175]
    v_exp_f32 v130, v130
    v_mfma_f32_16x16x32_bf16 v[176:179], v[248:251], v[220:223], v[176:179]
    v_exp_f32 v131, v131
    v_mfma_f32_16x16x32_bf16 v[180:183], v[252:255], v[220:223], v[180:183]
    ds_read_b128 v[220:223], v2 offset:20480
    v_mov_b32 v118, v117
    v_mul_f32 v193, v193, v197
    v_mul_f32 v194, v194, v197
    v_cvt_pk_bf16_f32 v172, v172, v173
    v_cvt_pk_bf16_f32 v173, v174, v175
    v_mul_f32 v195, v195, v197
    v_mfma_f32_16x16x32_bf16 v[196:199], v[20:23], v[120:123], 0
    v_cvt_pk_bf16_f32 v186, v188, v189
    v_cvt_pk_bf16_f32 v187, v190, v191
    v_mfma_f32_16x16x32_bf16 v[188:191], v[88:91], v[120:123], 0
    v_exp_f32 v132, v132
    v_cvt_pk_bf16_f32 v180, v180, v181
    v_cvt_pk_bf16_f32 v174, v176, v177
    v_cvt_pk_bf16_f32 v175, v178, v179
    s_waitcnt lgkmcnt(2)
    v_mfma_f32_16x16x32_bf16 v[176:179], a[220:223], v[212:215], 0
    s_waitcnt lgkmcnt(0)
    v_cvt_pk_bf16_f32 v128, v128, v129
    v_cvt_pk_bf16_f32 v181, v182, v183
    v_mfma_f32_16x16x32_bf16 v[176:179], a[232:235], v[216:219], v[176:179]
    v_permlane32_swap_b32 v118, v117
    v_mfma_f32_16x16x32_bf16 v[176:179], a[244:247], v[220:223], v[176:179]
    v_cvt_pk_bf16_f32 v192, v192, v193
    v_cvt_pk_bf16_f32 v129, v130, v131
    v_add_u32 v182, v13, v10
    s_mov_b32 exec_lo, 0x1000100
    s_mov_b32 exec_hi, 0x1000100
    ds_write_b128 v3, v[184:187]
    s_mov_b64 exec, -1
    v_mfma_f32_16x16x32_bf16 v[184:187], v[80:83], v[120:123], 0
    buffer_store_dwordx4 v[172:175], v13, s[36:39], s54 offen sc1
    v_cvt_pk_bf16_f32 v193, v194, v195
    v_cvt_pk_bf16_f32 v130, v132, 0
    v_mfma_f32_16x16x32_bf16 v[172:175], a[216:219], v[212:215], 0
    v_mov_b32 v131, 0
    v_max_f32 v117, v117, v118
    v_mfma_f32_16x16x32_bf16 v[172:175], a[228:231], v[216:219], v[172:175]
    v_mov_b32 v118, v117
    v_mov_b32 v62, v16
    v_mfma_f32_16x16x32_bf16 v[196:199], v[20:23], v[128:131], v[196:199]
    v_permlane16_swap_b32 v118, v117
    v_mfma_f32_16x16x32_bf16 v[184:187], v[84:87], v[128:131], v[184:187]
    v_max_f32 v117, v117, v118
    v_sub_f32 v104, v104, v117
    v_mfma_f32_16x16x32_bf16 v[188:191], v[92:95], v[128:131], v[188:191]
    v_sub_f32 v105, v105, v117
    v_sub_f32 v106, v106, v117
    v_mfma_f32_16x16x32_bf16 v[172:175], a[240:243], v[220:223], v[172:175]
    buffer_store_dwordx2 v[180:181], v182, s[36:39], s54 offen sc1
    v_mfma_f32_16x16x32_bf16 v[180:183], a[224:227], v[212:215], 0
    ds_read_b128 v[212:215], v2 offset:21504
    v_sub_f32 v107, v107, v117
    v_mfma_f32_16x16x32_bf16 v[180:183], a[236:239], v[216:219], v[180:183]
    v_rcp_f32 v197, v196
    v_mfma_f32_16x16x32_bf16 v[180:183], a[248:251], v[220:223], v[180:183]
    s_mov_b32 exec_lo, 0x1000100
    s_mov_b32 exec_hi, 0x1000100
    ds_write_b64 v4, v[192:193]
    s_mov_b64 exec, -1
    v_mfma_f32_16x16x32_bf16 v[192:195], v[96:99], v[120:123], 0
    v_exp_f32 v104, v104
    v_mfma_f32_16x16x32_bf16 v[192:195], v[100:103], v[128:131], v[192:195]
    v_exp_f32 v105, v105
    s_waitcnt lgkmcnt(1)
    v_mfma_f32_16x16x32_bf16 v[172:175], a[252:255], v[212:215], v[172:175]
    ds_read_b128 v[216:219], v2 offset:22528
    v_sub_f32 v108, v108, v117
    v_mfma_f32_16x16x32_bf16 v[176:179], v[224:227], v[212:215], v[176:179]
    v_sub_f32 v109, v109, v117
    v_sub_f32 v110, v110, v117
    v_mfma_f32_16x16x32_bf16 v[180:183], v[228:231], v[212:215], v[180:183]
    v_sub_f32 v111, v111, v117
    v_exp_f32 v106, v106
    v_exp_f32 v107, v107
    v_exp_f32 v108, v108
    v_exp_f32 v109, v109
    v_exp_f32 v110, v110
    v_exp_f32 v111, v111
    s_waitcnt lgkmcnt(0)
    v_mfma_f32_16x16x32_bf16 v[172:175], v[232:235], v[216:219], v[172:175]
    v_sub_f32 v112, v112, v117
    v_sub_f32 v113, v113, v117
    v_mfma_f32_16x16x32_bf16 v[176:179], v[236:239], v[216:219], v[176:179]
    v_mul_f32 v184, v184, v197
    v_mul_f32 v185, v185, v197
    v_mfma_f32_16x16x32_bf16 v[180:183], v[240:243], v[216:219], v[180:183]
    v_cvt_pk_bf16_f32 v104, v104, v105
    v_sub_f32 v114, v114, v117
    v_sub_f32 v115, v115, v117
    v_mul_f32 v186, v186, v197
    v_mul_f32 v187, v187, v197
    ds_read_b128 v[220:223], v2 offset:23552
    v_exp_f32 v112, v112
    v_exp_f32 v113, v113
    v_cvt_pk_bf16_f32 v184, v184, v185
    v_cvt_pk_bf16_f32 v105, v106, v107
    v_sub_f32 v116, v116, v117
    v_mul_f32 v188, v188, v197
    v_mul_f32 v189, v189, v197
    v_mul_f32 v190, v190, v197
    v_mul_f32 v191, v191, v197
    v_exp_f32 v114, v114
    v_exp_f32 v115, v115
    v_cvt_pk_bf16_f32 v185, v186, v187
    v_cvt_pk_bf16_f32 v106, v108, v109
    v_cvt_pk_bf16_f32 v107, v110, v111
    v_mul_f32 v192, v192, v197
    v_mul_f32 v193, v193, v197
    s_waitcnt lgkmcnt(0)
    v_mfma_f32_16x16x32_bf16 v[172:175], v[244:247], v[220:223], v[172:175]
    v_mul_f32 v194, v194, v197
    v_mul_f32 v195, v195, v197
    v_mfma_f32_16x16x32_bf16 v[196:199], v[20:23], v[104:107], 0
    v_exp_f32 v116, v116
    v_mfma_f32_16x16x32_bf16 v[176:179], v[248:251], v[220:223], v[176:179]
    v_cvt_pk_bf16_f32 v186, v188, v189
    v_cvt_pk_bf16_f32 v187, v190, v191
    v_mfma_f32_16x16x32_bf16 v[188:191], v[88:91], v[104:107], 0
    v_cvt_pk_bf16_f32 v112, v112, v113
    v_cvt_pk_bf16_f32 v192, v192, v193
    v_mfma_f32_16x16x32_bf16 v[180:183], v[252:255], v[220:223], v[180:183]
    v_cvt_pk_bf16_f32 v113, v114, v115
    v_cvt_pk_bf16_f32 v193, v194, v195
    ds_write_b128 v3, v[184:187] offset:24576
    v_mfma_f32_16x16x32_bf16 v[184:187], v[80:83], v[104:107], 0
    v_cvt_pk_bf16_f32 v114, v116, 0
    v_mov_b32 v115, 0
    ds_write_b64 v4, v[192:193] offset:24576
    v_mfma_f32_16x16x32_bf16 v[192:195], v[96:99], v[104:107], 0
    ds_read_b128 v[200:203], v0 offset:30720
    ds_read_b128 v[204:207], v1 offset:30720
    v_mfma_f32_16x16x32_bf16 v[196:199], v[20:23], v[112:115], v[196:199]
    ds_read_b128 v[208:211], v0 offset:32768
    v_mfma_f32_16x16x32_bf16 v[184:187], v[84:87], v[112:115], v[184:187]
    v_cvt_pk_bf16_f32 v172, v172, v173
    v_cvt_pk_bf16_f32 v173, v174, v175
    v_mfma_f32_16x16x32_bf16 v[188:191], v[92:95], v[112:115], v[188:191]
    v_cvt_pk_bf16_f32 v180, v180, v181
    v_cvt_pk_bf16_f32 v174, v176, v177
    v_mfma_f32_16x16x32_bf16 v[192:195], v[100:103], v[112:115], v[192:195]
    v_rcp_f32 v197, v196
    v_cvt_pk_bf16_f32 v175, v178, v179
    v_mul_f32 v184, v184, v197
    v_mul_f32 v185, v185, v197
    v_mul_f32 v186, v186, v197
    v_mul_f32 v187, v187, v197
    v_cvt_pk_bf16_f32 v184, v184, v185
    v_mul_f32 v188, v188, v197
    s_waitcnt lgkmcnt(2)
    v_mfma_f32_16x16x32_bf16 v[160:163], a[144:147], v[200:203], 0
    v_mul_f32 v189, v189, v197
    v_mul_f32 v190, v190, v197
    v_mfma_f32_16x16x32_bf16 v[164:167], a[148:151], v[200:203], 0
    s_waitcnt lgkmcnt(1)
    v_mul_f32 v191, v191, v197
    v_mul_f32 v192, v192, v197
    v_mfma_f32_16x16x32_bf16 v[168:171], a[152:155], v[200:203], 0
    v_mul_f32 v193, v193, v197
    v_cvt_pk_bf16_f32 v185, v186, v187
    v_mfma_f32_16x16x32_bf16 v[160:163], a[156:159], v[204:207], v[160:163]
    s_waitcnt lgkmcnt(0)
    v_mul_f32 v194, v194, v197
    v_mul_f32 v195, v195, v197
    v_mfma_f32_16x16x32_bf16 v[164:167], a[160:163], v[204:207], v[164:167]
    v_cvt_pk_bf16_f32 v192, v192, v193
    v_cvt_pk_bf16_f32 v186, v188, v189
    v_mfma_f32_16x16x32_bf16 v[168:171], a[164:167], v[204:207], v[168:171]
    v_cvt_pk_bf16_f32 v187, v190, v191
    v_cvt_pk_bf16_f32 v193, v194, v195
    v_mfma_f32_16x16x32_bf16 v[160:163], a[168:171], v[208:211], v[160:163]
    v_cvt_pk_bf16_f32 v181, v182, v183
    v_add_u32 v182, v14, v10
    v_mfma_f32_16x16x32_bf16 v[164:167], a[172:175], v[208:211], v[164:167]
    ds_read_b128 v[200:203], v1 offset:32768
    ds_read_b128 v[204:207], v0 offset:34816
    v_mfma_f32_16x16x32_bf16 v[168:171], a[176:179], v[208:211], v[168:171]
    ds_write_b128 v3, v[184:187] offset:30720
    buffer_store_dwordx4 v[172:175], v14, s[36:39], s54 offen sc1
    ds_read_b128 v[208:211], v1 offset:34816
    ds_read_b32 v132, v7 offset:9376
    v_sub_u32 v12, v12, v19
    v_add_u32 v12, 0x1f80, v12
    s_waitcnt lgkmcnt(4)
    v_mfma_f32_16x16x32_bf16 v[160:163], a[180:183], v[200:203], v[160:163]
    ds_read_b128 v[120:123], v5 offset:6144
    ds_read_b128 v[124:127], v5 offset:7168
    v_mfma_f32_16x16x32_bf16 v[164:167], a[184:187], v[200:203], v[164:167]
    s_waitcnt lgkmcnt(5)
    v_bfe_i32 v19, v11, 3, 1
    v_and_b32 v19, 0x15000, v19
    v_mfma_f32_16x16x32_bf16 v[168:171], a[188:191], v[200:203], v[168:171]
    ds_read_b128 v[128:131], v5 offset:8192
    v_sub_u32 v13, v13, v19
    v_mfma_f32_16x16x32_bf16 v[160:163], a[192:195], v[204:207], v[160:163]
    ds_read_b32 v116, v7 offset:9456
    ds_read_b128 v[104:107], v6
    v_mfma_f32_16x16x32_bf16 v[164:167], a[196:199], v[204:207], v[164:167]
    ds_read_b128 v[108:111], v6 offset:64
    v_mfma_f32_16x16x32_bf16 v[168:171], a[200:203], v[204:207], v[168:171]
    s_waitcnt lgkmcnt(7)
    ds_read_b128 v[112:115], v6 offset:128
    v_mfma_f32_16x16x32_bf16 v[160:163], a[204:207], v[208:211], v[160:163]
    v_add_u32 v13, 0x1f80, v13
    v_bfe_i32 v19, v11, 4, 1
    v_mfma_f32_16x16x32_bf16 v[164:167], a[208:211], v[208:211], v[164:167]
    v_and_b32 v19, 0x15000, v19
    v_sub_u32 v14, v14, v19
    v_mfma_f32_16x16x32_bf16 v[168:171], a[212:215], v[208:211], v[168:171]
    ds_write_b64 v4, v[192:193] offset:30720
    v_add_u32 v14, 0x1f80, v14
    v_mul_f32 v160, s43, v160
    s_waitcnt lgkmcnt(4)
    v_mfma_f32_16x16x32_bf16 v[116:119], v[48:51], v[72:75], v[116:119]
    v_mul_f32 v161, s43, v161
    v_mul_f32 v162, s43, v162
    s_waitcnt lgkmcnt(3)
    v_mfma_f32_16x16x32_bf16 v[104:107], v[24:27], v[72:75], v[104:107]
    s_waitcnt lgkmcnt(2)
    v_mul_f32 v163, s43, v163
    v_mul_f32 v164, s43, v164
    v_mfma_f32_16x16x32_bf16 v[108:111], v[32:35], v[72:75], v[108:111]
    s_waitcnt lgkmcnt(1)
    v_mul_f32 v165, s43, v165
    v_mul_f32 v166, s43, v166
    v_mfma_f32_16x16x32_bf16 v[112:115], v[40:43], v[72:75], v[112:115]
    v_mul_f32 v167, s43, v167
    v_cvt_pk_bf16_f32 v56, v160, v161
    v_mfma_f32_16x16x32_bf16 v[116:119], v[52:55], v[76:79], v[116:119]
    s_waitcnt lgkmcnt(0)
    s_barrier
    v_mfma_f32_16x16x32_bf16 v[104:107], v[28:31], v[76:79], v[104:107]
    ds_read_b128 v[212:215], v2 offset:24576
    ds_read_b128 v[216:219], v2 offset:25600
    v_mfma_f32_16x16x32_bf16 v[108:111], v[36:39], v[76:79], v[108:111]
    ds_read_b128 v[220:223], v2 offset:26624
    v_cvt_pk_bf16_f32 v57, v162, v163
    v_mfma_f32_16x16x32_bf16 v[112:115], v[44:47], v[76:79], v[112:115]
    buffer_store_dwordx2 v[180:181], v182, s[36:39], s54 offen sc1
    v_cvt_pk_bf16_f32 v58, v164, v165
    v_cvt_pk_bf16_f32 v59, v166, v167
    v_mul_f32 v168, s43, v168
    v_mul_f32 v169, s43, v169
    v_mfma_f32_16x16x32_bf16 v[120:123], v[24:27], v[56:59], v[120:123]
    v_mul_f32 v170, s43, v170
    v_mul_f32 v171, s43, v171
    v_mfma_f32_16x16x32_bf16 v[132:135], v[48:51], v[56:59], v[132:135]
    s_waitcnt lgkmcnt(2)
    v_cvt_pk_bf16_f32 v60, v168, v169
    v_cvt_pk_bf16_f32 v61, v170, v171
    v_mfma_f32_16x16x32_bf16 v[124:127], v[32:35], v[56:59], v[124:127]
    v_max3_f32 v117, v104, v105, v106
    v_max3_f32 v118, v107, v108, v109
    v_mfma_f32_16x16x32_bf16 v[128:131], v[40:43], v[56:59], v[128:131]
    v_max3_f32 v117, v117, v110, v111
    v_max3_f32 v118, v118, v112, v113
    v_mfma_f32_16x16x32_bf16 v[120:123], v[28:31], v[60:63], v[120:123]
    v_max3_f32 v117, v117, v114, v115
    v_max3_f32 v117, v117, v118, v116
    v_mfma_f32_16x16x32_bf16 v[132:135], v[52:55], v[60:63], v[132:135]
    v_mov_b32 v118, v117
    v_mfma_f32_16x16x32_bf16 v[124:127], v[36:39], v[60:63], v[124:127]
    v_mfma_f32_16x16x32_bf16 v[128:131], v[44:47], v[60:63], v[128:131]
    v_permlane32_swap_b32 v118, v117
    v_mfma_f32_16x16x32_bf16 v[172:175], a[216:219], v[212:215], 0
    s_waitcnt lgkmcnt(0)
    v_max_f32 v117, v117, v118
    v_mov_b32 v118, v117
    v_mfma_f32_16x16x32_bf16 v[176:179], a[220:223], v[212:215], 0
    v_max3_f32 v133, v120, v121, v122
    v_max3_f32 v134, v123, v124, v125
    v_mfma_f32_16x16x32_bf16 v[180:183], a[224:227], v[212:215], 0
    ds_read_b128 v[212:215], v2 offset:27648
    v_max3_f32 v133, v133, v126, v127
    v_mfma_f32_16x16x32_bf16 v[172:175], a[228:231], v[216:219], v[172:175]
    v_max3_f32 v134, v134, v128, v129
    v_max3_f32 v133, v133, v130, v131
    v_mfma_f32_16x16x32_bf16 v[176:179], a[232:235], v[216:219], v[176:179]
    v_max3_f32 v133, v133, v134, v132
    v_mov_b32 v134, v133
    v_mfma_f32_16x16x32_bf16 v[180:183], a[236:239], v[216:219], v[180:183]
    ds_read_b128 v[216:219], v2 offset:28672
    v_mfma_f32_16x16x32_bf16 v[172:175], a[240:243], v[220:223], v[172:175]
    v_permlane32_swap_b32 v134, v133
    v_mfma_f32_16x16x32_bf16 v[176:179], a[244:247], v[220:223], v[176:179]
    v_max_f32 v133, v133, v134
    v_mov_b32 v134, v133
    v_mfma_f32_16x16x32_bf16 v[180:183], a[248:251], v[220:223], v[180:183]
    s_waitcnt lgkmcnt(1)
    ds_read_b128 v[220:223], v2 offset:29696
    v_mfma_f32_16x16x32_bf16 v[172:175], a[252:255], v[212:215], v[172:175]
    v_permlane16_swap_b32 v134, v133
    v_mfma_f32_16x16x32_bf16 v[176:179], v[224:227], v[212:215], v[176:179]
    v_max_f32 v133, v133, v134
    v_sub_f32 v120, v120, v133
    v_mfma_f32_16x16x32_bf16 v[180:183], v[228:231], v[212:215], v[180:183]
    s_waitcnt lgkmcnt(1)
    ds_read_b128 v[212:215], v2 offset:30720
    v_sub_f32 v121, v121, v133
    v_mfma_f32_16x16x32_bf16 v[172:175], v[232:235], v[216:219], v[172:175]
    v_sub_f32 v122, v122, v133
    v_sub_f32 v123, v123, v133
    v_mfma_f32_16x16x32_bf16 v[176:179], v[236:239], v[216:219], v[176:179]
    v_exp_f32 v120, v120
    v_mfma_f32_16x16x32_bf16 v[180:183], v[240:243], v[216:219], v[180:183]
    s_waitcnt lgkmcnt(1)
    ds_read_b128 v[216:219], v2 offset:31744
    v_sub_f32 v124, v124, v133
    v_mfma_f32_16x16x32_bf16 v[172:175], v[244:247], v[220:223], v[172:175]
    v_exp_f32 v121, v121
    v_mfma_f32_16x16x32_bf16 v[176:179], v[248:251], v[220:223], v[176:179]
    v_sub_f32 v125, v125, v133
    v_sub_f32 v126, v126, v133
    v_mfma_f32_16x16x32_bf16 v[180:183], v[252:255], v[220:223], v[180:183]
    ds_read_b128 v[220:223], v2 offset:32768
    v_sub_f32 v127, v127, v133
    v_exp_f32 v122, v122
    v_cvt_pk_bf16_f32 v172, v172, v173
    v_cvt_pk_bf16_f32 v173, v174, v175
    v_cvt_pk_bf16_f32 v174, v176, v177
    v_cvt_pk_bf16_f32 v175, v178, v179
    s_waitcnt lgkmcnt(2)
    v_mfma_f32_16x16x32_bf16 v[176:179], a[220:223], v[212:215], 0
    s_waitcnt lgkmcnt(1)
    v_cvt_pk_bf16_f32 v180, v180, v181
    v_cvt_pk_bf16_f32 v181, v182, v183
    v_mfma_f32_16x16x32_bf16 v[176:179], a[232:235], v[216:219], v[176:179]
    v_add_u32 v182, v12, v10
    buffer_store_dwordx2 v[180:181], v182, s[36:39], 0 offen
    v_mfma_f32_16x16x32_bf16 v[180:183], a[224:227], v[212:215], 0
    s_waitcnt lgkmcnt(0)
    v_exp_f32 v123, v123
    v_mfma_f32_16x16x32_bf16 v[180:183], a[236:239], v[216:219], v[180:183]
    v_exp_f32 v124, v124
    v_mfma_f32_16x16x32_bf16 v[176:179], a[244:247], v[220:223], v[176:179]
    v_exp_f32 v125, v125
    v_mfma_f32_16x16x32_bf16 v[180:183], a[248:251], v[220:223], v[180:183]
    buffer_store_dwordx4 v[172:175], v12, s[36:39], 0 offen
    v_exp_f32 v126, v126
    v_exp_f32 v127, v127
    v_mfma_f32_16x16x32_bf16 v[172:175], a[216:219], v[212:215], 0
    ds_read_b128 v[212:215], v2 offset:33792
    v_sub_f32 v128, v128, v133
    v_mfma_f32_16x16x32_bf16 v[172:175], a[228:231], v[216:219], v[172:175]
    ds_read_b128 v[216:219], v2 offset:34816
    v_sub_f32 v129, v129, v133
    v_mfma_f32_16x16x32_bf16 v[172:175], a[240:243], v[220:223], v[172:175]
    v_cvt_pk_bf16_f32 v120, v120, v121
    v_sub_f32 v130, v130, v133
    v_sub_f32 v131, v131, v133
    v_exp_f32 v128, v128
    v_exp_f32 v129, v129
    ds_read_b128 v[220:223], v2 offset:35840
    v_cvt_pk_bf16_f32 v121, v122, v123
    v_sub_f32 v132, v132, v133
    v_exp_f32 v130, v130
    s_waitcnt lgkmcnt(2)
    v_mfma_f32_16x16x32_bf16 v[176:179], v[224:227], v[212:215], v[176:179]
    v_exp_f32 v131, v131
    v_mfma_f32_16x16x32_bf16 v[180:183], v[228:231], v[212:215], v[180:183]
    s_waitcnt lgkmcnt(1)
    v_cvt_pk_bf16_f32 v122, v124, v125
    v_cvt_pk_bf16_f32 v123, v126, v127
    v_mfma_f32_16x16x32_bf16 v[172:175], a[252:255], v[212:215], v[172:175]
    v_exp_f32 v132, v132
    v_mfma_f32_16x16x32_bf16 v[196:199], v[20:23], v[120:123], 0
    v_cvt_pk_bf16_f32 v128, v128, v129
    v_cvt_pk_bf16_f32 v129, v130, v131
    v_mfma_f32_16x16x32_bf16 v[184:187], v[80:83], v[120:123], 0
    v_cvt_pk_bf16_f32 v130, v132, 0
    v_mov_b32 v131, 0
    v_mfma_f32_16x16x32_bf16 v[188:191], v[88:91], v[120:123], 0
    v_permlane16_swap_b32 v118, v117
    v_mfma_f32_16x16x32_bf16 v[196:199], v[20:23], v[128:131], v[196:199]
    v_max_f32 v117, v117, v118
    v_sub_f32 v104, v104, v117
    v_mfma_f32_16x16x32_bf16 v[192:195], v[96:99], v[120:123], 0
    v_sub_f32 v105, v105, v117
    v_sub_f32 v106, v106, v117
    v_mfma_f32_16x16x32_bf16 v[184:187], v[84:87], v[128:131], v[184:187]
    v_sub_f32 v107, v107, v117
    v_sub_f32 v108, v108, v117
    v_mfma_f32_16x16x32_bf16 v[188:191], v[92:95], v[128:131], v[188:191]
    v_rcp_f32 v197, v196
    v_mfma_f32_16x16x32_bf16 v[192:195], v[100:103], v[128:131], v[192:195]
    v_exp_f32 v104, v104
    v_mfma_f32_16x16x32_bf16 v[176:179], v[236:239], v[216:219], v[176:179]
    s_waitcnt lgkmcnt(0)
    v_mul_f32 v184, v184, v197
    v_mul_f32 v185, v185, v197
    v_mfma_f32_16x16x32_bf16 v[180:183], v[240:243], v[216:219], v[180:183]
    v_mul_f32 v186, v186, v197
    v_mul_f32 v187, v187, v197
    v_mfma_f32_16x16x32_bf16 v[172:175], v[232:235], v[216:219], v[172:175]
    v_cvt_pk_bf16_f32 v184, v184, v185
    v_mul_f32 v188, v188, v197
    v_mfma_f32_16x16x32_bf16 v[176:179], v[248:251], v[220:223], v[176:179]
    v_mul_f32 v189, v189, v197
    v_mul_f32 v190, v190, v197
    v_mfma_f32_16x16x32_bf16 v[180:183], v[252:255], v[220:223], v[180:183]
    v_mul_f32 v191, v191, v197
    v_mul_f32 v192, v192, v197
    v_mfma_f32_16x16x32_bf16 v[172:175], v[244:247], v[220:223], v[172:175]
    v_mul_f32 v193, v193, v197
    v_cvt_pk_bf16_f32 v185, v186, v187
    v_mul_f32 v194, v194, v197
    v_mul_f32 v195, v195, v197
    v_cvt_pk_bf16_f32 v192, v192, v193
    v_cvt_pk_bf16_f32 v186, v188, v189
    v_cvt_pk_bf16_f32 v187, v190, v191
    v_cvt_pk_bf16_f32 v193, v194, v195
    ds_write_b128 v3, v[184:187] offset:36864
    v_cvt_pk_bf16_f32 v172, v172, v173
    v_cvt_pk_bf16_f32 v173, v174, v175
    v_cvt_pk_bf16_f32 v180, v180, v181
    ds_write_b64 v4, v[192:193] offset:36864
    v_cvt_pk_bf16_f32 v174, v176, v177
    v_cvt_pk_bf16_f32 v175, v178, v179
    v_cvt_pk_bf16_f32 v181, v182, v183
    v_add_u32 v182, v13, v10
    buffer_store_dwordx4 v[172:175], v13, s[36:39], 0 offen
    v_exp_f32 v105, v105
    v_sub_f32 v109, v109, v117
    v_sub_f32 v110, v110, v117
    v_sub_f32 v111, v111, v117
    v_exp_f32 v106, v106
    v_exp_f32 v107, v107
    v_exp_f32 v108, v108
    buffer_store_dwordx2 v[180:181], v182, s[36:39], 0 offen
    s_waitcnt lgkmcnt(0)
    s_barrier
    ds_read_b128 v[212:215], v2 offset:36864
    ds_read_b128 v[216:219], v2 offset:37888
    ds_read_b128 v[220:223], v2 offset:38912
    v_exp_f32 v109, v109
    v_exp_f32 v110, v110
    v_exp_f32 v111, v111
    v_sub_f32 v112, v112, v117
    v_sub_f32 v113, v113, v117
    v_cvt_pk_bf16_f32 v104, v104, v105
    v_sub_f32 v114, v114, v117
    v_sub_f32 v115, v115, v117
    v_exp_f32 v112, v112
    v_exp_f32 v113, v113
    v_cvt_pk_bf16_f32 v105, v106, v107
    v_sub_f32 v116, v116, v117
    v_cvt_pk_bf16_f32 v106, v108, v109
    s_waitcnt lgkmcnt(2)
    v_mfma_f32_16x16x32_bf16 v[172:175], a[216:219], v[212:215], 0
    v_exp_f32 v114, v114
    v_mfma_f32_16x16x32_bf16 v[176:179], a[220:223], v[212:215], 0
    s_waitcnt lgkmcnt(1)
    v_exp_f32 v115, v115
    v_mfma_f32_16x16x32_bf16 v[180:183], a[224:227], v[212:215], 0
    ds_read_b128 v[212:215], v2 offset:39936
    v_cvt_pk_bf16_f32 v107, v110, v111
    v_mfma_f32_16x16x32_bf16 v[172:175], a[228:231], v[216:219], v[172:175]
    s_waitcnt lgkmcnt(1)
    v_exp_f32 v116, v116
    v_mfma_f32_16x16x32_bf16 v[196:199], v[20:23], v[104:107], 0
    v_cvt_pk_bf16_f32 v112, v112, v113
    v_cvt_pk_bf16_f32 v113, v114, v115
    v_mfma_f32_16x16x32_bf16 v[184:187], v[80:83], v[104:107], 0
    v_cvt_pk_bf16_f32 v114, v116, 0
    v_mov_b32 v115, 0
    v_mfma_f32_16x16x32_bf16 v[188:191], v[88:91], v[104:107], 0
    v_mfma_f32_16x16x32_bf16 v[192:195], v[96:99], v[104:107], 0
    v_lshrrev_b32 v107, 4, v2
    v_subrev_u32 v107, 0x1500, v107
    v_mfma_f32_16x16x32_bf16 v[196:199], v[20:23], v[112:115], v[196:199]
    v_bfe_u32 v105, v107, 2, 2
    v_mul_u32_u24 v104, 7, v105
    v_mfma_f32_16x16x32_bf16 v[184:187], v[84:87], v[112:115], v[184:187]
    v_add_u32 v104, s61, v104
    v_add_u32 v104, 6, v104
    v_mfma_f32_16x16x32_bf16 v[188:191], v[92:95], v[112:115], v[188:191]
    v_subrev_u32 v106, 224, v104
    v_min_u32 v104, v104, v106
    v_mfma_f32_16x16x32_bf16 v[192:195], v[100:103], v[112:115], v[192:195]
    v_rcp_f32 v197, v196
    v_mfma_f32_16x16x32_bf16 v[176:179], a[232:235], v[216:219], v[176:179]
    v_mul_f32 v184, v184, v197
    v_mul_f32 v185, v185, v197
    v_mfma_f32_16x16x32_bf16 v[180:183], a[236:239], v[216:219], v[180:183]
    ds_read_b128 v[216:219], v2 offset:40960
    v_mul_f32 v186, v186, v197
    v_mfma_f32_16x16x32_bf16 v[172:175], a[240:243], v[220:223], v[172:175]
    s_waitcnt lgkmcnt(1)
    v_mul_f32 v187, v187, v197
    v_cvt_pk_bf16_f32 v184, v184, v185
    v_mfma_f32_16x16x32_bf16 v[176:179], a[244:247], v[220:223], v[176:179]
    v_mul_f32 v188, v188, v197
    v_mul_f32 v189, v189, v197
    v_mfma_f32_16x16x32_bf16 v[180:183], a[248:251], v[220:223], v[180:183]
    ds_read_b128 v[220:223], v2 offset:41984
    v_mul_f32 v190, v190, v197
    v_mfma_f32_16x16x32_bf16 v[172:175], a[252:255], v[212:215], v[172:175]
    v_mul_f32 v191, v191, v197
    v_mul_f32 v192, v192, v197
    v_mfma_f32_16x16x32_bf16 v[176:179], v[224:227], v[212:215], v[176:179]
    v_mul_f32 v193, v193, v197
    v_cvt_pk_bf16_f32 v185, v186, v187
    v_mfma_f32_16x16x32_bf16 v[180:183], v[228:231], v[212:215], v[180:183]
    s_waitcnt lgkmcnt(1)
    v_mul_f32 v194, v194, v197
    v_mul_f32 v195, v195, v197
    v_mfma_f32_16x16x32_bf16 v[172:175], v[232:235], v[216:219], v[172:175]
    v_cvt_pk_bf16_f32 v192, v192, v193
    v_cvt_pk_bf16_f32 v186, v188, v189
    v_mfma_f32_16x16x32_bf16 v[176:179], v[236:239], v[216:219], v[176:179]
    v_cvt_pk_bf16_f32 v187, v190, v191
    v_cvt_pk_bf16_f32 v193, v194, v195
    v_mfma_f32_16x16x32_bf16 v[180:183], v[240:243], v[216:219], v[180:183]
    s_waitcnt lgkmcnt(0)
    v_mul_u32_u24 v104, 384, v104
    v_lshrrev_b32 v105, 4, v107
    v_mfma_f32_16x16x32_bf16 v[172:175], v[244:247], v[220:223], v[172:175]
    v_add_u32 v104, s70, v104
    v_lshl_add_u32 v104, v105, 4, v104
    v_mfma_f32_16x16x32_bf16 v[176:179], v[248:251], v[220:223], v[176:179]
    v_and_b32 v105, 3, v107
    v_cmp_eq_u32 vcc, 0, v105
    v_mfma_f32_16x16x32_bf16 v[180:183], v[252:255], v[220:223], v[180:183]
    s_mov_b32 exec_lo, 0x10001000
    s_mov_b32 exec_hi, 0x10001000
    ds_write_b128 v3, v[184:187]
    s_mov_b64 exec, -1
    s_mov_b32 exec_lo, 0x10001000
    s_mov_b32 exec_hi, 0x10001000
    ds_write_b64 v4, v[192:193]
    s_mov_b64 exec, -1
    v_cvt_pk_bf16_f32 v172, v172, v173
    v_cvt_pk_bf16_f32 v173, v174, v175
    v_cvt_pk_bf16_f32 v180, v180, v181
    v_cvt_pk_bf16_f32 v174, v176, v177
    v_cvt_pk_bf16_f32 v175, v178, v179
    v_cvt_pk_bf16_f32 v181, v182, v183
    v_add_u32 v182, v14, v10
    buffer_store_dwordx4 v[172:175], v14, s[36:39], 0 offen
    v_mov_b32 v106, 0x40000000
    v_cndmask_b32 v104, v106, v104, vcc
    s_waitcnt lgkmcnt(0)
    s_barrier
    ds_read_b128 v[212:215], v2
    ds_read_b128 v[216:219], v2 offset:1024
    ds_read_b128 v[220:223], v2 offset:2048
    buffer_store_dwordx2 v[180:181], v182, s[36:39], 0 offen
    s_waitcnt lgkmcnt(2)
    v_mfma_f32_16x16x32_bf16 v[172:175], a[216:219], v[212:215], 0
    v_mfma_f32_16x16x32_bf16 v[176:179], a[220:223], v[212:215], 0
    s_waitcnt lgkmcnt(1)
    v_mfma_f32_16x16x32_bf16 v[180:183], a[224:227], v[212:215], 0
    ds_read_b128 v[212:215], v2 offset:3072
    v_mfma_f32_16x16x32_bf16 v[172:175], a[228:231], v[216:219], v[172:175]
    s_waitcnt lgkmcnt(1)
    v_mfma_f32_16x16x32_bf16 v[176:179], a[232:235], v[216:219], v[176:179]
    v_mfma_f32_16x16x32_bf16 v[180:183], a[236:239], v[216:219], v[180:183]
    ds_read_b128 v[216:219], v2 offset:4096
    v_mfma_f32_16x16x32_bf16 v[172:175], a[240:243], v[220:223], v[172:175]
    v_mfma_f32_16x16x32_bf16 v[176:179], a[244:247], v[220:223], v[176:179]
    v_mfma_f32_16x16x32_bf16 v[180:183], a[248:251], v[220:223], v[180:183]
    s_waitcnt lgkmcnt(1)
    ds_read_b128 v[220:223], v2 offset:5120
    v_mfma_f32_16x16x32_bf16 v[172:175], a[252:255], v[212:215], v[172:175]
    v_mfma_f32_16x16x32_bf16 v[180:183], v[228:231], v[212:215], v[180:183]
    v_mfma_f32_16x16x32_bf16 v[176:179], v[224:227], v[212:215], v[176:179]
    s_waitcnt lgkmcnt(1)
    v_mfma_f32_16x16x32_bf16 v[172:175], v[232:235], v[216:219], v[172:175]
    v_mfma_f32_16x16x32_bf16 v[180:183], v[240:243], v[216:219], v[180:183]
    v_mfma_f32_16x16x32_bf16 v[176:179], v[236:239], v[216:219], v[176:179]
    s_waitcnt lgkmcnt(0)
    v_mfma_f32_16x16x32_bf16 v[172:175], v[244:247], v[220:223], v[172:175]
    v_mfma_f32_16x16x32_bf16 v[180:183], v[252:255], v[220:223], v[180:183]
    v_mfma_f32_16x16x32_bf16 v[176:179], v[248:251], v[220:223], v[176:179]
    s_nop 5
    v_cvt_pk_bf16_f32 v172, v172, v173
    v_cvt_pk_bf16_f32 v180, v180, v181
    v_cvt_pk_bf16_f32 v173, v174, v175
    v_cvt_pk_bf16_f32 v181, v182, v183
    v_cvt_pk_bf16_f32 v174, v176, v177
    v_cvt_pk_bf16_f32 v175, v178, v179
    v_add_u32 v182, v104, v10
    buffer_store_dwordx4 v[172:175], v104, s[36:39], 0 offen
    buffer_store_dwordx2 v[180:181], v182, s[36:39], 0 offen
    s_endpgm
.section .rodata,"a"
.p2align 6
.amdhsa_kernel standalone__window_attn_swin__vision_kernel
  .amdhsa_next_free_vgpr 512
  .amdhsa_next_free_sgpr 102
  .amdhsa_accum_offset 256
  .amdhsa_group_segment_fixed_size 0
  .amdhsa_kernarg_size 72
  .amdhsa_user_sgpr_count 2
  .amdhsa_user_sgpr_kernarg_segment_ptr 1
  .amdhsa_system_sgpr_workgroup_id_x 1
  .amdhsa_float_denorm_mode_32 3
.end_amdhsa_kernel
```
